```python
import torch

def _softmax(x, axis=-1):
    return torch.softmax(x, dim=axis)
def _gelu(x):
    return torch.nn.functional.gelu(x, approximate="tanh")
def _silu(x):
    return torch.nn.functional.silu(x)
def _sigmoid(x):
    return torch.sigmoid(x)
def _layernorm(x, axis=-1, eps=1e-5):
    m = x.mean(dim=axis, keepdim=True)
    v = x.var(dim=axis, keepdim=True, unbiased=False)
    return (x - m) / torch.sqrt(v + eps)
def _scatter_add(tgt, idx, src, axis=0):
    return tgt.clone().index_add_(axis, idx, src)
def _segment_sum(src, seg, n):
    out = torch.zeros((n,) + src.shape[1:], dtype=src.dtype)
    return out.index_add_(0, seg, src)
def _pad(x, pw):
    flat = tuple(v for pair in reversed(pw) for v in pair)
    return torch.nn.functional.pad(x, flat)

kernel_name = 'interleave_layers__spectral_fnet__swiglu_ffn__prompt'

def setup_inputs():

    _w = (lambda a: (lambda t: t.to(torch.bfloat16) if t.is_floating_point() else t)(torch.as_tensor(a)))
    def _A_setup():
        B, S, D = 1, 2048, 448
        ns = torch.arange(S)[:, None] * torch.arange(S)[None, :]
        nd = torch.arange(D)[:, None] * torch.arange(D)[None, :]
        Ws_re = torch.cos(-2.0 * torch.pi * ns / S).to(float)
        Ws_im = torch.sin(-2.0 * torch.pi * ns / S).to(float)
        Wd_re = torch.cos(-2.0 * torch.pi * nd / D).to(float)
        Wd_im = torch.sin(-2.0 * torch.pi * nd / D).to(float)
        return {
            "x": _w((lambda *s: torch.randn(*s, dtype=torch.bfloat16) * 0.05)(B, S, D)),
            "dft_seq_re": _w(Ws_re),
            "dft_seq_im": _w(Ws_im),
            "dft_hid_re": _w(Wd_re),
            "dft_hid_im": _w(Wd_im),
        }
    _A_in = _A_setup()

    def _B_setup():
        B, S, D, F = 1, 2048, 448, 1792
        return {
            "x": _w((lambda *s: torch.randn(*s, dtype=torch.bfloat16) * 0.05)(B, S, D)),
            "w_gate": _w((lambda *s: torch.randn(*s, dtype=torch.bfloat16) * 0.4)(D, F)),
            "w_up": _w((lambda *s: torch.randn(*s, dtype=torch.bfloat16) * 0.4)(D, F)),
            "w_down": _w((lambda *s: torch.randn(*s, dtype=torch.bfloat16) * 0.4)(F, D)),
        }
    _B_in = _B_setup()

    return {
        "A_x": _A_in["x"],
        "A_dft_seq_re": _A_in["dft_seq_re"],
        "A_dft_seq_im": _A_in["dft_seq_im"],
        "A_dft_hid_re": _A_in["dft_hid_re"],
        "A_dft_hid_im": _A_in["dft_hid_im"],
        "B_x": _B_in["x"],
        "B_w_gate": _B_in["w_gate"],
        "B_w_up": _B_in["w_up"],
        "B_w_down": _B_in["w_down"],
    }

def reference(A_x, A_dft_seq_re, A_dft_seq_im, A_dft_hid_re, A_dft_hid_im, B_x, B_w_gate, B_w_up, B_w_down):
    def _A_ref(x, dft_seq_re, dft_seq_im, dft_hid_re, dft_hid_im):
        a = torch.einsum("bsd,ed->bse", x, dft_hid_re)
        b = torch.einsum("bsd,ed->bse", x, dft_hid_im)
        y = torch.einsum("ts,bse->bte", dft_seq_re, a) - torch.einsum("ts,bse->bte", dft_seq_im, b)
        return y

    def _B_ref(x, w_gate, w_up, w_down):
        g = _silu(x @ w_gate)
        u = x @ w_up
        return (g * u) @ w_down

    x = A_x
    x = x + _A_ref(_layernorm(x, axis=-1), A_dft_seq_re, A_dft_seq_im, A_dft_hid_re, A_dft_hid_im)
    x = x + _B_ref(_layernorm(x, axis=-1), B_w_gate, B_w_up, B_w_down)
    x = x + _A_ref(_layernorm(x, axis=-1), A_dft_seq_re, A_dft_seq_im, A_dft_hid_re, A_dft_hid_im)
    x = x + _B_ref(_layernorm(x, axis=-1), B_w_gate, B_w_up, B_w_down)
    return x
```

```asm
; @launch grid=(256,1,1) block=(256,1,1) lds=163840
.amdgcn_target "amdgcn-amd-amdhsa--gfx950"
.text
.p2align 8
.globl interleave_layers__spectral_fnet__swiglu_ffn__prompt_kernel
.type interleave_layers__spectral_fnet__swiglu_ffn__prompt_kernel,@function
interleave_layers__spectral_fnet__swiglu_ffn__prompt_kernel:
  s_load_dwordx2 s[4:5], s[0:1], 0
  s_load_dwordx8 s[56:63], s[0:1], 48
  s_load_dwordx4 s[64:67], s[0:1], 80
  s_cmp_ge_u32 s2, 256
  s_cbranch_scc1 k_end
  s_getpc_b64 s[26:27]
k_pc:
  s_lshr_b32 s21, s2, 3
  v_lshrrev_b32 v40, 2, v0
  v_lshl_add_u32 v40, s21, 6, v40
  v_lshlrev_b32 v40, 6, v40
  v_min_u32 v40, k_last - k_pc, v40
  v_mov_b32 v41, s27
  v_add_co_u32 v40, vcc, s26, v40
  s_nop 1
  v_addc_co_u32 v41, vcc, 0, v41, vcc
  global_load_dword v255, v[40:41], off
  v_lshrrev_b32 v2, 6, v0
  v_and_b32 v1, 63, v0
  v_readfirstlane_b32 s20, v2
  v_lshrrev_b32 v3, 4, v1
  v_lshrrev_b32 v62, 3, v1
  v_and_b32 v63, 7, v1
  v_xor_b32 v60, v63, v3
  v_lshlrev_b32 v60, 4, v60
  s_mov_b32 s35, 57344
  v_mad_u32_u24 v60, v62, s35, v60
  v_xor_b32 v61, 64, v60
  v_add_u32 v61, 0x70000, v61
  s_and_b32 s32, s2, 7
  s_lshl_b32 s32, s32, 2
  s_bfe_u32 s35, s2, 0x20003
  s_add_u32 s32, s32, s35
  s_lshr_b32 s33, s2, 5
  s_lshr_b32 s23, s20, 1
  s_and_b32 s24, s20, 1
  s_mul_i32 s39, s20, 14336
  s_mov_b32 s6, 0x1c0000
  s_mov_b32 s7, 0x00020000
  s_cmp_ge_u32 s2, 224
  s_cbranch_scc1 k_idle1
  s_lshl_b32 s43, s23, 5
  s_lshl_b32 s35, s24, 10
  s_add_u32 s43, s43, s35
  s_add_u32 s43, s43, s32
  s_mul_i32 s43, s43, 896
  s_mov_b32 s40, s33
  s_lshl_b32 s42, s40, 11
  s_add_u32 m0, s42, s39
  s_lshl_b32 s41, s40, 7
  s_add_u32 s41, s41, s43
  s_waitcnt lgkmcnt(0)
  buffer_load_dwordx4 v60, s[4:7], s41 offen lds
  s_add_u32 m0, m0, 1024
  s_nop 0
  buffer_load_dwordx4 v61, s[4:7], s41 offen lds
  v_lshlrev_b32 v63, 4, v63
  v_and_b32 v2, 15, v1
  v_lshlrev_b32 v4, 4, v1
  s_mov_b32 s19, 0x00020000
  s_lshl_b32 s45, s2, 2
  s_add_u32 s45, s45, s20
  s_mul_i32 s44, s20, 7168
  s_add_u32 s44, s44, 114688
  s_mov_b32 s18, 1605632
  s_cmp_ge_u32 s2, 196
  s_cbranch_scc1 k_u2
  s_lshr_b32 s22, s45, 1
  s_mul_i32 s25, s22, 2341
  s_lshr_b32 s25, s25, 16
  s_mul_i32 s35, s25, 28
  s_sub_u32 s22, s22, s35
  s_lshl_b32 s46, s25, 5
  s_cmp_lt_u32 s25, 7
  s_addc_u32 s46, s46, 0
  s_mul_i32 s46, s46, 3584
  s_lshl_b32 s35, s22, 7
  s_add_u32 s46, s46, s35
  s_mul_i32 s47, s22, 56
  s_add_u32 s47, s47, s25
  s_lshl_b32 s47, s47, 1
  s_add_u32 s47, s47, s24
  s_lshl_b32 s47, s47, 10
  s_mov_b32 s48, 28672
  s_mov_b32 s49, 3584
  s_cmp_eq_u32 s25, 7
  s_cselect_b32 s21, 802816, 0
  s_mov_b32 s52, 8
  s_mov_b32 s53, 32
  s_branch k_u3
k_u2:
  s_sub_u32 s22, s45, 784
  s_lshr_b32 s25, s22, 3
  s_and_b32 s22, s22, 7
  s_mul_i32 s46, s25, 28672
  s_mul_i32 s35, s22, 112
  s_add_u32 s46, s46, s35
  s_mul_i32 s35, s25, 9363
  s_lshr_b32 s35, s35, 16
  s_mul_i32 s34, s35, 7
  s_sub_u32 s34, s25, s34
  s_cmp_eq_u32 s34, 0
  s_cselect_b32 s34, 7, s34
  s_sub_u32 s34, s34, 1
  s_lshl_b32 s34, s34, 1
  s_and_b32 s25, s35, 1
  s_add_u32 s34, s34, s25
  s_lshr_b32 s35, s35, 1
  s_lshl_b32 s22, s22, 2
  s_add_u32 s35, s35, s22
  s_mul_i32 s35, s35, 14
  s_add_u32 s35, s35, s34
  s_lshl_b32 s35, s35, 12
  s_add_u32 s47, s35, 0x310000
  s_mov_b32 s48, 1024
  s_mov_b32 s49, 896
  s_mov_b32 s21, 0
  s_mov_b32 s52, 32
  s_mov_b32 s53, 8
k_u3:
  v_mad_u32_u24 v63, v62, s49, v63
  v_add_u32 v63, s46, v63
  v_cmp_eq_u32 vcc, 0, v62
  v_mov_b32 v62, s21
  s_nop 0
  v_cndmask_b32 v62, 0, v62, vcc
  v_sub_u32 v62, v63, v62
  s_lshl_b32 s49, s49, 3
  s_mov_b32 s8, s66
  s_mov_b32 s9, s67
  s_mov_b32 s10, 0x1a00000
  s_mov_b32 s11, 0x00020000
  s_mov_b32 s12, s62
  s_mov_b32 s13, s63
  s_mov_b32 s14, 0x1c0000
  s_mov_b32 s15, 0x00020000
  s_mov_b32 s66, 0x100
  s_mov_b32 s67, 0x00020000
  s_lshl_b32 s35, s33, 5
  s_lshl_b32 s34, s24, 4
  s_add_u32 s35, s35, s34
  s_add_u32 s35, s35, 1
  v_add_u32 v28, s35, v2
  v_and_b32 v31, 1, v28
  v_cvt_f32_u32 v28, v28
  v_mul_u32_u24 v31, 0x8000, v31
  v_mul_f32 v28, 0xbb124925, v28
  v_lshl_or_b32 v31, v31, 16, v31
  s_lshl_b32 s35, s23, 7
  v_lshl_add_u32 v29, v3, 3, s35
  v_cvt_f32_u32 v29, v29
  v_mul_f32 v29, v28, v29
  s_mul_i32 s35, s24, 28672
  s_lshl_b32 s34, s23, 12
  s_add_u32 s35, s35, s34
  s_add_u32 s35, s35, 57344
  v_add_u32 v30, s35, v4
  v_fmamk_f32 v96, v28, 0x00000000, v29
  v_fmamk_f32 v97, v28, 0x3f800000, v29
  v_fmamk_f32 v98, v28, 0x40000000, v29
  v_fmamk_f32 v99, v28, 0x40400000, v29
  v_fmamk_f32 v100, v28, 0x40800000, v29
  v_fmamk_f32 v101, v28, 0x40a00000, v29
  v_fmamk_f32 v102, v28, 0x40c00000, v29
  v_fmamk_f32 v103, v28, 0x40e00000, v29
  v_sin_f32 v104, v96
  v_cos_f32 v96, v96
  v_sin_f32 v105, v97
  v_cos_f32 v97, v97
  v_sin_f32 v106, v98
  v_cos_f32 v98, v98
  v_sin_f32 v107, v99
  v_cos_f32 v99, v99
  v_sin_f32 v108, v100
  v_cos_f32 v100, v100
  v_sin_f32 v109, v101
  v_cos_f32 v101, v101
  v_sin_f32 v110, v102
  v_cos_f32 v102, v102
  v_sin_f32 v111, v103
  v_cos_f32 v103, v103
  v_cvt_pk_bf16_f32 v112, v96, v97
  v_cvt_pk_bf16_f32 v113, v98, v99
  v_cvt_pk_bf16_f32 v114, v100, v101
  v_cvt_pk_bf16_f32 v115, v102, v103
  v_cvt_pk_bf16_f32 v116, v104, v105
  v_cvt_pk_bf16_f32 v117, v106, v107
  v_cvt_pk_bf16_f32 v118, v108, v109
  v_cvt_pk_bf16_f32 v119, v110, v111
  v_xor_b32 v120, v31, v112
  v_xor_b32 v121, v31, v113
  v_xor_b32 v122, v31, v114
  v_xor_b32 v123, v31, v115
  v_xor_b32 v124, v31, v116
  v_xor_b32 v125, v31, v117
  v_xor_b32 v126, v31, v118
  v_xor_b32 v127, v31, v119
  ds_write_b128 v30, v[112:115] offset:0
  ds_write_b128 v30, v[116:119] offset:14336
  ds_write_b128 v30, v[120:123] offset:7168
  ds_write_b128 v30, v[124:127] offset:21504
  v_fmamk_f32 v128, v28, 0x42000000, v29
  v_fmamk_f32 v129, v28, 0x42040000, v29
  v_fmamk_f32 v130, v28, 0x42080000, v29
  v_fmamk_f32 v131, v28, 0x420c0000, v29
  v_fmamk_f32 v132, v28, 0x42100000, v29
  v_fmamk_f32 v133, v28, 0x42140000, v29
  v_fmamk_f32 v134, v28, 0x42180000, v29
  v_fmamk_f32 v135, v28, 0x421c0000, v29
  v_sin_f32 v136, v128
  v_cos_f32 v128, v128
  v_sin_f32 v137, v129
  s_add_u32 s40, s40, 1
  s_cmp_eq_u32 s40, 7
  s_cselect_b32 s40, 0, s40
  s_lshl_b32 s42, s40, 11
  s_add_u32 m0, s42, s39
  s_lshl_b32 s41, s40, 7
  s_add_u32 s41, s41, s43
  buffer_load_dwordx4 v60, s[4:7], s41 offen lds
  v_cos_f32 v129, v129
  v_sin_f32 v138, v130
  v_cos_f32 v130, v130
  v_sin_f32 v139, v131
  s_add_u32 m0, m0, 1024
  s_nop 0
  buffer_load_dwordx4 v61, s[4:7], s41 offen lds
  v_cos_f32 v131, v131
  v_sin_f32 v140, v132
  v_cos_f32 v132, v132
  v_sin_f32 v141, v133
  s_add_u32 s40, s40, 1
  s_cmp_eq_u32 s40, 7
  s_cselect_b32 s40, 0, s40
  s_lshl_b32 s42, s40, 11
  s_add_u32 m0, s42, s39
  s_lshl_b32 s41, s40, 7
  s_add_u32 s41, s41, s43
  buffer_load_dwordx4 v60, s[4:7], s41 offen lds
  v_cos_f32 v133, v133
  v_sin_f32 v142, v134
  v_cos_f32 v134, v134
  v_sin_f32 v143, v135
  s_add_u32 m0, m0, 1024
  s_nop 0
  buffer_load_dwordx4 v61, s[4:7], s41 offen lds
  v_cos_f32 v135, v135
  v_cvt_pk_bf16_f32 v144, v128, v129
  v_cvt_pk_bf16_f32 v145, v130, v131
  v_cvt_pk_bf16_f32 v146, v132, v133
  s_add_u32 s40, s40, 1
  s_cmp_eq_u32 s40, 7
  s_cselect_b32 s40, 0, s40
  s_lshl_b32 s42, s40, 11
  s_add_u32 m0, s42, s39
  s_lshl_b32 s41, s40, 7
  s_add_u32 s41, s41, s43
  buffer_load_dwordx4 v60, s[4:7], s41 offen lds
  v_cvt_pk_bf16_f32 v147, v134, v135
  v_cvt_pk_bf16_f32 v148, v136, v137
  v_cvt_pk_bf16_f32 v149, v138, v139
  v_cvt_pk_bf16_f32 v150, v140, v141
  s_add_u32 m0, m0, 1024
  s_nop 0
  buffer_load_dwordx4 v61, s[4:7], s41 offen lds
  v_cvt_pk_bf16_f32 v151, v142, v143
  v_xor_b32 v152, v31, v144
  v_xor_b32 v153, v31, v145
  v_xor_b32 v154, v31, v146
  s_add_u32 s40, s40, 1
  s_cmp_eq_u32 s40, 7
  s_cselect_b32 s40, 0, s40
  s_lshl_b32 s42, s40, 11
  s_add_u32 m0, s42, s39
  s_lshl_b32 s41, s40, 7
  s_add_u32 s41, s41, s43
  buffer_load_dwordx4 v60, s[4:7], s41 offen lds
  v_xor_b32 v155, v31, v147
  v_xor_b32 v156, v31, v148
  v_xor_b32 v157, v31, v149
  v_xor_b32 v158, v31, v150
  s_add_u32 m0, m0, 1024
  s_nop 0
  buffer_load_dwordx4 v61, s[4:7], s41 offen lds
  v_xor_b32 v159, v31, v151
  ds_write_b128 v30, v[144:147] offset:1024
  ds_write_b128 v30, v[148:151] offset:15360
  ds_write_b128 v30, v[152:155] offset:8192
  ds_write_b128 v30, v[156:159] offset:22528
  v_fmamk_f32 v96, v28, 0x42800000, v29
  v_fmamk_f32 v97, v28, 0x42820000, v29
  v_fmamk_f32 v98, v28, 0x42840000, v29
  s_add_u32 s40, s40, 1
  s_cmp_eq_u32 s40, 7
  s_cselect_b32 s40, 0, s40
  s_lshl_b32 s42, s40, 11
  s_add_u32 m0, s42, s39
  s_lshl_b32 s41, s40, 7
  s_add_u32 s41, s41, s43
  buffer_load_dwordx4 v60, s[4:7], s41 offen lds
  v_fmamk_f32 v99, v28, 0x42860000, v29
  v_fmamk_f32 v100, v28, 0x42880000, v29
  v_fmamk_f32 v101, v28, 0x428a0000, v29
  v_fmamk_f32 v102, v28, 0x428c0000, v29
  s_add_u32 m0, m0, 1024
  s_nop 0
  buffer_load_dwordx4 v61, s[4:7], s41 offen lds
  v_fmamk_f32 v103, v28, 0x428e0000, v29
  v_sin_f32 v104, v96
  v_cos_f32 v96, v96
  v_sin_f32 v105, v97
  s_add_u32 s40, s40, 1
  s_cmp_eq_u32 s40, 7
  s_cselect_b32 s40, 0, s40
  s_lshl_b32 s42, s40, 11
  s_add_u32 m0, s42, s39
  s_lshl_b32 s41, s40, 7
  s_add_u32 s41, s41, s43
  buffer_load_dwordx4 v60, s[4:7], s41 offen lds
  v_cos_f32 v97, v97
  v_sin_f32 v106, v98
  v_cos_f32 v98, v98
  v_sin_f32 v107, v99
  s_add_u32 m0, m0, 1024
  s_nop 0
  buffer_load_dwordx4 v61, s[4:7], s41 offen lds
  v_cos_f32 v99, v99
  v_sin_f32 v108, v100
  v_cos_f32 v100, v100
  v_sin_f32 v109, v101
  v_cos_f32 v101, v101
  v_sin_f32 v110, v102
  v_cos_f32 v102, v102
  v_sin_f32 v111, v103
  v_cos_f32 v103, v103
  v_cvt_pk_bf16_f32 v112, v96, v97
  v_cvt_pk_bf16_f32 v113, v98, v99
  v_cvt_pk_bf16_f32 v114, v100, v101
  v_cvt_pk_bf16_f32 v115, v102, v103
  v_cvt_pk_bf16_f32 v116, v104, v105
  v_cvt_pk_bf16_f32 v117, v106, v107
  v_cvt_pk_bf16_f32 v118, v108, v109
  v_cvt_pk_bf16_f32 v119, v110, v111
  v_xor_b32 v120, v31, v112
  v_xor_b32 v121, v31, v113
  v_xor_b32 v122, v31, v114
  v_xor_b32 v123, v31, v115
  v_xor_b32 v124, v31, v116
  v_xor_b32 v125, v31, v117
  v_xor_b32 v126, v31, v118
  v_xor_b32 v127, v31, v119
  ds_write_b128 v30, v[112:115] offset:2048
  ds_write_b128 v30, v[116:119] offset:16384
  ds_write_b128 v30, v[120:123] offset:9216
  ds_write_b128 v30, v[124:127] offset:23552
  s_mul_i32 s35, s23, 0xc2f80000
  s_mul_i32 s34, s23, 4088
  v_fma_f32 v29, v28, s35, v29
  v_subrev_u32 v30, s34, v30
  v_fmamk_f32 v128, v28, 0x42c00000, v29
  v_fmamk_f32 v129, v28, 0x42c20000, v29
  v_fmamk_f32 v130, v28, 0x42c40000, v29
  v_fmamk_f32 v131, v28, 0x42c60000, v29
  v_sin_f32 v132, v128
  v_cos_f32 v128, v128
  v_sin_f32 v133, v129
  v_cos_f32 v129, v129
  v_sin_f32 v134, v130
  v_cos_f32 v130, v130
  v_sin_f32 v135, v131
  v_cos_f32 v131, v131
  v_cvt_pk_bf16_f32 v144, v128, v129
  v_cvt_pk_bf16_f32 v145, v130, v131
  v_cvt_pk_bf16_f32 v146, v132, v133
  v_cvt_pk_bf16_f32 v147, v134, v135
  v_xor_b32 v152, v31, v144
  v_xor_b32 v153, v31, v145
  v_xor_b32 v154, v31, v146
  v_xor_b32 v155, v31, v147
  ds_write_b64 v30, v[144:145] offset:3072
  ds_write_b64 v30, v[146:147] offset:17408
  ds_write_b64 v30, v[152:153] offset:10240
  ds_write_b64 v30, v[154:155] offset:24576
  v_bfe_u32 v88, v1, 2, 2
  v_lshl_add_u32 v88, v3, 3, v88
  v_lshlrev_b32 v88, 3, v88
  v_and_b32 v89, 1, v1
  v_add_u32 v88, v88, v89
  v_lshl_add_u32 v88, v88, 4, s44
  v_bfe_u32 v89, v1, 1, 1
  v_mad_u32_u24 v88, v89, s52, v88
  v_add_u32 v89, s53, v88
  v_lshrrev_b32 v26, 1, v2
  v_xor_b32 v26, v3, v26
  v_lshlrev_b32 v26, 4, v26
  v_lshl_add_u32 v26, v2, 7, v26
  v_add_u32 v26, s39, v26
  v_xor_b32 v27, 64, v26
  s_bfe_u32 s21, s2, 0x20001
  s_lshl_b32 s21, s21, 3
  s_bfe_u32 s35, s2, 0x30003
  s_add_u32 s21, s21, s35
  s_sub_u32 s26, 64, s21
  s_xor_b32 s28, s23, 1
  s_cmp_eq_u32 s21, 0
  s_cselect_b32 s26, 32, s26
  s_cselect_b32 s28, s23, s28
  s_cmp_eq_u32 s23, 0
  s_cselect_b32 s27, s21, s26
  s_mul_i32 s37, s20, 458752
  s_lshl_b32 s35, s33, 12
  s_add_u32 s37, s37, s35
  s_lshl_b32 s35, s32, 6
  s_add_u32 s37, s37, s35
  s_add_u32 s37, s37, 0x500000
  s_lshl_b32 s1, s24, 10
  s_add_u32 s1, s1, s27
  s_mul_i32 s1, s1, 896
  s_mov_b32 s100, 128
  s_mov_b32 s101, 0
  s_mov_b32 s3, 0
  s_lshl_b32 s35, s20, 11
  s_add_u32 s35, s35, 155648
  v_add_u32 v17, s35, v4
  v_xor_b32 v18, 2048, v17
  s_cmp_eq_u32 s24, 0
  s_cselect_b32 s16, s56, s58
  s_cselect_b32 s17, s57, s59
  s_cmp_ge_u32 s2, 196
  s_cselect_b32 s16, s60, s16
  s_cselect_b32 s17, s61, s17
  s_add_u32 m0, s44, 0
  s_nop 0
  buffer_load_dwordx4 v62, s[16:19], 0 offen lds
  s_add_u32 m0, s44, 1024
  s_nop 0
  buffer_load_dwordx4 v63, s[16:19], s49 offen lds
  s_add_u32 m0, s44, 2048
  s_mul_i32 s46, s49, 2
  buffer_load_dwordx4 v63, s[16:19], s46 offen lds
  s_add_u32 m0, s44, 3072
  s_mul_i32 s46, s49, 3
  buffer_load_dwordx4 v63, s[16:19], s46 offen lds
  s_waitcnt vmcnt(4)
  ds_read_b128 a[0:3], v26 offset:0
  ds_read_b128 a[4:7], v27 offset:0
  ds_read_b128 a[8:11], v26 offset:2048
  ds_read_b128 a[12:15], v27 offset:2048
  ds_read_b128 a[16:19], v26 offset:4096
  ds_read_b128 a[20:23], v27 offset:4096
  ds_read_b128 a[24:27], v26 offset:6144
  ds_read_b128 a[28:31], v27 offset:6144
  ds_read_b128 a[32:35], v26 offset:8192
  ds_read_b128 a[36:39], v27 offset:8192
  ds_read_b128 a[40:43], v26 offset:10240
  ds_read_b128 a[44:47], v27 offset:10240
  ds_read_b128 a[48:51], v26 offset:12288
  ds_read_b128 a[52:55], v27 offset:12288
  s_waitcnt lgkmcnt(0)
  s_barrier
k_kloop:
  v_add_u32 v248, 57344, v4
  ds_read_b128 v[96:99], v248 offset:0
  ds_read_b128 v[100:103], v248 offset:14336
  ds_read_b128 v[104:107], v248 offset:28672
  ds_read_b128 v[108:111], v248 offset:43008
  ds_read_b128 v[112:115], v248 offset:1024
  ds_read_b128 v[116:119], v248 offset:15360
  ds_read_b128 v[120:123], v248 offset:29696
  ds_read_b128 v[124:127], v248 offset:44032
  v_mov_b32 v56, 0x3f803f80
  v_mov_b32 v57, 0x3f803f80
  v_mov_b32 v58, 0x3f803f80
  v_mov_b32 v59, 0x3f803f80
  s_lshl_b32 s34, s23, 5
  s_add_u32 s34, s34, s32
  s_lshl_b32 s35, s24, 10
  s_add_u32 s34, s34, s35
  s_mov_b32 s35, 0x3b124925
  s_mov_b32 s68, 28672
  s_waitcnt vmcnt(13)
  v_mfma_f32_16x16x32_bf16 v[48:51], a[0:3], a[0:3], 0
  ds_read_b128 v[128:131], v248 offset:2048
  ds_read_b128 v[132:135], v248 offset:16384
  v_mfma_f32_16x16x32_bf16 v[52:55], a[0:3], v[56:59], 0
  s_waitcnt vmcnt(12)
  ds_read_b128 v[136:139], v248 offset:30720
  ds_read_b128 v[140:143], v248 offset:45056
  v_mfma_f32_16x16x32_bf16 v[48:51], a[4:7], a[4:7], v[48:51]
  ds_read_b128 v[144:147], v248 offset:3072
  ds_read_b128 v[148:151], v248 offset:17408
  v_mfma_f32_16x16x32_bf16 v[52:55], a[4:7], v[56:59], v[52:55]
  s_waitcnt vmcnt(11)
  ds_read_b128 v[152:155], v248 offset:31744
  ds_read_b128 v[156:159], v248 offset:46080
  v_mfma_f32_16x16x32_bf16 v[48:51], a[8:11], a[8:11], v[48:51]
  ds_read_b128 v[160:163], v248 offset:4096
  ds_read_b128 v[164:167], v248 offset:18432
  v_mfma_f32_16x16x32_bf16 v[52:55], a[8:11], v[56:59], v[52:55]
  s_waitcnt vmcnt(10)
  ds_read_b128 v[168:171], v248 offset:32768
  ds_read_b128 v[172:175], v248 offset:47104
  v_mfma_f32_16x16x32_bf16 v[48:51], a[12:15], a[12:15], v[48:51]
  ds_read_b128 v[176:179], v248 offset:5120
  ds_read_b128 v[180:183], v248 offset:19456
  v_mfma_f32_16x16x32_bf16 v[52:55], a[12:15], v[56:59], v[52:55]
  s_waitcnt vmcnt(9)
  ds_read_b128 v[184:187], v248 offset:33792
  ds_read_b128 v[188:191], v248 offset:48128
  v_mfma_f32_16x16x32_bf16 v[48:51], a[16:19], a[16:19], v[48:51]
  ds_read_b128 v[192:195], v248 offset:6144
  ds_read_b128 v[196:199], v248 offset:20480
  v_mfma_f32_16x16x32_bf16 v[52:55], a[16:19], v[56:59], v[52:55]
  s_waitcnt lgkmcnt(14)
  ds_read_b128 v[200:203], v248 offset:34816
  ds_read_b128 v[204:207], v248 offset:49152
  v_mfma_f32_16x16x32_bf16 v[32:35], a[0:3], v[96:99], 0
  ds_read_b128 v[96:99], v248 offset:7168
  v_mov_b32 v28, 0x3727c5ac
  v_mfma_f32_16x16x32_bf16 v[36:39], a[0:3], v[100:103], 0
  ds_read_b128 v[100:103], v248 offset:21504
  v_mul_u32_u24 v250, 80, v3
  v_mfma_f32_16x16x32_bf16 v[40:43], a[0:3], v[104:107], 0
  ds_read_b128 v[104:107], v248 offset:35840
  v_lshlrev_b32 v30, 4, v3
  v_mfma_f32_16x16x32_bf16 v[44:47], a[0:3], v[108:111], 0
  s_waitcnt vmcnt(8)
  ds_read_b128 v[108:111], v248 offset:50176
  v_mad_u32_u24 v249, v2, s68, v30
  v_mfma_f32_16x16x32_bf16 v[48:51], a[20:23], a[20:23], v[48:51]
  s_add_u32 m0, s39, 0
  v_xor_b32 v29, 4096, v17
  v_xor_b32 v30, 4096, v18
  v_mfma_f32_16x16x32_bf16 v[52:55], a[20:23], v[56:59], v[52:55]
  buffer_load_dwordx4 v60, s[4:7], s1 offen sc1 lds
  v_mfma_f32_16x16x32_bf16 v[32:35], a[4:7], v[112:115], v[32:35]
  ds_read_b128 v[112:115], v248 offset:8192
  v_lshl_add_u32 v232, s20, 4, v2
  v_mfma_f32_16x16x32_bf16 v[36:39], a[4:7], v[116:119], v[36:39]
  ds_read_b128 v[116:119], v248 offset:22528
  v_cvt_f32_u32 v232, v232
  v_mfma_f32_16x16x32_bf16 v[40:43], a[4:7], v[120:123], v[40:43]
  ds_read_b128 v[120:123], v248 offset:36864
  v_lshl_add_u32 v233, v3, 8, s34
  v_mfma_f32_16x16x32_bf16 v[44:47], a[4:7], v[124:127], v[44:47]
  s_waitcnt vmcnt(8)
  ds_read_b128 v[124:127], v248 offset:51200
  v_xor_b32 v234, 32, v233
  v_mfma_f32_16x16x32_bf16 v[48:51], a[24:27], a[24:27], v[48:51]
  s_add_u32 m0, s39, 1024
  v_cvt_f32_u32 v233, v233
  v_cvt_f32_u32 v234, v234
  v_mfma_f32_16x16x32_bf16 v[52:55], a[24:27], v[56:59], v[52:55]
  buffer_load_dwordx4 v61, s[4:7], s1 offen sc1 lds
  v_mfma_f32_16x16x32_bf16 v[32:35], a[8:11], v[128:131], v[32:35]
  ds_read_b128 v[128:131], v248 offset:9216
  v_mul_f32 v232, 0x3a000000, v232
  v_mfma_f32_16x16x32_bf16 v[36:39], a[8:11], v[132:135], v[36:39]
  ds_read_b128 v[132:135], v248 offset:23552
  v_and_b32 v235, 1, v2
  v_mfma_f32_16x16x32_bf16 v[40:43], a[8:11], v[136:139], v[40:43]
  ds_read_b128 v[136:139], v248 offset:37888
  v_mul_u32_u24 v235, 0x8000, v235
  v_mfma_f32_16x16x32_bf16 v[44:47], a[8:11], v[140:143], v[44:47]
  s_waitcnt vmcnt(8)
  ds_read_b128 v[140:143], v248 offset:52224
  v_lshl_or_b32 v235, v235, 16, v235
  v_mfma_f32_16x16x32_bf16 v[48:51], a[28:31], a[28:31], v[48:51]
  s_add_u32 m0, s39, 2048
  v_mul_f32 v236, v232, v233
  v_fmamk_f32 v237, v232, 0x42800000, v236
  v_mfma_f32_16x16x32_bf16 v[52:55], a[28:31], v[56:59], v[52:55]
  s_add_u32 s1, s1, s100
  v_fmamk_f32 v238, v232, 0x43000000, v236
  v_fmamk_f32 v239, v232, 0x43400000, v236
  v_mfma_f32_16x16x32_bf16 v[32:35], a[12:15], v[144:147], v[32:35]
  ds_read_b128 v[144:147], v248 offset:10240
  v_fract_f32 v236, v236
  v_mfma_f32_16x16x32_bf16 v[36:39], a[12:15], v[148:151], v[36:39]
  s_waitcnt lgkmcnt(14)
  ds_read_b128 v[148:151], v248 offset:24576
  v_fract_f32 v237, v237
  v_mfma_f32_16x16x32_bf16 v[40:43], a[12:15], v[152:155], v[40:43]
  ds_read_b128 v[152:155], v248 offset:38912
  v_fract_f32 v238, v238
  v_mfma_f32_16x16x32_bf16 v[44:47], a[12:15], v[156:159], v[44:47]
  s_waitcnt vmcnt(7)
  ds_read_b128 v[156:159], v248 offset:53248
  v_fract_f32 v239, v239
  v_mfma_f32_16x16x32_bf16 v[48:51], a[32:35], a[32:35], v[48:51]
  buffer_load_dwordx4 v60, s[4:7], s1 offen sc1 lds
  v_mfma_f32_16x16x32_bf16 v[52:55], a[32:35], v[56:59], v[52:55]
  s_add_u32 m0, s39, 3072
  v_sin_f32 v240, v236
  v_mfma_f32_16x16x32_bf16 v[32:35], a[16:19], v[160:163], v[32:35]
  ds_read_b128 v[160:163], v248 offset:11264
  v_mfma_f32_16x16x32_bf16 v[36:39], a[16:19], v[164:167], v[36:39]
  ds_read_b128 v[164:167], v248 offset:25600
  v_mfma_f32_16x16x32_bf16 v[40:43], a[16:19], v[168:171], v[40:43]
  ds_read_b128 v[168:171], v248 offset:39936
  v_mfma_f32_16x16x32_bf16 v[44:47], a[16:19], v[172:175], v[44:47]
  s_waitcnt vmcnt(7)
  ds_read_b128 v[172:175], v248 offset:54272
  v_mfma_f32_16x16x32_bf16 v[48:51], a[36:39], a[36:39], v[48:51]
  buffer_load_dwordx4 v61, s[4:7], s1 offen sc1 lds
  v_mfma_f32_16x16x32_bf16 v[52:55], a[36:39], v[56:59], v[52:55]
  s_add_u32 m0, s39, 4096
  v_cos_f32 v236, v236
  v_mfma_f32_16x16x32_bf16 v[32:35], a[20:23], v[176:179], v[32:35]
  ds_read_b128 v[176:179], v248 offset:12288
  v_mfma_f32_16x16x32_bf16 v[36:39], a[20:23], v[180:183], v[36:39]
  ds_read_b128 v[180:183], v248 offset:26624
  v_mfma_f32_16x16x32_bf16 v[40:43], a[20:23], v[184:187], v[40:43]
  ds_read_b128 v[184:187], v248 offset:40960
  v_mfma_f32_16x16x32_bf16 v[44:47], a[20:23], v[188:191], v[44:47]
  s_cmp_eq_u32 s3, 0
  s_cbranch_scc1 k_x10
  s_waitcnt vmcnt(4)
k_x10:
  ds_read_b128 v[188:191], v248 offset:55296
  v_mfma_f32_16x16x32_bf16 v[48:51], a[40:43], a[40:43], v[48:51]
  s_add_u32 s1, s1, s100
  v_sin_f32 v241, v237
  v_mfma_f32_16x16x32_bf16 v[52:55], a[40:43], v[56:59], v[52:55]
  buffer_load_dwordx4 v60, s[4:7], s1 offen sc1 lds
  v_mfma_f32_16x16x32_bf16 v[32:35], a[24:27], v[192:195], v[32:35]
  ds_read_b128 v[192:195], v248 offset:13312
  v_mfma_f32_16x16x32_bf16 v[36:39], a[24:27], v[196:199], v[36:39]
  ds_read_b128 v[196:199], v248 offset:27648
  v_mfma_f32_16x16x32_bf16 v[40:43], a[24:27], v[200:203], v[40:43]
  ds_read_b128 v[200:203], v248 offset:41984
  v_mfma_f32_16x16x32_bf16 v[44:47], a[24:27], v[204:207], v[44:47]
  s_waitcnt lgkmcnt(14)
  ds_read_b128 v[204:207], v248 offset:56320
  v_mfma_f32_16x16x32_bf16 v[48:51], a[44:47], a[44:47], v[48:51]
  s_add_u32 m0, s39, 5120
  v_cos_f32 v237, v237
  v_mfma_f32_16x16x32_bf16 v[52:55], a[44:47], v[56:59], v[52:55]
  buffer_load_dwordx4 v61, s[4:7], s1 offen sc1 lds
  v_mfma_f32_16x16x32_bf16 v[32:35], a[28:31], v[96:99], v[32:35]
  s_add_u32 m0, s39, 6144
  v_sin_f32 v242, v238
  v_mfma_f32_16x16x32_bf16 v[36:39], a[28:31], v[100:103], v[36:39]
  s_add_u32 s1, s1, s100
  v_cos_f32 v238, v238
  v_mfma_f32_16x16x32_bf16 v[40:43], a[28:31], v[104:107], v[40:43]
  buffer_load_dwordx4 v60, s[4:7], s1 offen sc1 lds
  v_mfma_f32_16x16x32_bf16 v[44:47], a[28:31], v[108:111], v[44:47]
  s_add_u32 m0, s39, 7168
  v_sin_f32 v243, v239
  v_mfma_f32_16x16x32_bf16 v[48:51], a[48:51], a[48:51], v[48:51]
  buffer_load_dwordx4 v61, s[4:7], s1 offen sc1 lds
  v_mfma_f32_16x16x32_bf16 v[52:55], a[48:51], v[56:59], v[52:55]
  s_add_u32 m0, s39, 8192
  v_cos_f32 v239, v239
  v_mfma_f32_16x16x32_bf16 v[32:35], a[32:35], v[112:115], v[32:35]
  s_add_u32 s1, s1, s100
  v_cvt_pk_bf16_f32 v212, v240, v241
  v_cvt_pk_bf16_f32 v210, v236, v237
  v_mfma_f32_16x16x32_bf16 v[36:39], a[32:35], v[116:119], v[36:39]
  buffer_load_dwordx4 v60, s[4:7], s1 offen sc1 lds
  v_mfma_f32_16x16x32_bf16 v[40:43], a[32:35], v[120:123], v[40:43]
  s_add_u32 m0, s39, 9216
  v_cvt_pk_bf16_f32 v213, v242, v243
  v_cvt_pk_bf16_f32 v211, v238, v239
  v_mfma_f32_16x16x32_bf16 v[44:47], a[32:35], v[124:127], v[44:47]
  buffer_load_dwordx4 v61, s[4:7], s1 offen sc1 lds
  v_mfma_f32_16x16x32_bf16 v[48:51], a[52:55], a[52:55], v[48:51]
  v_xor_b32 v208, 0x80008000, v212
  v_xor_b32 v209, 0x80008000, v213
  v_mfma_f32_16x16x32_bf16 v[52:55], a[52:55], v[56:59], v[52:55]
  v_xor_b32 v214, v235, v208
  v_xor_b32 v215, v235, v209
  v_mfma_f32_16x16x32_bf16 v[32:35], a[36:39], v[128:131], v[32:35]
  s_add_u32 m0, s39, 10240
  v_xor_b32 v216, v235, v210
  v_xor_b32 v217, v235, v211
  v_mfma_f32_16x16x32_bf16 v[36:39], a[36:39], v[132:135], v[36:39]
  ds_bpermute_b32 v24, v250, v48 offset:0
  ds_bpermute_b32 v25, v250, v49 offset:4
  v_mfma_f32_16x16x32_bf16 v[40:43], a[36:39], v[136:139], v[40:43]
  ds_bpermute_b32 v26, v250, v50 offset:8
  ds_bpermute_b32 v27, v250, v51 offset:12
  v_mfma_f32_16x16x32_bf16 v[44:47], a[36:39], v[140:143], v[44:47]
  v_mul_f32 v52, s35, v52
  v_mul_f32 v53, s35, v53
  v_mfma_f32_16x16x32_bf16 v[32:35], a[40:43], v[144:147], v[32:35]
  v_mul_f32 v54, s35, v54
  v_mul_f32 v55, s35, v55
  v_mfma_f32_16x16x32_bf16 v[36:39], a[40:43], v[148:151], v[36:39]
  s_waitcnt lgkmcnt(14)
  v_fma_f32 v52, -v52, v52, v28
  v_fma_f32 v53, -v53, v53, v28
  v_mfma_f32_16x16x32_bf16 v[40:43], a[40:43], v[152:155], v[40:43]
  v_fma_f32 v54, -v54, v54, v28
  v_fma_f32 v55, -v55, v55, v28
  v_mfma_f32_16x16x32_bf16 v[44:47], a[40:43], v[156:159], v[44:47]
  s_add_u32 s1, s1, s100
  v_xor_b32 v218, v235, v212
  v_xor_b32 v219, v235, v213
  v_mfma_f32_16x16x32_bf16 v[32:35], a[44:47], v[160:163], v[32:35]
  buffer_load_dwordx4 v60, s[4:7], s1 offen sc1 lds
  v_mfma_f32_16x16x32_bf16 v[36:39], a[44:47], v[164:167], v[36:39]
  s_add_u32 m0, s39, 11264
  v_mul_f32 v236, v232, v234
  v_fmamk_f32 v237, v232, 0x42800000, v236
  s_waitcnt lgkmcnt(13)
  v_mfma_f32_16x16x32_bf16 v[40:43], a[44:47], v[168:171], v[40:43]
  s_waitcnt lgkmcnt(3)
  v_fma_f32 v24, v24, s35, v52
  s_waitcnt lgkmcnt(2)
  v_fma_f32 v25, v25, s35, v53
  v_mfma_f32_16x16x32_bf16 v[44:47], a[44:47], v[172:175], v[44:47]
  s_waitcnt lgkmcnt(1)
  v_fma_f32 v26, v26, s35, v54
  s_waitcnt lgkmcnt(0)
  v_fma_f32 v27, v27, s35, v55
  v_mfma_f32_16x16x32_bf16 v[32:35], a[48:51], v[176:179], v[32:35]
  v_rsq_f32 v24, v24
  v_mfma_f32_16x16x32_bf16 v[36:39], a[48:51], v[180:183], v[36:39]
  v_rsq_f32 v25, v25
  v_mfma_f32_16x16x32_bf16 v[40:43], a[48:51], v[184:187], v[40:43]
  v_rsq_f32 v26, v26
  v_mfma_f32_16x16x32_bf16 v[44:47], a[48:51], v[188:191], v[44:47]
  v_rsq_f32 v27, v27
  v_mfma_f32_16x16x32_bf16 v[32:35], a[52:55], v[192:195], v[32:35]
  v_add_f32 v62, v24, v25
  v_add_f32 v63, v26, v27
  v_mfma_f32_16x16x32_bf16 v[36:39], a[52:55], v[196:199], v[36:39]
  v_cmp_u_f32 vcc, v62, v63
  v_fmamk_f32 v238, v232, 0x43000000, v236
  v_mfma_f32_16x16x32_bf16 v[40:43], a[52:55], v[200:203], v[40:43]
  buffer_load_dwordx4 v61, s[4:7], s1 offen sc1 lds
  v_mfma_f32_16x16x32_bf16 v[44:47], a[52:55], v[204:207], v[44:47]
  s_add_u32 m0, s39, 12288
  v_fmamk_f32 v239, v232, 0x43400000, v236
  v_fract_f32 v236, v236
  s_cbranch_vccnz k_xre
k_xok:
  s_cmp_lg_u32 s3, 0
  s_cbranch_scc1 k_w1
  s_waitcnt vmcnt(12)
  ds_read_b64_tr_b16 v[64:65], v88 offset:0
  ds_read_b64_tr_b16 v[66:67], v88 offset:512
  ds_read_b64_tr_b16 v[68:69], v89 offset:0
  ds_read_b64_tr_b16 v[70:71], v89 offset:512
  ds_read_b64_tr_b16 v[72:73], v88 offset:64
  ds_read_b64_tr_b16 v[74:75], v88 offset:576
  ds_read_b64_tr_b16 v[76:77], v89 offset:64
  ds_read_b64_tr_b16 v[78:79], v89 offset:576
k_w1:
  v_pk_mul_f32 v[32:33], v[32:33], v[24:25]
  s_add_u32 s1, s1, s100
  buffer_load_dwordx4 v60, s[4:7], s1 offen sc1 lds
  v_pk_mul_f32 v[34:35], v[34:35], v[26:27]
  v_pk_mul_f32 v[36:37], v[36:37], v[24:25]
  v_pk_mul_f32 v[38:39], v[38:39], v[26:27]
  v_cvt_pk_bf16_f32 v96, v32, v33
  v_cvt_pk_bf16_f32 v97, v34, v35
  v_cvt_pk_bf16_f32 v98, v36, v37
  s_add_u32 m0, s39, 13312
  s_nop 0
  buffer_load_dwordx4 v61, s[4:7], s1 offen sc1 lds
  v_cvt_pk_bf16_f32 v99, v38, v39
  ds_write_b128 v17, v[96:99] offset:0
  v_pk_mul_f32 v[40:41], v[40:41], v[24:25]
  v_pk_mul_f32 v[42:43], v[42:43], v[26:27]
  v_pk_mul_f32 v[44:45], v[44:45], v[24:25]
  v_pk_mul_f32 v[46:47], v[46:47], v[26:27]
  v_cvt_pk_bf16_f32 v100, v40, v41
  v_cvt_pk_bf16_f32 v101, v42, v43
  v_cvt_pk_bf16_f32 v102, v44, v45
  v_cvt_pk_bf16_f32 v103, v46, v47
  ds_write_b128 v17, v[100:103] offset:1024
  v_fract_f32 v237, v237
  v_fract_f32 v238, v238
  v_fract_f32 v239, v239
  v_sin_f32 v240, v236
  v_cos_f32 v236, v236
  v_sin_f32 v241, v237
  v_cos_f32 v237, v237
  v_sin_f32 v242, v238
  v_cos_f32 v238, v238
  v_sin_f32 v243, v239
  v_cos_f32 v239, v239
  v_cvt_pk_bf16_f32 v224, v240, v241
  v_cvt_pk_bf16_f32 v222, v236, v237
  v_cvt_pk_bf16_f32 v225, v242, v243
  v_cvt_pk_bf16_f32 v223, v238, v239
  v_xor_b32 v220, 0x80008000, v224
  v_xor_b32 v221, 0x80008000, v225
  v_xor_b32 v226, v235, v220
  v_xor_b32 v227, v235, v221
  v_xor_b32 v228, v235, v222
  v_xor_b32 v229, v235, v223
  v_xor_b32 v230, v235, v224
  v_xor_b32 v231, v235, v225
  s_waitcnt lgkmcnt(0)
  s_cmp_lg_u32 s3, 0
  s_cbranch_scc1 k_w2
  buffer_store_dwordx4 v[64:67], v4, s[8:11], s47 offen sc1
  s_add_u32 s47, s47, s48
  buffer_store_dwordx4 v[68:71], v4, s[8:11], s47 offen sc1
  s_add_u32 s47, s47, s48
  buffer_store_dwordx4 v[72:75], v4, s[8:11], s47 offen sc1
  s_add_u32 s47, s47, s48
  buffer_store_dwordx4 v[76:79], v4, s[8:11], s47 offen sc1
k_w2:
  s_barrier
  ds_read_b128 v[104:107], v18 offset:0
  ds_read_b128 v[108:111], v18 offset:1024
  ds_read_b128 v[112:115], v29 offset:0
  ds_read_b128 v[116:119], v29 offset:1024
  ds_read_b128 v[120:123], v30 offset:0
  ds_read_b128 v[124:127], v30 offset:1024
  v_mfma_f32_16x16x32_bf16 v[232:235], v[96:99], v[210:213], 0
  v_mfma_f32_16x16x32_bf16 v[236:239], v[96:99], v[208:211], 0
  v_mfma_f32_16x16x32_bf16 v[240:243], v[100:103], v[210:213], 0
  v_mfma_f32_16x16x32_bf16 v[244:247], v[100:103], v[208:211], 0
  s_waitcnt lgkmcnt(5)
  v_mfma_f32_16x16x32_bf16 v[232:235], v[104:107], v[216:219], v[232:235]
  v_mfma_f32_16x16x32_bf16 v[236:239], v[104:107], v[214:217], v[236:239]
  s_waitcnt lgkmcnt(4)
  v_mfma_f32_16x16x32_bf16 v[240:243], v[108:111], v[216:219], v[240:243]
  v_mfma_f32_16x16x32_bf16 v[244:247], v[108:111], v[214:217], v[244:247]
  s_waitcnt lgkmcnt(3)
  v_mfma_f32_16x16x32_bf16 v[232:235], v[112:115], v[222:225], v[232:235]
  v_mfma_f32_16x16x32_bf16 v[236:239], v[112:115], v[220:223], v[236:239]
  s_waitcnt lgkmcnt(2)
  v_mfma_f32_16x16x32_bf16 v[240:243], v[116:119], v[222:225], v[240:243]
  v_mfma_f32_16x16x32_bf16 v[244:247], v[116:119], v[220:223], v[244:247]
  s_waitcnt lgkmcnt(1)
  v_mfma_f32_16x16x32_bf16 v[232:235], v[120:123], v[228:231], v[232:235]
  v_mfma_f32_16x16x32_bf16 v[236:239], v[120:123], v[226:229], v[236:239]
  s_waitcnt lgkmcnt(0)
  v_mfma_f32_16x16x32_bf16 v[240:243], v[124:127], v[228:231], v[240:243]
  v_mfma_f32_16x16x32_bf16 v[244:247], v[124:127], v[226:229], v[244:247]
  s_nop 4
  v_cvt_pk_bf16_f32 v52, v232, v236
  v_cvt_pk_bf16_f32 v53, v233, v237
  v_cvt_pk_bf16_f32 v54, v234, v238
  v_cvt_pk_bf16_f32 v55, v235, v239
  buffer_store_dwordx4 v[52:55], v249, s[8:11], s37 offen offset:0 sc1
  v_cvt_pk_bf16_f32 v56, v240, v244
  v_cvt_pk_bf16_f32 v57, v241, v245
  v_cvt_pk_bf16_f32 v58, v242, v246
  v_cvt_pk_bf16_f32 v59, v243, v247
  buffer_store_dwordx4 v[56:59], v249, s[8:11], s37 offen offset:2048 sc1
  s_cmp_eq_u32 s3, 0
  s_cbranch_scc1 k_l1t
k_a2t:
  s_add_u32 s46, s26, 0
  s_add_u32 m0, s62, 0
  s_nop 0
  buffer_load_dwordx4 v4, s[8:11], s46 offen offset:0 sc1 lds
  s_add_u32 m0, s62, 3072
  s_nop 0
  buffer_load_dwordx4 v4, s[8:11], s46 offen offset:1024 sc1 lds
  v_add_u32 v28, s39, v4
  s_waitcnt vmcnt(4)
  ds_read_b32 v232, v28 offset:0
  ds_read_b32 v233, v28 offset:1024
  ds_read_b32 v234, v28 offset:2048
  ds_read_b32 v235, v28 offset:3072
  ds_read_b32 v236, v28 offset:4096
  ds_read_b32 v237, v28 offset:5120
  ds_read_b32 v238, v28 offset:6144
  ds_read_b32 v239, v28 offset:7168
  ds_read_b32 v240, v28 offset:8192
  ds_read_b32 v241, v28 offset:9216
  ds_read_b32 v242, v28 offset:10240
  ds_read_b32 v243, v28 offset:11264
  ds_read_b32 v244, v28 offset:12288
  ds_read_b32 v245, v28 offset:13312
  s_waitcnt lgkmcnt(11)
  v_max3_u32 v232, v232, v233, v234
  s_waitcnt lgkmcnt(9)
  v_max3_u32 v232, v232, v235, v236
  s_waitcnt lgkmcnt(7)
  v_max3_u32 v232, v232, v237, v238
  s_waitcnt lgkmcnt(5)
  v_max3_u32 v232, v232, v239, v240
  s_waitcnt lgkmcnt(3)
  v_max3_u32 v232, v232, v241, v242
  s_waitcnt lgkmcnt(1)
  v_max3_u32 v232, v232, v243, v244
  s_waitcnt lgkmcnt(0)
  v_max3_u32 v232, v232, v245, v245
  v_cmp_eq_u32 vcc, -1, v232
  s_cbranch_vccnz k_rre
k_join:
  s_barrier
  s_lshl_b32 s34, s24, 10
  s_add_u32 s34, s34, s27
  s_mul_i32 s34, s34, 896
  s_mov_b32 s35, 57344
  v_mul_u32_u24 v254, s35, v2
  buffer_load_dword v255, v254, s[12:15], s34 offen
  v_and_b32 v30, 1, v3
  s_add_u32 m0, s62, 6144
  s_nop 0
  buffer_load_dwordx4 v4, s[8:11], s46 offen offset:2048 sc1 lds
  v_mul_u32_u24 v30, 240, v30
  v_add3_u32 v30, v30, v6, 8
  s_mul_i32 s35, s28, 28672
  v_lshl_add_u32 v31, v2, 4, s35
  ds_read_b64 v[96:97], v6 offset:0
  ds_read_b32 v99, v30 offset:0
  ds_read_b64 v[106:107], v7 offset:6144
  ds_read_b64 v[100:101], v6 offset:14336
  ds_read_b32 v103, v30 offset:14336
  ds_read_b64 v[110:111], v7 offset:20480
  ds_read_b64 v[112:113], v6 offset:1024
  ds_read_b32 v115, v30 offset:1024
  ds_read_b64 v[122:123], v7 offset:5120
  s_add_u32 m0, s62, 9216
  s_nop 0
  buffer_load_dwordx4 v4, s[8:11], s46 offen offset:3072 sc1 lds
  ds_read_b64 v[116:117], v6 offset:15360
  ds_read_b32 v119, v30 offset:15360
  ds_read_b64 v[126:127], v7 offset:19456
  ds_read_b64 v[176:177], v6 offset:2048
  ds_read_b32 v179, v30 offset:2048
  ds_read_b64 v[186:187], v7 offset:4096
  ds_read_b64 v[180:181], v6 offset:16384
  ds_read_b32 v183, v30 offset:16384
  ds_read_b64 v[190:191], v7 offset:18432
  s_waitcnt lgkmcnt(14)
  v_and_b32 v98, 0xffff0000, v97
  v_lshlrev_b32 v97, 16, v97
  v_and_b32 v96, 0xffff0000, v96
  s_add_u32 s47, s26, 4096
  s_add_u32 m0, s62, 16384
  s_nop 0
  buffer_load_dwordx4 v4, s[8:11], s47 offen offset:0 sc1 lds
  v_lshlrev_b32 v99, 16, v99
  v_and_b32 v104, 0xffff0000, v107
  v_lshlrev_b32 v105, 16, v107
  v_lshlrev_b32 v107, 16, v106
  v_and_b32 v106, 0xffff0000, v106
  v_and_b32 v102, 0xffff0000, v101
  v_lshlrev_b32 v101, 16, v101
  v_and_b32 v100, 0xffff0000, v100
  s_waitcnt lgkmcnt(13)
  v_lshlrev_b32 v103, 16, v103
  s_waitcnt lgkmcnt(12)
  v_and_b32 v108, 0xffff0000, v111
  v_lshlrev_b32 v109, 16, v111
  v_lshlrev_b32 v111, 16, v110
  s_add_u32 m0, s62, 19456
  s_nop 0
  buffer_load_dwordx4 v4, s[8:11], s47 offen offset:1024 sc1 lds
  v_and_b32 v110, 0xffff0000, v110
  ds_read_b64 v[128:129], v6 offset:3072
  ds_read_b32 v131, v30 offset:3072
  ds_read_b64 v[138:139], v7 offset:3072
  ds_read_b64 v[132:133], v6 offset:17408
  ds_read_b32 v135, v30 offset:17408
  ds_read_b64 v[142:143], v7 offset:17408
  s_waitcnt lgkmcnt(14)
  v_and_b32 v114, 0xffff0000, v113
  v_lshlrev_b32 v113, 16, v113
  v_and_b32 v112, 0xffff0000, v112
  v_lshlrev_b32 v115, 16, v115
  v_and_b32 v120, 0xffff0000, v123
  s_add_u32 m0, s62, 22528
  s_nop 0
  buffer_load_dwordx4 v4, s[8:11], s47 offen offset:2048 sc1 lds
  v_lshlrev_b32 v121, 16, v123
  v_lshlrev_b32 v123, 16, v122
  v_and_b32 v122, 0xffff0000, v122
  v_and_b32 v118, 0xffff0000, v117
  v_lshlrev_b32 v117, 16, v117
  v_and_b32 v116, 0xffff0000, v116
  s_waitcnt lgkmcnt(13)
  v_lshlrev_b32 v119, 16, v119
  s_waitcnt lgkmcnt(12)
  v_and_b32 v124, 0xffff0000, v127
  v_lshlrev_b32 v125, 16, v127
  v_lshlrev_b32 v127, 16, v126
  v_and_b32 v126, 0xffff0000, v126
  ds_read_b64 v[192:193], v6 offset:4096
  s_add_u32 m0, s62, 25600
  s_nop 0
  buffer_load_dwordx4 v4, s[8:11], s47 offen offset:3072 sc1 lds
  ds_read_b32 v195, v30 offset:4096
  ds_read_b64 v[202:203], v7 offset:2048
  ds_read_b64 v[196:197], v6 offset:18432
  ds_read_b32 v199, v30 offset:18432
  ds_read_b64 v[206:207], v7 offset:16384
  s_waitcnt lgkmcnt(14)
  v_and_b32 v178, 0xffff0000, v177
  v_lshlrev_b32 v177, 16, v177
  v_and_b32 v176, 0xffff0000, v176
  v_lshlrev_b32 v179, 16, v179
  v_and_b32 v184, 0xffff0000, v187
  v_lshlrev_b32 v185, 16, v187
  v_lshlrev_b32 v187, 16, v186
  s_add_u32 s48, s26, 8192
  s_add_u32 m0, s62, 32768
  s_nop 0
  buffer_load_dwordx4 v4, s[8:11], s48 offen offset:0 sc1 lds
  v_and_b32 v186, 0xffff0000, v186
  v_and_b32 v182, 0xffff0000, v181
  v_lshlrev_b32 v181, 16, v181
  v_and_b32 v180, 0xffff0000, v180
  s_waitcnt lgkmcnt(13)
  v_lshlrev_b32 v183, 16, v183
  s_waitcnt lgkmcnt(12)
  v_and_b32 v188, 0xffff0000, v191
  v_lshlrev_b32 v189, 16, v191
  v_lshlrev_b32 v191, 16, v190
  v_and_b32 v190, 0xffff0000, v190
  ds_read_b64 v[144:145], v6 offset:5120
  ds_read_b32 v147, v30 offset:5120
  ds_read_b64 v[154:155], v7 offset:1024
  s_add_u32 m0, s62, 35840
  s_nop 0
  buffer_load_dwordx4 v4, s[8:11], s48 offen offset:1024 sc1 lds
  ds_read_b64 v[148:149], v6 offset:19456
  ds_read_b32 v151, v30 offset:19456
  ds_read_b64 v[158:159], v7 offset:15360
  s_waitcnt lgkmcnt(14)
  v_and_b32 v130, 0xffff0000, v129
  v_lshlrev_b32 v129, 16, v129
  v_and_b32 v128, 0xffff0000, v128
  v_lshlrev_b32 v131, 16, v131
  v_and_b32 v136, 0xffff0000, v139
  v_lshlrev_b32 v137, 16, v139
  v_lshlrev_b32 v139, 16, v138
  v_and_b32 v138, 0xffff0000, v138
  v_and_b32 v134, 0xffff0000, v133
  s_add_u32 m0, s62, 38912
  s_nop 0
  buffer_load_dwordx4 v4, s[8:11], s48 offen offset:2048 sc1 lds
  v_lshlrev_b32 v133, 16, v133
  v_and_b32 v132, 0xffff0000, v132
  s_waitcnt lgkmcnt(13)
  v_lshlrev_b32 v135, 16, v135
  s_waitcnt lgkmcnt(12)
  v_and_b32 v140, 0xffff0000, v143
  v_lshlrev_b32 v141, 16, v143
  v_lshlrev_b32 v143, 16, v142
  v_and_b32 v142, 0xffff0000, v142
  ds_read_b64 v[160:161], v6 offset:6144
  ds_read_b32 v163, v30 offset:6144
  ds_read_b64 v[170:171], v7 offset:0
  ds_read_b64 v[164:165], v6 offset:20480
  ds_read_b32 v167, v30 offset:20480
  s_add_u32 m0, s62, 41984
  s_nop 0
  buffer_load_dwordx4 v4, s[8:11], s48 offen offset:3072 sc1 lds
  ds_read_b64 v[174:175], v7 offset:14336
  ds_read_b32 v40, v31 offset:0
  ds_read_b32 v41, v31 offset:14336
  s_waitcnt lgkmcnt(14)
  v_and_b32 v194, 0xffff0000, v193
  v_lshlrev_b32 v193, 16, v193
  v_and_b32 v192, 0xffff0000, v192
  v_lshlrev_b32 v195, 16, v195
  v_and_b32 v200, 0xffff0000, v203
  v_lshlrev_b32 v201, 16, v203
  v_lshlrev_b32 v203, 16, v202
  v_and_b32 v202, 0xffff0000, v202
  v_and_b32 v198, 0xffff0000, v197
  s_add_u32 s49, s26, 12288
  s_add_u32 m0, s62, 49152
  s_nop 0
  buffer_load_dwordx4 v4, s[8:11], s49 offen offset:0 sc1 lds
  v_lshlrev_b32 v197, 16, v197
  v_and_b32 v196, 0xffff0000, v196
  v_lshlrev_b32 v199, 16, v199
  v_and_b32 v204, 0xffff0000, v207
  v_lshlrev_b32 v205, 16, v207
  v_lshlrev_b32 v207, 16, v206
  v_and_b32 v206, 0xffff0000, v206
  s_waitcnt lgkmcnt(13)
  v_and_b32 v146, 0xffff0000, v145
  v_lshlrev_b32 v145, 16, v145
  v_and_b32 v144, 0xffff0000, v144
  s_waitcnt lgkmcnt(12)
  v_lshlrev_b32 v147, 16, v147
  s_waitcnt lgkmcnt(11)
  v_and_b32 v152, 0xffff0000, v155
  s_add_u32 m0, s62, 52224
  s_nop 0
  buffer_load_dwordx4 v4, s[8:11], s49 offen offset:1024 sc1 lds
  v_lshlrev_b32 v153, 16, v155
  v_lshlrev_b32 v155, 16, v154
  v_and_b32 v154, 0xffff0000, v154
  s_waitcnt lgkmcnt(10)
  v_and_b32 v150, 0xffff0000, v149
  v_lshlrev_b32 v149, 16, v149
  v_and_b32 v148, 0xffff0000, v148
  s_waitcnt lgkmcnt(9)
  v_lshlrev_b32 v151, 16, v151
  s_waitcnt lgkmcnt(8)
  v_and_b32 v156, 0xffff0000, v159
  v_lshlrev_b32 v157, 16, v159
  v_lshlrev_b32 v159, 16, v158
  v_and_b32 v158, 0xffff0000, v158
  s_waitcnt lgkmcnt(7)
  v_and_b32 v162, 0xffff0000, v161
  s_add_u32 s46, s40, 0
  buffer_load_dwordx4 a[0:3], v4, s[8:11], s46 offen offset:0 sc1
  v_lshlrev_b32 v161, 16, v161
  v_and_b32 v160, 0xffff0000, v160
  s_waitcnt lgkmcnt(6)
  v_lshlrev_b32 v163, 16, v163
  s_waitcnt lgkmcnt(5)
  v_and_b32 v168, 0xffff0000, v171
  v_lshlrev_b32 v169, 16, v171
  v_lshlrev_b32 v171, 16, v170
  v_and_b32 v170, 0xffff0000, v170
  s_waitcnt lgkmcnt(4)
  v_and_b32 v166, 0xffff0000, v165
  v_lshlrev_b32 v165, 16, v165
  v_and_b32 v164, 0xffff0000, v164
  s_waitcnt lgkmcnt(3)
  v_lshlrev_b32 v167, 16, v167
  s_waitcnt lgkmcnt(2)
  v_and_b32 v172, 0xffff0000, v175
  buffer_load_dwordx4 a[4:7], v4, s[8:11], s46 offen offset:1024 sc1
  v_lshlrev_b32 v173, 16, v175
  v_lshlrev_b32 v175, 16, v174
  v_and_b32 v174, 0xffff0000, v174
  s_waitcnt lgkmcnt(1)
  v_lshlrev_b32 v40, 16, v40
  s_waitcnt lgkmcnt(0)
  v_lshlrev_b32 v41, 16, v41
  s_add_u32 s47, s40, 24576
  buffer_load_dwordx4 a[8:11], v4, s[8:11], s47 offen offset:2048 sc1
  buffer_load_dwordx4 a[12:15], v4, s[8:11], s47 offen offset:3072 sc1
  buffer_load_dwordx4 a[16:19], v4, s[8:11], s46 offen offset:2048 sc1
  buffer_load_dwordx4 a[20:23], v4, s[8:11], s46 offen offset:3072 sc1
  buffer_load_dwordx4 a[24:27], v4, s[8:11], s47 offen offset:0 sc1
  buffer_load_dwordx4 a[28:31], v4, s[8:11], s47 offen offset:1024 sc1
  s_branch k_p2g
k_l1t:
k_l1i:
  v_mov_b32 v28, 0
  buffer_load_dword v63, v28, s[64:67], 0 offen sc1
  s_lshl_b32 s34, s2, 6
  v_mov_b32 v53, s34
  v_mov_b32 v52, 0x80000000
  v_cmp_eq_u32 vcc, 0, v0
  s_nop 1
  v_cndmask_b32 v22, v52, v53, vcc
  s_lshl_b32 s34, s24, 7
  s_add_u32 s34, s34, s23
  s_lshl_b32 s34, s34, 6
  v_lshl_add_u32 v20, v1, 7, s34
  v_mov_b32 v52, 1
  s_and_b32 s22, s2, 1
  s_lshl_b32 s22, s22, 2
  s_lshr_b32 s35, s2, 6
  s_add_u32 s22, s22, s35
  s_cmp_eq_u32 s28, 0
  s_cselect_b32 s30, s21, s26
  s_min_u32 s30, s30, 1
  s_mov_b32 s31, s24
  s_mul_i32 s36, s27, 14
  s_add_u32 s36, s36, s31
  s_lshl_b32 s36, s36, 11
  s_add_u32 s36, s36, 0x500000
  s_mul_i32 s35, s22, 14
  s_add_u32 s38, s35, s23
  s_mul_i32 s38, s38, 28672
  s_lshl_b32 s34, s24, 10
  s_add_u32 s38, s38, s34
  s_add_u32 s40, s35, s20
  s_add_u32 s40, s40, 2
  s_mul_i32 s40, s40, 28672
  s_lshl_b32 s41, s22, 2
  s_add_u32 s41, s41, s20
  s_mul_i32 s41, s41, 57344
  s_add_u32 s41, s41, 0x310000
  s_mul_i32 s42, s2, 28672
  s_add_u32 s42, s42, 0xc00000
  s_and_b32 s43, s2, 0x3e
  s_lshl_b32 s35, s24, 7
  s_add_u32 s43, s43, s35
  s_add_u32 s43, s43, s23
  s_mul_i32 s43, s43, 28672
  s_add_u32 s43, s43, 0xc00000
  s_lshl_b32 s62, s20, 10
  s_xor_b32 s17, s62, 1024
  s_xor_b32 s18, s62, 2048
  s_xor_b32 s19, s62, 3072
  s_add_u32 s16, s62, s43
  s_add_u32 s17, s17, s43
  s_add_u32 s18, s18, s43
  s_add_u32 s19, s19, s43
  s_add_u32 s62, s62, 57344
  s_mov_b32 s50, 0
  s_mul_i32 s51, s24, 0xffff0000
  s_sub_u32 s52, 0, s24
  s_mov_b32 s53, s52
  v_lshlrev_b32 v5, 2, v1
  v_add_u32 v5, s39, v5
  v_lshrrev_b32 v28, 1, v3
  v_and_b32 v29, 1, v3
  v_lshlrev_b32 v30, 4, v2
  v_lshl_add_u32 v30, v28, 8, v30
  v_lshl_add_u32 v30, v29, 3, v30
  s_mul_i32 s35, s23, 28672
  s_lshl_b32 s34, s31, 9
  s_add_u32 s35, s35, s34
  v_add_u32 v6, s35, v30
  v_xor_b32 v30, 0x108, v30
  s_mul_i32 s35, s28, 28672
  s_add_u32 s35, s35, 7680
  s_sub_u32 s35, s35, s34
  v_add_u32 v7, s35, v30
  s_mul_i32 s35, s24, 28672
  v_add_u32 v8, s35, v4
  s_sub_u32 s35, 28672, s35
  v_add_u32 v9, s35, v4
  v_lshl_add_u32 v11, v28, 9, v4
  s_lshl_b32 s34, s24, 11
  s_lshl_b32 s35, s23, 9
  s_add_u32 s35, s35, s34
  s_add_u32 s35, s35, 24576
  v_add_u32 v12, s35, v11
  s_mul_i32 s34, s24, 2560
  s_lshl_b32 s35, s23, 12
  s_add_u32 s35, s35, s34
  v_add_u32 v10, s35, v11
  v_xor_b32 v11, 2048, v10
  v_mov_b32 v30, s23
  v_mov_b32 v31, s28
  v_cmp_eq_u32 vcc, 0, v28
  s_nop 1
  v_cndmask_b32 v30, v31, v30, vcc
  v_lshl_add_u32 v30, v30, 1, v29
  v_lshl_add_u32 v30, v30, 4, v2
  v_lshlrev_b32 v15, 5, v30
  v_add_u32 v15, 151552, v15
  v_lshl_add_u32 v14, v28, 4, v15
  s_lshl_b32 s35, s24, 3
  v_add_u32 v14, s35, v14
  v_lshlrev_b32 v16, 3, v30
  v_add_u32 v16, 153600, v16
  v_lshlrev_b32 v0, 6, v0
  s_mul_i32 s56, s22, 1792
  s_lshl_b32 s29, s27, 1
  s_add_u32 s29, s29, s24
  s_mul_i32 s29, s29, 14336
  s_add_u32 s29, s29, 0x8c0000
  s_add_u32 s55, s29, s56
  s_mov_b32 s61, 16
  s_mov_b32 s63, 256
  s_add_u32 s56, s56, s39
  s_mov_b32 s59, 0x05040c0c
  s_cmp_lt_u32 s22, 4
  s_cselect_b32 s57, -242, 0
  s_cselect_b32 s60, 0x03020c0c, s59
  s_cselect_b32 s59, s59, 0x07060c0c
  s_cmp_eq_u32 s22, 4
  s_cselect_b32 s58, -242, s57
  s_cmp_eq_u32 s22, 0
  s_cselect_b32 s58, 7168, s58
  s_sub_u32 s69, s57, s58
  s_add_u32 s57, s57, 1024
  s_mov_b32 s54, 0x40053526
  s_bfe_u32 s35, s2, 0x30003
  s_lshl_b32 s35, s35, 1
  s_lshr_b32 s35, 0x4924, s35
  s_and_b32 s35, s35, 3
  s_add_u32 s35, s35, 1
  s_cmp_eq_u32 s35, 3
  s_cselect_b32 s35, 0, s35
  s_mul_i32 s34, s35, 114688
  s_add_u32 s21, s40, s34
  s_lshl_b32 s34, s35, 14
  s_add_u32 s31, s41, s34
  s_add_u32 s35, s35, 1
  s_cmp_eq_u32 s35, 3
  s_cselect_b32 s35, 0, s35
  s_mul_i32 s34, s35, 114688
  s_add_u32 s25, s40, s34
  s_lshl_b32 s34, s35, 14
  s_add_u32 s33, s41, s34
  s_add_u32 s35, s35, 1
  s_cmp_eq_u32 s35, 3
  s_cselect_b32 s35, 0, s35
  s_mul_i32 s34, s35, 114688
  s_add_u32 s40, s40, s34
  s_lshl_b32 s34, s35, 14
  s_add_u32 s26, s41, s34
  v_cvt_f32_u32 v32, v2
  v_add_u32 v33, s30, v2
  v_and_b32 v34, 1, v3
  v_and_b32 v35, 1, v2
  v_and_b32 v36, 1, v33
  v_cvt_f32_u32 v33, v33
  v_cvt_f32_u32 v40, v3
  s_mov_b32 s35, 0x80008000
  v_mul_lo_u32 v34, v34, s35
  v_mul_lo_u32 v35, v35, s35
  v_mul_lo_u32 v36, v36, s35
  v_mul_f32 v32, 0x3d000000, v32
  v_mul_f32 v33, 0xbd000000, v33
  v_add_f32 v41, 4.0, v40
  v_add_f32 v42, 4.0, v41
  v_add_f32 v43, 4.0, v42
  v_mul_f32 v44, v32, v40
  v_mul_f32 v45, v32, v41
  v_mul_f32 v46, v32, v42
  v_mul_f32 v47, v32, v43
  v_fract_f32 v44, v44
  v_fract_f32 v45, v45
  v_fract_f32 v46, v46
  v_fract_f32 v47, v47
  v_sin_f32 v48, v44
  v_cos_f32 v44, v44
  v_sin_f32 v49, v45
  v_cos_f32 v45, v45
  v_sin_f32 v50, v46
  v_cos_f32 v46, v46
  v_sin_f32 v51, v47
  v_cos_f32 v47, v47
  v_cvt_pk_bf16_f32 v64, v44, v48
  v_cvt_pk_bf16_f32 v65, v45, v49
  v_cvt_pk_bf16_f32 v66, v46, v50
  v_cvt_pk_bf16_f32 v67, v47, v51
  v_xor_b32 v68, v35, v64
  v_xor_b32 v69, v35, v65
  v_xor_b32 v70, v35, v66
  v_xor_b32 v71, v35, v67
  v_xor_b32 v72, v34, v64
  v_xor_b32 v73, v34, v65
  v_xor_b32 v74, v34, v66
  v_xor_b32 v75, v34, v67
  v_xor_b32 v76, v34, v68
  v_xor_b32 v77, v34, v69
  v_xor_b32 v78, v34, v70
  v_xor_b32 v79, v34, v71
  v_mul_f32 v44, v33, v40
  v_mul_f32 v45, v33, v41
  v_mul_f32 v46, v33, v42
  v_mul_f32 v47, v33, v43
  v_fract_f32 v44, v44
  v_fract_f32 v45, v45
  v_fract_f32 v46, v46
  v_fract_f32 v47, v47
  v_sin_f32 v48, v44
  v_cos_f32 v44, v44
  v_sin_f32 v49, v45
  v_cos_f32 v45, v45
  v_sin_f32 v50, v46
  v_cos_f32 v46, v46
  v_sin_f32 v51, v47
  v_cos_f32 v47, v47
  v_cvt_pk_bf16_f32 v80, v44, v48
  v_cvt_pk_bf16_f32 v81, v45, v49
  v_cvt_pk_bf16_f32 v82, v46, v50
  v_cvt_pk_bf16_f32 v83, v47, v51
  v_xor_b32 v84, v36, v80
  v_xor_b32 v85, v36, v81
  v_xor_b32 v86, v36, v82
  v_xor_b32 v87, v36, v83
  v_xor_b32 v88, v34, v80
  v_xor_b32 v89, v34, v81
  v_xor_b32 v90, v34, v82
  v_xor_b32 v91, v34, v83
  v_xor_b32 v92, v34, v84
  v_xor_b32 v93, v34, v85
  v_xor_b32 v94, v34, v86
  v_xor_b32 v95, v34, v87
  v_lshrrev_b32 v26, 1, v2
  v_xor_b32 v26, v3, v26
  v_lshlrev_b32 v26, 4, v26
  v_lshl_add_u32 v26, v2, 7, v26
  v_add_u32 v26, s39, v26
  v_xor_b32 v27, 64, v26
  s_mov_b32 s35, 0xb00000
  s_cmp_lg_u32 s20, 0
  s_waitcnt vmcnt(0) lgkmcnt(0)
  v_cmp_eq_u32 vcc, 0, v63
  v_mov_b32 v28, 0
  s_nop 4
  s_cbranch_vccz k_flagA
  s_mov_b32 s68, 0
k_pz:
  buffer_load_dword v63, v28, s[64:67], 0 offen sc1
  s_add_u32 s68, s68, 1
  s_waitcnt vmcnt(0)
  v_cmp_eq_u32 vcc, 0, v63
  s_cmp_ge_u32 s68, 0x20000
  s_cbranch_scc1 k_pz_go
  s_nop 2
  s_cbranch_vccnz k_pz
k_pz_go:
k_flagA:
  s_barrier
  buffer_store_dword v52, v22, s[8:11], s35 offen sc1
  v_mov_b32 v56, -1
  v_mov_b32 v57, -1
  v_mov_b32 v58, -1
  v_mov_b32 v59, -1
  ds_read_b128 a[0:3], v26 offset:0
  s_lshl_b32 s44, s2, 2
  s_add_u32 s44, s44, s20
  s_mul_i32 s44, s44, 7168
  s_add_u32 s44, s44, 0xc00000
  buffer_store_dwordx4 v[56:59], v4, s[8:11], s44 offen offset:0 sc1
  ds_read_b128 a[4:7], v27 offset:0
  ds_read_b128 a[8:11], v26 offset:2048
  ds_read_b128 a[12:15], v27 offset:2048
  ds_read_b128 a[16:19], v26 offset:4096
  ds_read_b128 a[20:23], v27 offset:4096
  ds_read_b128 a[24:27], v26 offset:6144
  ds_read_b128 a[28:31], v27 offset:6144
  ds_read_b128 a[32:35], v26 offset:8192
  ds_read_b128 a[36:39], v27 offset:8192
  ds_read_b128 a[40:43], v26 offset:10240
  ds_read_b128 a[44:47], v27 offset:10240
  ds_read_b128 a[48:51], v26 offset:12288
  ds_read_b128 a[52:55], v27 offset:12288
  v_add_u32 v28, s39, v4
  buffer_store_dwordx4 v[56:59], v4, s[8:11], s44 offen offset:1024 sc1
  s_waitcnt lgkmcnt(0)
  ds_write_b128 v28, a[0:3] offset:0
  ds_write_b128 v28, a[4:7] offset:1024
  ds_write_b128 v28, a[8:11] offset:2048
  ds_write_b128 v28, a[12:15] offset:3072
  ds_write_b128 v28, a[16:19] offset:4096
  ds_write_b128 v28, a[20:23] offset:5120
  ds_write_b128 v28, a[24:27] offset:6144
  ds_write_b128 v28, a[28:31] offset:7168
  ds_write_b128 v28, a[32:35] offset:8192
  ds_write_b128 v28, a[36:39] offset:9216
  ds_write_b128 v28, a[40:43] offset:10240
  ds_write_b128 v28, a[44:47] offset:11264
  ds_write_b128 v28, a[48:51] offset:12288
  ds_write_b128 v28, a[52:55] offset:13312
  buffer_store_dwordx4 v[56:59], v4, s[8:11], s44 offen offset:2048 sc1
  s_waitcnt lgkmcnt(0)
  s_barrier
  v_and_b32 v30, 1, v3
  v_mul_u32_u24 v30, 240, v30
  v_add3_u32 v30, v30, v6, 8
  s_mul_i32 s35, s28, 28672
  v_lshl_add_u32 v31, v2, 4, s35
  ds_read_b64 v[96:97], v6 offset:0
  ds_read_b32 v99, v30 offset:0
  ds_read_b64 v[106:107], v7 offset:6144
  ds_read_b64 v[100:101], v6 offset:14336
  ds_read_b32 v103, v30 offset:14336
  ds_read_b64 v[110:111], v7 offset:20480
  ds_read_b64 v[112:113], v6 offset:1024
  ds_read_b32 v115, v30 offset:1024
  ds_read_b64 v[122:123], v7 offset:5120
  ds_read_b64 v[116:117], v6 offset:15360
  buffer_store_dwordx4 v[56:59], v4, s[8:11], s44 offen offset:3072 sc1
  ds_read_b32 v119, v30 offset:15360
  ds_read_b64 v[126:127], v7 offset:19456
  ds_read_b64 v[176:177], v6 offset:2048
  ds_read_b32 v179, v30 offset:2048
  ds_read_b64 v[186:187], v7 offset:4096
  ds_read_b64 v[180:181], v6 offset:16384
  ds_read_b32 v183, v30 offset:16384
  ds_read_b64 v[190:191], v7 offset:18432
  s_waitcnt lgkmcnt(14)
  v_and_b32 v98, 0xffff0000, v97
  v_lshlrev_b32 v97, 16, v97
  v_and_b32 v96, 0xffff0000, v96
  v_lshlrev_b32 v99, 16, v99
  v_and_b32 v104, 0xffff0000, v107
  v_lshlrev_b32 v105, 16, v107
  s_add_u32 s44, s44, 0x1000
  buffer_store_dwordx4 v[56:59], v4, s[8:11], s44 offen offset:0 sc1
  v_lshlrev_b32 v107, 16, v106
  v_and_b32 v106, 0xffff0000, v106
  v_and_b32 v102, 0xffff0000, v101
  v_lshlrev_b32 v101, 16, v101
  v_and_b32 v100, 0xffff0000, v100
  s_waitcnt lgkmcnt(13)
  v_lshlrev_b32 v103, 16, v103
  s_waitcnt lgkmcnt(12)
  v_and_b32 v108, 0xffff0000, v111
  v_lshlrev_b32 v109, 16, v111
  v_lshlrev_b32 v111, 16, v110
  v_and_b32 v110, 0xffff0000, v110
  ds_read_b64 v[128:129], v6 offset:3072
  ds_read_b32 v131, v30 offset:3072
  ds_read_b64 v[138:139], v7 offset:3072
  ds_read_b64 v[132:133], v6 offset:17408
  buffer_store_dwordx4 v[56:59], v4, s[8:11], s44 offen offset:1024 sc1
  ds_read_b32 v135, v30 offset:17408
  ds_read_b64 v[142:143], v7 offset:17408
  s_waitcnt lgkmcnt(14)
  v_and_b32 v114, 0xffff0000, v113
  v_lshlrev_b32 v113, 16, v113
  v_and_b32 v112, 0xffff0000, v112
  v_lshlrev_b32 v115, 16, v115
  v_and_b32 v120, 0xffff0000, v123
  v_lshlrev_b32 v121, 16, v123
  v_lshlrev_b32 v123, 16, v122
  v_and_b32 v122, 0xffff0000, v122
  v_and_b32 v118, 0xffff0000, v117
  v_lshlrev_b32 v117, 16, v117
  v_and_b32 v116, 0xffff0000, v116
  s_waitcnt lgkmcnt(13)
  v_lshlrev_b32 v119, 16, v119
  buffer_store_dwordx4 v[56:59], v4, s[8:11], s44 offen offset:2048 sc1
  s_waitcnt lgkmcnt(12)
  v_and_b32 v124, 0xffff0000, v127
  v_lshlrev_b32 v125, 16, v127
  v_lshlrev_b32 v127, 16, v126
  v_and_b32 v126, 0xffff0000, v126
  ds_read_b64 v[192:193], v6 offset:4096
  ds_read_b32 v195, v30 offset:4096
  ds_read_b64 v[202:203], v7 offset:2048
  ds_read_b64 v[196:197], v6 offset:18432
  ds_read_b32 v199, v30 offset:18432
  ds_read_b64 v[206:207], v7 offset:16384
  s_waitcnt lgkmcnt(14)
  v_and_b32 v178, 0xffff0000, v177
  v_lshlrev_b32 v177, 16, v177
  v_and_b32 v176, 0xffff0000, v176
  v_lshlrev_b32 v179, 16, v179
  s_lshl_b32 s44, s2, 2
  s_add_u32 s44, s44, s20
  s_mul_i32 s44, s44, 3584
  s_add_u32 s44, s44, 0x700000
  buffer_store_dwordx4 v[56:59], v4, s[8:11], s44 offen offset:0 sc1
  v_and_b32 v184, 0xffff0000, v187
  v_lshlrev_b32 v185, 16, v187
  v_lshlrev_b32 v187, 16, v186
  v_and_b32 v186, 0xffff0000, v186
  v_and_b32 v182, 0xffff0000, v181
  v_lshlrev_b32 v181, 16, v181
  v_and_b32 v180, 0xffff0000, v180
  s_waitcnt lgkmcnt(13)
  v_lshlrev_b32 v183, 16, v183
  s_waitcnt lgkmcnt(12)
  v_and_b32 v188, 0xffff0000, v191
  v_lshlrev_b32 v189, 16, v191
  v_lshlrev_b32 v191, 16, v190
  v_and_b32 v190, 0xffff0000, v190
  ds_read_b64 v[144:145], v6 offset:5120
  ds_read_b32 v147, v30 offset:5120
  buffer_store_dwordx4 v[56:59], v4, s[8:11], s44 offen offset:1024 sc1
  ds_read_b64 v[154:155], v7 offset:1024
  ds_read_b64 v[148:149], v6 offset:19456
  ds_read_b32 v151, v30 offset:19456
  ds_read_b64 v[158:159], v7 offset:15360
  s_waitcnt lgkmcnt(14)
  v_and_b32 v130, 0xffff0000, v129
  v_lshlrev_b32 v129, 16, v129
  v_and_b32 v128, 0xffff0000, v128
  v_lshlrev_b32 v131, 16, v131
  v_and_b32 v136, 0xffff0000, v139
  v_lshlrev_b32 v137, 16, v139
  v_lshlrev_b32 v139, 16, v138
  v_and_b32 v138, 0xffff0000, v138
  v_and_b32 v134, 0xffff0000, v133
  v_lshlrev_b32 v133, 16, v133
  buffer_store_dwordx4 v[56:59], v4, s[8:11], s44 offen offset:2048 sc1
  v_and_b32 v132, 0xffff0000, v132
  s_waitcnt lgkmcnt(13)
  v_lshlrev_b32 v135, 16, v135
  s_waitcnt lgkmcnt(12)
  v_and_b32 v140, 0xffff0000, v143
  v_lshlrev_b32 v141, 16, v143
  v_lshlrev_b32 v143, 16, v142
  v_and_b32 v142, 0xffff0000, v142
  ds_read_b64 v[160:161], v6 offset:6144
  ds_read_b32 v163, v30 offset:6144
  ds_read_b64 v[170:171], v7 offset:0
  ds_read_b64 v[164:165], v6 offset:20480
  ds_read_b32 v167, v30 offset:20480
  ds_read_b64 v[174:175], v7 offset:14336
  ds_read_b32 v40, v31 offset:0
  ds_read_b32 v41, v31 offset:14336
  buffer_store_dwordx4 v[56:59], v4, s[8:11], s44 offen offset:2560 sc1
  s_waitcnt lgkmcnt(14)
  v_and_b32 v194, 0xffff0000, v193
  v_lshlrev_b32 v193, 16, v193
  v_and_b32 v192, 0xffff0000, v192
  v_lshlrev_b32 v195, 16, v195
  v_and_b32 v200, 0xffff0000, v203
  v_lshlrev_b32 v201, 16, v203
  v_lshlrev_b32 v203, 16, v202
  v_and_b32 v202, 0xffff0000, v202
  v_and_b32 v198, 0xffff0000, v197
  v_lshlrev_b32 v197, 16, v197
  v_and_b32 v196, 0xffff0000, v196
  v_lshlrev_b32 v199, 16, v199
  v_and_b32 v204, 0xffff0000, v207
  v_lshlrev_b32 v205, 16, v207
  v_lshlrev_b32 v207, 16, v206
  v_and_b32 v206, 0xffff0000, v206
  s_waitcnt lgkmcnt(13)
  v_and_b32 v146, 0xffff0000, v145
  v_lshlrev_b32 v145, 16, v145
  v_and_b32 v144, 0xffff0000, v144
  s_waitcnt lgkmcnt(12)
  v_lshlrev_b32 v147, 16, v147
  s_waitcnt lgkmcnt(11)
  v_and_b32 v152, 0xffff0000, v155
  v_lshlrev_b32 v153, 16, v155
  v_lshlrev_b32 v155, 16, v154
  v_and_b32 v154, 0xffff0000, v154
  s_waitcnt lgkmcnt(10)
  v_and_b32 v150, 0xffff0000, v149
  v_lshlrev_b32 v149, 16, v149
  v_and_b32 v148, 0xffff0000, v148
  s_waitcnt lgkmcnt(9)
  v_lshlrev_b32 v151, 16, v151
  s_waitcnt lgkmcnt(8)
  v_and_b32 v156, 0xffff0000, v159
  v_lshlrev_b32 v157, 16, v159
  v_lshlrev_b32 v159, 16, v158
  v_and_b32 v158, 0xffff0000, v158
  s_waitcnt lgkmcnt(7)
  v_and_b32 v162, 0xffff0000, v161
  v_lshlrev_b32 v161, 16, v161
  v_and_b32 v160, 0xffff0000, v160
  s_waitcnt lgkmcnt(6)
  v_lshlrev_b32 v163, 16, v163
  s_waitcnt lgkmcnt(5)
  v_and_b32 v168, 0xffff0000, v171
  v_lshlrev_b32 v169, 16, v171
  v_lshlrev_b32 v171, 16, v170
  v_and_b32 v170, 0xffff0000, v170
  s_waitcnt lgkmcnt(4)
  v_and_b32 v166, 0xffff0000, v165
  v_lshlrev_b32 v165, 16, v165
  v_and_b32 v164, 0xffff0000, v164
  s_waitcnt lgkmcnt(3)
  v_lshlrev_b32 v167, 16, v167
  s_waitcnt lgkmcnt(2)
  v_and_b32 v172, 0xffff0000, v175
  v_lshlrev_b32 v173, 16, v175
  v_lshlrev_b32 v175, 16, v174
  v_and_b32 v174, 0xffff0000, v174
  s_waitcnt lgkmcnt(1)
  v_lshlrev_b32 v40, 16, v40
  s_waitcnt lgkmcnt(0)
  v_lshlrev_b32 v41, 16, v41
k_gp:
  s_cmp_eq_u32 s3, 0
  s_cselect_b32 s35, 0xb00000, s36
  s_cselect_b32 s34, 0x80000000, 0
  s_cselect_b32 s68, -1, 0xfc0
  v_mov_b32 v28, 0x80000000
  v_and_b32 v44, s68, v0
  v_add_u32 v45, s34, v44
  v_add_u32 v47, 10240, v45
  v_add_u32 v46, 8192, v45
  v_add_u32 v45, 4096, v45
  s_mov_b32 s68, 0
k_pg:
  buffer_load_dword v48, v44, s[8:11], s35 offen sc1
  buffer_load_dword v49, v45, s[8:11], s35 offen sc1
  buffer_load_dword v50, v46, s[8:11], s35 offen sc1
  buffer_load_dword v51, v47, s[8:11], s35 offen sc1
  s_add_u32 s68, s68, 1
  s_waitcnt vmcnt(0)
  v_cmp_eq_u32 vcc, -1, v48
  s_nop 1
  v_cndmask_b32 v44, v28, v44, vcc
  v_cmp_eq_u32 vcc, -1, v49
  s_nop 1
  v_cndmask_b32 v45, v28, v45, vcc
  v_cmp_eq_u32 vcc, -1, v50
  s_nop 1
  v_cndmask_b32 v46, v28, v46, vcc
  v_cmp_eq_u32 vcc, -1, v51
  s_nop 1
  v_cndmask_b32 v47, v28, v47, vcc
  v_max3_u32 v48, v48, v49, v50
  v_max_u32 v48, v48, v51
  v_cmp_eq_u32 vcc, -1, v48
  s_cmp_ge_u32 s68, 0x20000
  s_cbranch_scc1 k_pg_go
  s_nop 2
  s_cbranch_vccnz k_pg
k_pg_go:
  s_barrier
  s_add_u32 m0, s39, 0
  s_add_u32 s35, s36, 0
  buffer_load_dwordx4 v4, s[8:11], s35 offen offset:0 sc1 lds
  buffer_load_dwordx4 v4, s[8:11], s35 offen offset:1024 sc1 lds
  s_add_u32 s35, s36, 2048
  buffer_load_dwordx4 v4, s[8:11], s35 offen offset:2048 sc1 lds
  buffer_load_dwordx4 v4, s[8:11], s35 offen offset:3072 sc1 lds
  s_add_u32 m0, s39, 4096
  s_add_u32 s35, s36, 8192
  buffer_load_dwordx4 v4, s[8:11], s35 offen offset:0 sc1 lds
  buffer_load_dwordx4 v4, s[8:11], s35 offen offset:1024 sc1 lds
  s_add_u32 s35, s36, 10240
  buffer_load_dwordx4 v4, s[8:11], s35 offen offset:2048 sc1 lds
  buffer_load_dwordx4 v4, s[8:11], s35 offen offset:3072 sc1 lds
  s_add_u32 m0, s39, 8192
  s_add_u32 s35, s36, 16384
  buffer_load_dwordx4 v4, s[8:11], s35 offen offset:0 sc1 lds
  buffer_load_dwordx4 v4, s[8:11], s35 offen offset:1024 sc1 lds
  s_add_u32 s35, s36, 18432
  buffer_load_dwordx4 v4, s[8:11], s35 offen offset:2048 sc1 lds
  buffer_load_dwordx4 v4, s[8:11], s35 offen offset:3072 sc1 lds
  s_add_u32 m0, s39, 12288
  s_add_u32 s35, s36, 24576
  buffer_load_dwordx4 v4, s[8:11], s35 offen offset:0 sc1 lds
  buffer_load_dwordx4 v4, s[8:11], s35 offen offset:1024 sc1 lds
  s_waitcnt vmcnt(12)
  ds_read2st64_b32 v[208:209], v5 offset0:0 offset1:1
  ds_read2st64_b32 v[210:211], v5 offset0:2 offset1:3
  ds_read2st64_b32 v[212:213], v5 offset0:4 offset1:5
  ds_read2st64_b32 v[214:215], v5 offset0:6 offset1:7
  s_waitcnt lgkmcnt(2)
  v_mfma_f32_16x16x32_bf16 v[96:99], v[208:211], v[64:67], v[96:99]
  s_waitcnt vmcnt(10)
  ds_read2st64_b32 v[216:217], v5 offset0:8 offset1:9
  ds_read2st64_b32 v[218:219], v5 offset0:10 offset1:11
  ds_read2st64_b32 v[220:221], v5 offset0:12 offset1:13
  ds_read2st64_b32 v[222:223], v5 offset0:14 offset1:15
  v_mfma_f32_16x16x32_bf16 v[100:103], v[208:211], v[72:75], v[100:103]
  v_mfma_f32_16x16x32_bf16 v[104:107], v[208:211], v[80:83], v[104:107]
  v_mfma_f32_16x16x32_bf16 v[108:111], v[208:211], v[88:91], v[108:111]
  s_waitcnt lgkmcnt(4)
  v_mfma_f32_16x16x32_bf16 v[96:99], v[212:215], v[68:71], v[96:99]
  v_mfma_f32_16x16x32_bf16 v[100:103], v[212:215], v[76:79], v[100:103]
  v_mfma_f32_16x16x32_bf16 v[104:107], v[212:215], v[84:87], v[104:107]
  v_mfma_f32_16x16x32_bf16 v[108:111], v[212:215], v[92:95], v[108:111]
  s_waitcnt lgkmcnt(2)
  v_mfma_f32_16x16x32_bf16 v[112:115], v[216:219], v[64:67], v[112:115]
  s_waitcnt vmcnt(8)
  ds_read2st64_b32 v[224:225], v5 offset0:16 offset1:17
  ds_read2st64_b32 v[226:227], v5 offset0:18 offset1:19
  ds_read2st64_b32 v[228:229], v5 offset0:20 offset1:21
  ds_read2st64_b32 v[230:231], v5 offset0:22 offset1:23
  v_mfma_f32_16x16x32_bf16 v[116:119], v[216:219], v[72:75], v[116:119]
  v_mul_f32 v36, v96, v96
  v_mul_f32 v37, v100, v100
  v_mul_f32 v38, v104, v104
  v_mul_f32 v39, v108, v108
  v_mfma_f32_16x16x32_bf16 v[120:123], v[216:219], v[80:83], v[120:123]
  v_add_f32 v32, v96, v97
  v_fmac_f32 v36, v97, v97
  v_add_f32 v33, v100, v101
  v_fmac_f32 v37, v101, v101
  v_mfma_f32_16x16x32_bf16 v[124:127], v[216:219], v[88:91], v[124:127]
  v_add_f32 v34, v104, v105
  v_fmac_f32 v38, v105, v105
  v_add_f32 v35, v108, v109
  v_fmac_f32 v39, v109, v109
  s_waitcnt lgkmcnt(4)
  v_mfma_f32_16x16x32_bf16 v[112:115], v[220:223], v[68:71], v[112:115]
  v_add_f32 v32, v32, v98
  v_fmac_f32 v36, v98, v98
  v_add_f32 v33, v33, v102
  v_fmac_f32 v37, v102, v102
  v_mfma_f32_16x16x32_bf16 v[116:119], v[220:223], v[76:79], v[116:119]
  v_add_f32 v34, v34, v106
  v_fmac_f32 v38, v106, v106
  v_add_f32 v35, v35, v110
  v_fmac_f32 v39, v110, v110
  v_mfma_f32_16x16x32_bf16 v[120:123], v[220:223], v[84:87], v[120:123]
  v_add_f32 v32, v32, v99
  v_fmac_f32 v36, v99, v99
  v_add_f32 v33, v33, v103
  v_fmac_f32 v37, v103, v103
  v_mfma_f32_16x16x32_bf16 v[124:127], v[220:223], v[92:95], v[124:127]
  v_add_f32 v34, v34, v107
  v_fmac_f32 v38, v107, v107
  v_add_f32 v35, v35, v111
  v_fmac_f32 v39, v111, v111
  s_add_u32 s46, s40, 0
  buffer_load_dwordx4 a[0:3], v4, s[8:11], s46 offen offset:0 sc1
  buffer_load_dwordx4 a[4:7], v4, s[8:11], s46 offen offset:1024 sc1
  s_add_u32 s47, s40, 24576
  buffer_load_dwordx4 a[8:11], v4, s[8:11], s47 offen offset:2048 sc1
  s_waitcnt lgkmcnt(2)
  v_mfma_f32_16x16x32_bf16 v[176:179], v[224:227], v[64:67], v[176:179]
  s_waitcnt vmcnt(9)
  ds_read2st64_b32 v[208:209], v5 offset0:24 offset1:25
  ds_read2st64_b32 v[210:211], v5 offset0:26 offset1:27
  ds_read2st64_b32 v[212:213], v5 offset0:28 offset1:29
  ds_read2st64_b32 v[214:215], v5 offset0:30 offset1:31
  v_mfma_f32_16x16x32_bf16 v[180:183], v[224:227], v[72:75], v[180:183]
  v_add_f32 v32, v32, v112
  v_fmac_f32 v36, v112, v112
  v_add_f32 v33, v33, v116
  v_fmac_f32 v37, v116, v116
  v_mfma_f32_16x16x32_bf16 v[184:187], v[224:227], v[80:83], v[184:187]
  v_add_f32 v34, v34, v120
  v_fmac_f32 v38, v120, v120
  v_add_f32 v35, v35, v124
  v_fmac_f32 v39, v124, v124
  v_mfma_f32_16x16x32_bf16 v[188:191], v[224:227], v[88:91], v[188:191]
  v_add_f32 v32, v32, v113
  v_fmac_f32 v36, v113, v113
  v_add_f32 v33, v33, v117
  v_fmac_f32 v37, v117, v117
  s_waitcnt lgkmcnt(4)
  v_mfma_f32_16x16x32_bf16 v[176:179], v[228:231], v[68:71], v[176:179]
  v_add_f32 v34, v34, v121
  v_fmac_f32 v38, v121, v121
  v_add_f32 v35, v35, v125
  v_fmac_f32 v39, v125, v125
  v_mfma_f32_16x16x32_bf16 v[180:183], v[228:231], v[76:79], v[180:183]
  v_add_f32 v32, v32, v114
  v_fmac_f32 v36, v114, v114
  v_add_f32 v33, v33, v118
  v_fmac_f32 v37, v118, v118
  v_mfma_f32_16x16x32_bf16 v[184:187], v[228:231], v[84:87], v[184:187]
  v_add_f32 v34, v34, v122
  v_fmac_f32 v38, v122, v122
  v_add_f32 v35, v35, v126
  v_fmac_f32 v39, v126, v126
  v_mfma_f32_16x16x32_bf16 v[188:191], v[228:231], v[92:95], v[188:191]
  v_add_f32 v32, v32, v115
  v_fmac_f32 v36, v115, v115
  v_add_f32 v33, v33, v119
  v_fmac_f32 v37, v119, v119
  v_add_f32 v34, v34, v123
  v_fmac_f32 v38, v123, v123
  v_add_f32 v35, v35, v127
  v_fmac_f32 v39, v127, v127
  buffer_load_dwordx4 a[12:15], v4, s[8:11], s47 offen offset:3072 sc1
  buffer_load_dwordx4 a[16:19], v4, s[8:11], s46 offen offset:2048 sc1
  buffer_load_dwordx4 a[20:23], v4, s[8:11], s46 offen offset:3072 sc1
  s_waitcnt lgkmcnt(2)
  v_mfma_f32_16x16x32_bf16 v[128:131], v[208:211], v[64:67], v[128:131]
  s_waitcnt vmcnt(10)
  ds_read2st64_b32 v[216:217], v5 offset0:32 offset1:33
  ds_read2st64_b32 v[218:219], v5 offset0:34 offset1:35
  ds_read2st64_b32 v[220:221], v5 offset0:36 offset1:37
  ds_read2st64_b32 v[222:223], v5 offset0:38 offset1:39
  v_mfma_f32_16x16x32_bf16 v[132:135], v[208:211], v[72:75], v[132:135]
  v_add_f32 v32, v32, v176
  v_fmac_f32 v36, v176, v176
  v_add_f32 v33, v33, v180
  v_fmac_f32 v37, v180, v180
  v_mfma_f32_16x16x32_bf16 v[136:139], v[208:211], v[80:83], v[136:139]
  v_add_f32 v34, v34, v184
  v_fmac_f32 v38, v184, v184
  v_add_f32 v35, v35, v188
  v_fmac_f32 v39, v188, v188
  v_mfma_f32_16x16x32_bf16 v[140:143], v[208:211], v[88:91], v[140:143]
  v_add_f32 v32, v32, v177
  v_fmac_f32 v36, v177, v177
  v_add_f32 v33, v33, v181
  v_fmac_f32 v37, v181, v181
  s_waitcnt lgkmcnt(4)
  v_mfma_f32_16x16x32_bf16 v[128:131], v[212:215], v[68:71], v[128:131]
  v_add_f32 v34, v34, v185
  v_fmac_f32 v38, v185, v185
  v_add_f32 v35, v35, v189
  v_fmac_f32 v39, v189, v189
  v_mfma_f32_16x16x32_bf16 v[132:135], v[212:215], v[76:79], v[132:135]
  v_add_f32 v32, v32, v178
  v_fmac_f32 v36, v178, v178
  v_add_f32 v33, v33, v182
  v_fmac_f32 v37, v182, v182
  v_mfma_f32_16x16x32_bf16 v[136:139], v[212:215], v[84:87], v[136:139]
  v_add_f32 v34, v34, v186
  v_fmac_f32 v38, v186, v186
  v_add_f32 v35, v35, v190
  v_fmac_f32 v39, v190, v190
  v_mfma_f32_16x16x32_bf16 v[140:143], v[212:215], v[92:95], v[140:143]
  v_add_f32 v32, v32, v179
  v_fmac_f32 v36, v179, v179
  v_add_f32 v33, v33, v183
  v_fmac_f32 v37, v183, v183
  v_add_f32 v34, v34, v187
  v_fmac_f32 v38, v187, v187
  v_add_f32 v35, v35, v191
  v_fmac_f32 v39, v191, v191
  buffer_load_dwordx4 a[24:27], v4, s[8:11], s47 offen offset:0 sc1
  buffer_load_dwordx4 a[28:31], v4, s[8:11], s47 offen offset:1024 sc1
  s_add_u32 s48, s40, 4096
  buffer_load_dwordx4 a[32:35], v4, s[8:11], s48 offen offset:0 sc1
  s_waitcnt lgkmcnt(2)
  v_mfma_f32_16x16x32_bf16 v[192:195], v[216:219], v[64:67], v[192:195]
  s_waitcnt vmcnt(11)
  ds_read2st64_b32 v[224:225], v5 offset0:40 offset1:41
  ds_read2st64_b32 v[226:227], v5 offset0:42 offset1:43
  ds_read2st64_b32 v[228:229], v5 offset0:44 offset1:45
  ds_read2st64_b32 v[230:231], v5 offset0:46 offset1:47
  v_mfma_f32_16x16x32_bf16 v[196:199], v[216:219], v[72:75], v[196:199]
  v_add_f32 v32, v32, v128
  v_fmac_f32 v36, v128, v128
  v_add_f32 v33, v33, v132
  v_fmac_f32 v37, v132, v132
  v_mfma_f32_16x16x32_bf16 v[200:203], v[216:219], v[80:83], v[200:203]
  v_add_f32 v34, v34, v136
  v_fmac_f32 v38, v136, v136
  v_add_f32 v35, v35, v140
  v_fmac_f32 v39, v140, v140
  v_mfma_f32_16x16x32_bf16 v[204:207], v[216:219], v[88:91], v[204:207]
  v_add_f32 v32, v32, v129
  v_fmac_f32 v36, v129, v129
  v_add_f32 v33, v33, v133
  v_fmac_f32 v37, v133, v133
  s_waitcnt lgkmcnt(4)
  v_mfma_f32_16x16x32_bf16 v[192:195], v[220:223], v[68:71], v[192:195]
  v_add_f32 v34, v34, v137
  v_fmac_f32 v38, v137, v137
  v_add_f32 v35, v35, v141
  v_fmac_f32 v39, v141, v141
  v_mfma_f32_16x16x32_bf16 v[196:199], v[220:223], v[76:79], v[196:199]
  v_add_f32 v32, v32, v130
  v_fmac_f32 v36, v130, v130
  v_add_f32 v33, v33, v134
  v_fmac_f32 v37, v134, v134
  v_mfma_f32_16x16x32_bf16 v[200:203], v[220:223], v[84:87], v[200:203]
  v_add_f32 v34, v34, v138
  v_fmac_f32 v38, v138, v138
  v_add_f32 v35, v35, v142
  v_fmac_f32 v39, v142, v142
  v_mfma_f32_16x16x32_bf16 v[204:207], v[220:223], v[92:95], v[204:207]
  v_add_f32 v32, v32, v131
  v_fmac_f32 v36, v131, v131
  v_add_f32 v33, v33, v135
  v_fmac_f32 v37, v135, v135
  v_add_f32 v34, v34, v139
  v_fmac_f32 v38, v139, v139
  v_add_f32 v35, v35, v143
  v_fmac_f32 v39, v143, v143
  buffer_load_dwordx4 a[36:39], v4, s[8:11], s48 offen offset:1024 sc1
  s_add_u32 s49, s40, 20480
  buffer_load_dwordx4 a[40:43], v4, s[8:11], s49 offen offset:2048 sc1
  buffer_load_dwordx4 a[44:47], v4, s[8:11], s49 offen offset:3072 sc1
  s_waitcnt lgkmcnt(2)
  v_mfma_f32_16x16x32_bf16 v[144:147], v[224:227], v[64:67], v[144:147]
  s_waitcnt vmcnt(12)
  ds_read2st64_b32 v[208:209], v5 offset0:48 offset1:49
  ds_read2st64_b32 v[210:211], v5 offset0:50 offset1:51
  ds_read2st64_b32 v[212:213], v5 offset0:52 offset1:53
  ds_read2st64_b32 v[214:215], v5 offset0:54 offset1:55
  v_mfma_f32_16x16x32_bf16 v[148:151], v[224:227], v[72:75], v[148:151]
  v_add_f32 v32, v32, v192
  v_fmac_f32 v36, v192, v192
  v_add_f32 v33, v33, v196
  v_fmac_f32 v37, v196, v196
  v_mfma_f32_16x16x32_bf16 v[152:155], v[224:227], v[80:83], v[152:155]
  v_add_f32 v34, v34, v200
  v_fmac_f32 v38, v200, v200
  v_add_f32 v35, v35, v204
  v_fmac_f32 v39, v204, v204
  v_mfma_f32_16x16x32_bf16 v[156:159], v[224:227], v[88:91], v[156:159]
  v_add_f32 v32, v32, v193
  v_fmac_f32 v36, v193, v193
  v_add_f32 v33, v33, v197
  v_fmac_f32 v37, v197, v197
  s_waitcnt lgkmcnt(4)
  v_mfma_f32_16x16x32_bf16 v[144:147], v[228:231], v[68:71], v[144:147]
  v_add_f32 v34, v34, v201
  v_fmac_f32 v38, v201, v201
  v_add_f32 v35, v35, v205
  v_fmac_f32 v39, v205, v205
  v_mfma_f32_16x16x32_bf16 v[148:151], v[228:231], v[76:79], v[148:151]
  v_add_f32 v32, v32, v194
  v_fmac_f32 v36, v194, v194
  v_add_f32 v33, v33, v198
  v_fmac_f32 v37, v198, v198
  v_mfma_f32_16x16x32_bf16 v[152:155], v[228:231], v[84:87], v[152:155]
  v_add_f32 v34, v34, v202
  v_fmac_f32 v38, v202, v202
  v_add_f32 v35, v35, v206
  v_fmac_f32 v39, v206, v206
  v_mfma_f32_16x16x32_bf16 v[156:159], v[228:231], v[92:95], v[156:159]
  v_add_f32 v32, v32, v195
  v_fmac_f32 v36, v195, v195
  v_add_f32 v33, v33, v199
  v_fmac_f32 v37, v199, v199
  v_add_f32 v34, v34, v203
  v_fmac_f32 v38, v203, v203
  v_add_f32 v35, v35, v207
  v_fmac_f32 v39, v207, v207
  buffer_load_dwordx4 a[48:51], v4, s[8:11], s48 offen offset:2048 sc1
  buffer_load_dwordx4 a[52:55], v4, s[8:11], s48 offen offset:3072 sc1
  buffer_load_dwordx4 a[56:59], v4, s[8:11], s49 offen offset:0 sc1
  s_waitcnt lgkmcnt(2)
  v_mfma_f32_16x16x32_bf16 v[160:163], v[208:211], v[64:67], v[160:163]
  v_add_f32 v32, v32, v144
  v_fmac_f32 v36, v144, v144
  v_add_f32 v33, v33, v148
  v_fmac_f32 v37, v148, v148
  v_mfma_f32_16x16x32_bf16 v[164:167], v[208:211], v[72:75], v[164:167]
  v_add_f32 v34, v34, v152
  v_fmac_f32 v38, v152, v152
  v_add_f32 v35, v35, v156
  v_fmac_f32 v39, v156, v156
  v_mfma_f32_16x16x32_bf16 v[168:171], v[208:211], v[80:83], v[168:171]
  v_add_f32 v32, v32, v145
  v_fmac_f32 v36, v145, v145
  v_add_f32 v33, v33, v149
  v_fmac_f32 v37, v149, v149
  v_mfma_f32_16x16x32_bf16 v[172:175], v[208:211], v[88:91], v[172:175]
  v_add_f32 v34, v34, v153
  v_fmac_f32 v38, v153, v153
  v_add_f32 v35, v35, v157
  v_fmac_f32 v39, v157, v157
  s_waitcnt lgkmcnt(0)
  v_mfma_f32_16x16x32_bf16 v[160:163], v[212:215], v[68:71], v[160:163]
  v_add_f32 v32, v32, v146
  v_fmac_f32 v36, v146, v146
  v_add_f32 v33, v33, v150
  v_fmac_f32 v37, v150, v150
  v_mfma_f32_16x16x32_bf16 v[164:167], v[212:215], v[76:79], v[164:167]
  v_add_f32 v34, v34, v154
  v_fmac_f32 v38, v154, v154
  v_add_f32 v35, v35, v158
  v_fmac_f32 v39, v158, v158
  v_mfma_f32_16x16x32_bf16 v[168:171], v[212:215], v[84:87], v[168:171]
  v_add_f32 v32, v32, v147
  v_fmac_f32 v36, v147, v147
  v_add_f32 v33, v33, v151
  v_fmac_f32 v37, v151, v151
  v_mfma_f32_16x16x32_bf16 v[172:175], v[212:215], v[92:95], v[172:175]
  v_add_f32 v34, v34, v155
  v_fmac_f32 v38, v155, v155
  v_add_f32 v35, v35, v159
  v_fmac_f32 v39, v159, v159
  buffer_load_dwordx4 a[60:63], v4, s[8:11], s49 offen offset:1024 sc1
  s_add_u32 s46, s40, 8192
  buffer_load_dwordx4 a[64:67], v4, s[8:11], s46 offen offset:0 sc1
  buffer_load_dwordx4 a[68:71], v4, s[8:11], s46 offen offset:1024 sc1
  v_cndmask_b32 v171, v171, v40, s[50:51]
  v_cndmask_b32 v175, v175, v41, s[50:51]
  v_add_f32 v32, v32, v160
  v_fmac_f32 v36, v160, v160
  v_add_f32 v33, v33, v164
  v_fmac_f32 v37, v164, v164
  v_add_f32 v34, v34, v168
  v_fmac_f32 v38, v168, v168
  v_add_f32 v35, v35, v172
  v_fmac_f32 v39, v172, v172
  v_add_f32 v32, v32, v161
  v_fmac_f32 v36, v161, v161
  v_add_f32 v33, v33, v165
  v_fmac_f32 v37, v165, v165
  v_add_f32 v34, v34, v169
  v_fmac_f32 v38, v169, v169
  v_add_f32 v35, v35, v173
  v_fmac_f32 v39, v173, v173
  v_add_f32 v32, v32, v162
  v_fmac_f32 v36, v162, v162
  v_add_f32 v33, v33, v166
  v_fmac_f32 v37, v166, v166
  v_add_f32 v34, v34, v170
  v_fmac_f32 v38, v170, v170
  v_add_f32 v35, v35, v174
  v_fmac_f32 v39, v174, v174
  v_add_f32 v32, v32, v163
  v_fmac_f32 v36, v163, v163
  v_add_f32 v33, v33, v167
  v_fmac_f32 v37, v167, v167
  v_add_f32 v34, v34, v171
  v_fmac_f32 v38, v171, v171
  v_add_f32 v35, v35, v175
  v_fmac_f32 v39, v175, v175
  v_permlane32_swap_b32 v32, v34
  v_permlane32_swap_b32 v33, v35
  v_permlane32_swap_b32 v36, v38
  v_permlane32_swap_b32 v37, v39
  v_add_f32 v32, v32, v34
  v_add_f32 v33, v33, v35
  v_add_f32 v36, v36, v38
  v_add_f32 v37, v37, v39
  v_permlane16_swap_b32 v32, v33
  s_nop 0
  v_permlane16_swap_b32 v36, v37
  v_add_f32 v40, v32, v33
  v_add_f32 v41, v36, v37
  ds_write_b64 v14, v[40:41]
  s_mov_b32 s35, 0x3b124925
  v_mov_b32 v28, 0x3727c5ac
  s_add_u32 s47, s40, 16384
  buffer_load_dwordx4 a[72:75], v4, s[8:11], s47 offen offset:2048 sc1
  buffer_load_dwordx4 a[76:79], v4, s[8:11], s47 offen offset:3072 sc1
  buffer_load_dwordx4 a[80:83], v4, s[8:11], s46 offen offset:2048 sc1
  s_waitcnt lgkmcnt(0)
  s_barrier
  ds_read_b128 v[44:47], v15
  ds_read_b128 v[48:51], v15 offset:16
  buffer_load_dwordx4 a[84:87], v4, s[8:11], s46 offen offset:3072 sc1
  buffer_load_dwordx4 a[88:91], v4, s[8:11], s47 offen offset:0 sc1
  buffer_load_dwordx4 a[92:95], v4, s[8:11], s47 offen offset:1024 sc1
  s_waitcnt lgkmcnt(1)
  v_pk_add_f32 v[44:45], v[44:45], v[46:47]
  s_waitcnt lgkmcnt(0)
  v_pk_add_f32 v[48:49], v[48:49], v[50:51]
  v_pk_add_f32 v[44:45], v[44:45], v[48:49]
  v_mul_f32 v44, s35, v44
  v_fma_f32 v45, v45, s35, v28
  v_fma_f32 v45, -v44, v44, v45
  v_rsq_f32 v46, v45
  v_mul_f32 v45, 0xbf317218, v45
  v_mul_f32 v64, 0xbfb8aa3b, v46
  v_mul_f32 v65, -v44, v64
  v_mul_f32 v66, 0xbfb8aa3b, v46
  v_mul_f32 v67, -v44, v64
  v_mul_f32 v45, v45, v46
  v_permlane16_swap_b32 v64, v66
  v_permlane16_swap_b32 v65, v67
  ds_write_b64 v16, v[44:45]
  v_mov_b32 v68, v64
  v_mov_b32 v69, v65
  v_mov_b32 v70, v66
  v_mov_b32 v71, v67
  v_permlane32_swap_b32 v64, v68
  v_permlane32_swap_b32 v65, v69
  v_permlane32_swap_b32 v66, v70
  v_permlane32_swap_b32 v67, v71
  v_pk_fma_f32 v[96:97], v[96:97], v[64:65], v[64:65] op_sel:[0,0,1] op_sel_hi:[1,0,1]
  v_pk_fma_f32 v[98:99], v[98:99], v[64:65], v[64:65] op_sel:[0,0,1] op_sel_hi:[1,0,1]
  v_pk_fma_f32 v[100:101], v[100:101], v[66:67], v[66:67] op_sel:[0,0,1] op_sel_hi:[1,0,1]
  v_pk_fma_f32 v[102:103], v[102:103], v[66:67], v[66:67] op_sel:[0,0,1] op_sel_hi:[1,0,1]
  v_pk_fma_f32 v[104:105], v[104:105], v[68:69], v[68:69] op_sel:[0,0,1] op_sel_hi:[1,0,1]
  v_pk_fma_f32 v[106:107], v[106:107], v[68:69], v[68:69] op_sel:[0,0,1] op_sel_hi:[1,0,1]
  v_pk_fma_f32 v[108:109], v[108:109], v[70:71], v[70:71] op_sel:[0,0,1] op_sel_hi:[1,0,1]
  v_pk_fma_f32 v[110:111], v[110:111], v[70:71], v[70:71] op_sel:[0,0,1] op_sel_hi:[1,0,1]
  v_cvt_pk_bf16_f32 v96, v96, v97
  v_cvt_pk_bf16_f32 v97, v98, v99
  ds_write_b64 v6, v[96:97] offset:0
  v_cvt_pk_bf16_f32 v100, v100, v101
  v_cvt_pk_bf16_f32 v101, v102, v103
  ds_write_b64 v6, v[100:101] offset:14336
  v_cvt_pk_bf16_f32 v105, v105, v104
  v_cvt_pk_bf16_f32 v104, v107, v106
  ds_write_b64 v7, v[104:105] offset:6144
  v_cvt_pk_bf16_f32 v109, v109, v108
  v_cvt_pk_bf16_f32 v108, v111, v110
  ds_write_b64 v7, v[108:109] offset:20480
  s_add_u32 s48, s40, 12288
  buffer_load_dwordx4 a[96:99], v4, s[8:11], s48 offen offset:0 sc1
  buffer_load_dwordx4 a[100:103], v4, s[8:11], s48 offen offset:1024 sc1
  buffer_load_dwordx4 a[104:107], v4, s[8:11], s48 offen offset:2048 sc1
  v_pk_fma_f32 v[112:113], v[112:113], v[64:65], v[64:65] op_sel:[0,0,1] op_sel_hi:[1,0,1]
  v_pk_fma_f32 v[114:115], v[114:115], v[64:65], v[64:65] op_sel:[0,0,1] op_sel_hi:[1,0,1]
  v_pk_fma_f32 v[116:117], v[116:117], v[66:67], v[66:67] op_sel:[0,0,1] op_sel_hi:[1,0,1]
  v_pk_fma_f32 v[118:119], v[118:119], v[66:67], v[66:67] op_sel:[0,0,1] op_sel_hi:[1,0,1]
  v_pk_fma_f32 v[120:121], v[120:121], v[68:69], v[68:69] op_sel:[0,0,1] op_sel_hi:[1,0,1]
  v_pk_fma_f32 v[122:123], v[122:123], v[68:69], v[68:69] op_sel:[0,0,1] op_sel_hi:[1,0,1]
  v_pk_fma_f32 v[124:125], v[124:125], v[70:71], v[70:71] op_sel:[0,0,1] op_sel_hi:[1,0,1]
  v_pk_fma_f32 v[126:127], v[126:127], v[70:71], v[70:71] op_sel:[0,0,1] op_sel_hi:[1,0,1]
  v_cvt_pk_bf16_f32 v112, v112, v113
  v_cvt_pk_bf16_f32 v113, v114, v115
  ds_write_b64 v6, v[112:113] offset:1024
  v_cvt_pk_bf16_f32 v116, v116, v117
  v_cvt_pk_bf16_f32 v117, v118, v119
  ds_write_b64 v6, v[116:117] offset:15360
  v_cvt_pk_bf16_f32 v121, v121, v120
  v_cvt_pk_bf16_f32 v120, v123, v122
  ds_write_b64 v7, v[120:121] offset:5120
  v_cvt_pk_bf16_f32 v125, v125, v124
  v_cvt_pk_bf16_f32 v124, v127, v126
  ds_write_b64 v7, v[124:125] offset:19456
  buffer_load_dwordx4 a[108:111], v4, s[8:11], s48 offen offset:3072 sc1
  s_add_u32 s49, s21, 0
  buffer_load_dwordx4 a[112:115], v4, s[8:11], s49 offen offset:0 sc1
  buffer_load_dwordx4 a[116:119], v4, s[8:11], s49 offen offset:1024 sc1
  v_pk_fma_f32 v[176:177], v[176:177], v[64:65], v[64:65] op_sel:[0,0,1] op_sel_hi:[1,0,1]
  v_pk_fma_f32 v[178:179], v[178:179], v[64:65], v[64:65] op_sel:[0,0,1] op_sel_hi:[1,0,1]
  v_pk_fma_f32 v[180:181], v[180:181], v[66:67], v[66:67] op_sel:[0,0,1] op_sel_hi:[1,0,1]
  v_pk_fma_f32 v[182:183], v[182:183], v[66:67], v[66:67] op_sel:[0,0,1] op_sel_hi:[1,0,1]
  v_pk_fma_f32 v[184:185], v[184:185], v[68:69], v[68:69] op_sel:[0,0,1] op_sel_hi:[1,0,1]
  v_pk_fma_f32 v[186:187], v[186:187], v[68:69], v[68:69] op_sel:[0,0,1] op_sel_hi:[1,0,1]
  v_pk_fma_f32 v[188:189], v[188:189], v[70:71], v[70:71] op_sel:[0,0,1] op_sel_hi:[1,0,1]
  v_pk_fma_f32 v[190:191], v[190:191], v[70:71], v[70:71] op_sel:[0,0,1] op_sel_hi:[1,0,1]
  v_cvt_pk_bf16_f32 v176, v176, v177
  v_cvt_pk_bf16_f32 v177, v178, v179
  ds_write_b64 v6, v[176:177] offset:2048
  v_cvt_pk_bf16_f32 v180, v180, v181
  v_cvt_pk_bf16_f32 v181, v182, v183
  ds_write_b64 v6, v[180:181] offset:16384
  v_cvt_pk_bf16_f32 v185, v185, v184
  v_cvt_pk_bf16_f32 v184, v187, v186
  ds_write_b64 v7, v[184:185] offset:4096
  v_cvt_pk_bf16_f32 v189, v189, v188
  v_cvt_pk_bf16_f32 v188, v191, v190
  ds_write_b64 v7, v[188:189] offset:18432
  s_add_u32 s46, s21, 24576
  buffer_load_dwordx4 a[120:123], v4, s[8:11], s46 offen offset:2048 sc1
  buffer_load_dwordx4 a[124:127], v4, s[8:11], s46 offen offset:3072 sc1
  buffer_load_dwordx4 a[128:131], v4, s[8:11], s49 offen offset:2048 sc1
  v_pk_fma_f32 v[128:129], v[128:129], v[64:65], v[64:65] op_sel:[0,0,1] op_sel_hi:[1,0,1]
  v_pk_fma_f32 v[130:131], v[130:131], v[64:65], v[64:65] op_sel:[0,0,1] op_sel_hi:[1,0,1]
  v_pk_fma_f32 v[132:133], v[132:133], v[66:67], v[66:67] op_sel:[0,0,1] op_sel_hi:[1,0,1]
  v_pk_fma_f32 v[134:135], v[134:135], v[66:67], v[66:67] op_sel:[0,0,1] op_sel_hi:[1,0,1]
  v_pk_fma_f32 v[136:137], v[136:137], v[68:69], v[68:69] op_sel:[0,0,1] op_sel_hi:[1,0,1]
  v_pk_fma_f32 v[138:139], v[138:139], v[68:69], v[68:69] op_sel:[0,0,1] op_sel_hi:[1,0,1]
  v_pk_fma_f32 v[140:141], v[140:141], v[70:71], v[70:71] op_sel:[0,0,1] op_sel_hi:[1,0,1]
  v_pk_fma_f32 v[142:143], v[142:143], v[70:71], v[70:71] op_sel:[0,0,1] op_sel_hi:[1,0,1]
  v_cvt_pk_bf16_f32 v128, v128, v129
  v_cvt_pk_bf16_f32 v129, v130, v131
  ds_write_b64 v6, v[128:129] offset:3072
  v_cvt_pk_bf16_f32 v132, v132, v133
  v_cvt_pk_bf16_f32 v133, v134, v135
  ds_write_b64 v6, v[132:133] offset:17408
  v_cvt_pk_bf16_f32 v137, v137, v136
  v_cvt_pk_bf16_f32 v136, v139, v138
  ds_write_b64 v7, v[136:137] offset:3072
  v_cvt_pk_bf16_f32 v141, v141, v140
  v_cvt_pk_bf16_f32 v140, v143, v142
  ds_write_b64 v7, v[140:141] offset:17408
  buffer_load_dwordx4 a[132:135], v4, s[8:11], s49 offen offset:3072 sc1
  buffer_load_dwordx4 a[136:139], v4, s[8:11], s46 offen offset:0 sc1
  buffer_load_dwordx4 a[140:143], v4, s[8:11], s46 offen offset:1024 sc1
  v_pk_fma_f32 v[192:193], v[192:193], v[64:65], v[64:65] op_sel:[0,0,1] op_sel_hi:[1,0,1]
  v_pk_fma_f32 v[194:195], v[194:195], v[64:65], v[64:65] op_sel:[0,0,1] op_sel_hi:[1,0,1]
  v_pk_fma_f32 v[196:197], v[196:197], v[66:67], v[66:67] op_sel:[0,0,1] op_sel_hi:[1,0,1]
  v_pk_fma_f32 v[198:199], v[198:199], v[66:67], v[66:67] op_sel:[0,0,1] op_sel_hi:[1,0,1]
  v_pk_fma_f32 v[200:201], v[200:201], v[68:69], v[68:69] op_sel:[0,0,1] op_sel_hi:[1,0,1]
  v_pk_fma_f32 v[202:203], v[202:203], v[68:69], v[68:69] op_sel:[0,0,1] op_sel_hi:[1,0,1]
  v_pk_fma_f32 v[204:205], v[204:205], v[70:71], v[70:71] op_sel:[0,0,1] op_sel_hi:[1,0,1]
  v_pk_fma_f32 v[206:207], v[206:207], v[70:71], v[70:71] op_sel:[0,0,1] op_sel_hi:[1,0,1]
  v_cvt_pk_bf16_f32 v192, v192, v193
  v_cvt_pk_bf16_f32 v193, v194, v195
  ds_write_b64 v6, v[192:193] offset:4096
  v_cvt_pk_bf16_f32 v196, v196, v197
  v_cvt_pk_bf16_f32 v197, v198, v199
  ds_write_b64 v6, v[196:197] offset:18432
  v_cvt_pk_bf16_f32 v201, v201, v200
  v_cvt_pk_bf16_f32 v200, v203, v202
  ds_write_b64 v7, v[200:201] offset:2048
  v_cvt_pk_bf16_f32 v205, v205, v204
  v_cvt_pk_bf16_f32 v204, v207, v206
  ds_write_b64 v7, v[204:205] offset:16384
  s_add_u32 s47, s21, 4096
  buffer_load_dwordx4 a[144:147], v4, s[8:11], s47 offen offset:0 sc1
  buffer_load_dwordx4 a[148:151], v4, s[8:11], s47 offen offset:1024 sc1
  s_add_u32 s48, s21, 20480
  buffer_load_dwordx4 a[152:155], v4, s[8:11], s48 offen offset:2048 sc1
  v_pk_fma_f32 v[144:145], v[144:145], v[64:65], v[64:65] op_sel:[0,0,1] op_sel_hi:[1,0,1]
  v_pk_fma_f32 v[146:147], v[146:147], v[64:65], v[64:65] op_sel:[0,0,1] op_sel_hi:[1,0,1]
  v_pk_fma_f32 v[148:149], v[148:149], v[66:67], v[66:67] op_sel:[0,0,1] op_sel_hi:[1,0,1]
  v_pk_fma_f32 v[150:151], v[150:151], v[66:67], v[66:67] op_sel:[0,0,1] op_sel_hi:[1,0,1]
  v_pk_fma_f32 v[152:153], v[152:153], v[68:69], v[68:69] op_sel:[0,0,1] op_sel_hi:[1,0,1]
  v_pk_fma_f32 v[154:155], v[154:155], v[68:69], v[68:69] op_sel:[0,0,1] op_sel_hi:[1,0,1]
  v_pk_fma_f32 v[156:157], v[156:157], v[70:71], v[70:71] op_sel:[0,0,1] op_sel_hi:[1,0,1]
  v_pk_fma_f32 v[158:159], v[158:159], v[70:71], v[70:71] op_sel:[0,0,1] op_sel_hi:[1,0,1]
  v_cvt_pk_bf16_f32 v144, v144, v145
  v_cvt_pk_bf16_f32 v145, v146, v147
  ds_write_b64 v6, v[144:145] offset:5120
  v_cvt_pk_bf16_f32 v148, v148, v149
  v_cvt_pk_bf16_f32 v149, v150, v151
  ds_write_b64 v6, v[148:149] offset:19456
  v_cvt_pk_bf16_f32 v153, v153, v152
  v_cvt_pk_bf16_f32 v152, v155, v154
  ds_write_b64 v7, v[152:153] offset:1024
  v_cvt_pk_bf16_f32 v157, v157, v156
  v_cvt_pk_bf16_f32 v156, v159, v158
  ds_write_b64 v7, v[156:157] offset:15360
  buffer_load_dwordx4 a[156:159], v4, s[8:11], s48 offen offset:3072 sc1
  buffer_load_dwordx4 a[160:163], v4, s[8:11], s47 offen offset:2048 sc1
  buffer_load_dwordx4 a[164:167], v4, s[8:11], s47 offen offset:3072 sc1
  v_pk_fma_f32 v[160:161], v[160:161], v[64:65], v[64:65] op_sel:[0,0,1] op_sel_hi:[1,0,1]
  v_pk_fma_f32 v[162:163], v[162:163], v[64:65], v[64:65] op_sel:[0,0,1] op_sel_hi:[1,0,1]
  v_pk_fma_f32 v[164:165], v[164:165], v[66:67], v[66:67] op_sel:[0,0,1] op_sel_hi:[1,0,1]
  v_pk_fma_f32 v[166:167], v[166:167], v[66:67], v[66:67] op_sel:[0,0,1] op_sel_hi:[1,0,1]
  v_pk_fma_f32 v[168:169], v[168:169], v[68:69], v[68:69] op_sel:[0,0,1] op_sel_hi:[1,0,1]
  v_pk_fma_f32 v[170:171], v[170:171], v[68:69], v[68:69] op_sel:[0,0,1] op_sel_hi:[1,0,1]
  v_pk_fma_f32 v[172:173], v[172:173], v[70:71], v[70:71] op_sel:[0,0,1] op_sel_hi:[1,0,1]
  v_pk_fma_f32 v[174:175], v[174:175], v[70:71], v[70:71] op_sel:[0,0,1] op_sel_hi:[1,0,1]
  v_cvt_pk_bf16_f32 v160, v160, v161
  v_cvt_pk_bf16_f32 v161, v162, v163
  ds_write_b64 v6, v[160:161] offset:6144
  v_cvt_pk_bf16_f32 v164, v164, v165
  v_cvt_pk_bf16_f32 v165, v166, v167
  ds_write_b64 v6, v[164:165] offset:20480
  v_cvt_pk_bf16_f32 v169, v169, v168
  v_cvt_pk_bf16_f32 v168, v171, v170
  ds_write_b64 v7, v[168:169] offset:0
  v_cvt_pk_bf16_f32 v173, v173, v172
  v_cvt_pk_bf16_f32 v172, v175, v174
  ds_write_b64 v7, v[172:173] offset:14336
  buffer_load_dwordx4 a[168:171], v4, s[8:11], s48 offen offset:0 sc1
  buffer_load_dwordx4 a[172:175], v4, s[8:11], s48 offen offset:1024 sc1
  s_waitcnt lgkmcnt(0)
  s_barrier
  ds_read_b128 v[208:211], v8 offset:0
  ds_read_b128 v[212:215], v8 offset:14336
  ds_read_b128 v[216:219], v9 offset:0
  ds_read_b128 v[220:223], v9 offset:14336
  ds_read_b128 v[224:227], v8 offset:13312
  ds_read_b128 v[228:231], v8 offset:27648
  ds_read_b128 v[232:235], v9 offset:13312
  ds_read_b128 v[236:239], v9 offset:27648
  s_waitcnt vmcnt(43) lgkmcnt(7)
  v_mfma_f32_16x16x32_bf16 v[32:35], a[0:3], v[208:211], 0
  s_waitcnt lgkmcnt(4)
  ds_read_b128 v[240:243], v8 offset:1024
  ds_read_b128 v[244:247], v8 offset:15360
  v_mfma_f32_16x16x32_bf16 v[36:39], a[0:3], v[212:215], 0
  s_add_u32 s46, s21, 8192
  v_mfma_f32_16x16x32_bf16 v[40:43], a[0:3], v[216:219], 0
  buffer_load_dwordx4 a[176:179], v4, s[8:11], s46 offen offset:0 sc1
  v_mfma_f32_16x16x32_bf16 v[44:47], a[0:3], v[220:223], 0
  s_waitcnt vmcnt(43)
  ds_read_b128 v[248:251], v9 offset:1024
  ds_read_b128 v[252:255], v9 offset:15360
  v_mfma_f32_16x16x32_bf16 v[48:51], a[4:7], v[208:211], 0
  s_mov_b32 s34, 0xb00000
  v_mfma_f32_16x16x32_bf16 v[52:55], a[4:7], v[212:215], 0
  buffer_store_dword v4, v22, s[8:11], s34 offen sc1
  v_mfma_f32_16x16x32_bf16 v[56:59], a[4:7], v[216:219], 0
  s_waitcnt vmcnt(42) lgkmcnt(6)
  ds_read_b128 v[96:99], v8 offset:12288
  ds_read_b128 v[100:103], v8 offset:26624
  v_mfma_f32_16x16x32_bf16 v[60:63], a[4:7], v[220:223], 0
  buffer_load_dwordx4 a[180:183], v4, s[8:11], s46 offen offset:1024 sc1
  v_mfma_f32_16x16x32_bf16 v[32:35], a[8:11], v[224:227], v[32:35]
  s_add_u32 s47, s21, 16384
  v_mfma_f32_16x16x32_bf16 v[36:39], a[8:11], v[228:231], v[36:39]
  s_waitcnt lgkmcnt(6)
  ds_read_b128 v[104:107], v9 offset:12288
  ds_read_b128 v[108:111], v9 offset:26624
  v_mfma_f32_16x16x32_bf16 v[40:43], a[8:11], v[232:235], v[40:43]
  buffer_load_dwordx4 a[184:187], v4, s[8:11], s47 offen offset:2048 sc1
  v_mfma_f32_16x16x32_bf16 v[44:47], a[8:11], v[236:239], v[44:47]
  s_waitcnt vmcnt(43)
  v_mfma_f32_16x16x32_bf16 v[48:51], a[12:15], v[224:227], v[48:51]
  ds_read_b128 v[112:115], v8 offset:2048
  ds_read_b128 v[116:119], v8 offset:16384
  v_mfma_f32_16x16x32_bf16 v[52:55], a[12:15], v[228:231], v[52:55]
  buffer_load_dwordx4 a[188:191], v4, s[8:11], s47 offen offset:3072 sc1
  v_mfma_f32_16x16x32_bf16 v[56:59], a[12:15], v[232:235], v[56:59]
  v_mfma_f32_16x16x32_bf16 v[60:63], a[12:15], v[236:239], v[60:63]
  s_waitcnt vmcnt(43) lgkmcnt(8)
  ds_read_b128 v[120:123], v9 offset:2048
  ds_read_b128 v[124:127], v9 offset:16384
  v_mfma_f32_16x16x32_bf16 v[32:35], a[16:19], v[240:243], v[32:35]
  buffer_load_dwordx4 a[0:3], v4, s[8:11], s46 offen offset:2048 sc1
  v_mfma_f32_16x16x32_bf16 v[36:39], a[16:19], v[244:247], v[36:39]
  s_waitcnt lgkmcnt(9)
  v_mfma_f32_16x16x32_bf16 v[40:43], a[16:19], v[248:251], v[40:43]
  s_waitcnt lgkmcnt(8)
  ds_read_b128 a[192:195], v8 offset:11264
  ds_read_b128 a[196:199], v8 offset:25600
  v_mfma_f32_16x16x32_bf16 v[44:47], a[16:19], v[252:255], v[44:47]
  s_waitcnt vmcnt(43)
  v_mfma_f32_16x16x32_bf16 v[48:51], a[20:23], v[240:243], v[48:51]
  buffer_load_dwordx4 a[4:7], v4, s[8:11], s46 offen offset:3072 sc1
  v_mfma_f32_16x16x32_bf16 v[52:55], a[20:23], v[244:247], v[52:55]
  ds_read_b128 a[200:203], v9 offset:11264
  ds_read_b128 a[204:207], v9 offset:25600
  v_mfma_f32_16x16x32_bf16 v[56:59], a[20:23], v[248:251], v[56:59]
  s_waitcnt vmcnt(43) lgkmcnt(11)
  v_mfma_f32_16x16x32_bf16 v[60:63], a[20:23], v[252:255], v[60:63]
  buffer_load_dwordx4 a[8:11], v4, s[8:11], s47 offen offset:0 sc1
  v_mfma_f32_16x16x32_bf16 v[32:35], a[24:27], v[96:99], v[32:35]
  s_waitcnt lgkmcnt(10)
  ds_read_b128 v[128:131], v8 offset:3072
  ds_read_b128 v[132:135], v8 offset:17408
  v_mfma_f32_16x16x32_bf16 v[36:39], a[24:27], v[100:103], v[36:39]
  s_waitcnt lgkmcnt(11)
  v_mfma_f32_16x16x32_bf16 v[40:43], a[24:27], v[104:107], v[40:43]
  s_waitcnt lgkmcnt(10)
  v_mfma_f32_16x16x32_bf16 v[44:47], a[24:27], v[108:111], v[44:47]
  s_waitcnt vmcnt(43)
  ds_read_b128 v[136:139], v9 offset:3072
  ds_read_b128 v[140:143], v9 offset:17408
  v_mfma_f32_16x16x32_bf16 v[48:51], a[28:31], v[96:99], v[48:51]
  buffer_load_dwordx4 a[12:15], v4, s[8:11], s47 offen offset:1024 sc1
  v_mfma_f32_16x16x32_bf16 v[52:55], a[28:31], v[100:103], v[52:55]
  v_mfma_f32_16x16x32_bf16 v[56:59], a[28:31], v[104:107], v[56:59]
  s_waitcnt vmcnt(43) lgkmcnt(10)
  ds_read_b128 a[208:211], v8 offset:10240
  ds_read_b128 a[212:215], v8 offset:24576
  v_mfma_f32_16x16x32_bf16 v[60:63], a[28:31], v[108:111], v[60:63]
  s_add_u32 s48, s21, 12288
  v_mfma_f32_16x16x32_bf16 v[32:35], a[32:35], v[112:115], v[32:35]
  buffer_load_dwordx4 a[16:19], v4, s[8:11], s48 offen offset:0 sc1
  v_mfma_f32_16x16x32_bf16 v[36:39], a[32:35], v[116:119], v[36:39]
  s_waitcnt lgkmcnt(11)
  ds_read_b128 a[216:219], v9 offset:10240
  ds_read_b128 a[220:223], v9 offset:24576
  v_mfma_f32_16x16x32_bf16 v[40:43], a[32:35], v[120:123], v[40:43]
  s_waitcnt vmcnt(43) lgkmcnt(12)
  v_mfma_f32_16x16x32_bf16 v[44:47], a[32:35], v[124:127], v[44:47]
  buffer_load_dwordx4 a[20:23], v4, s[8:11], s48 offen offset:1024 sc1
  v_mfma_f32_16x16x32_bf16 v[48:51], a[36:39], v[112:115], v[48:51]
  ds_read_b128 a[224:227], v8 offset:4096
  ds_read_b128 a[228:231], v8 offset:18432
  v_mfma_f32_16x16x32_bf16 v[52:55], a[36:39], v[116:119], v[52:55]
  v_mfma_f32_16x16x32_bf16 v[56:59], a[36:39], v[120:123], v[56:59]
  v_mfma_f32_16x16x32_bf16 v[60:63], a[36:39], v[124:127], v[60:63]
  s_waitcnt vmcnt(43) lgkmcnt(13)
  ds_read_b128 a[232:235], v9 offset:4096
  ds_read_b128 a[236:239], v9 offset:18432
  v_mfma_f32_16x16x32_bf16 v[32:35], a[40:43], a[192:195], v[32:35]
  buffer_load_dwordx4 a[24:27], v4, s[8:11], s48 offen offset:2048 sc1
  v_mfma_f32_16x16x32_bf16 v[36:39], a[40:43], a[196:199], v[36:39]
  s_waitcnt lgkmcnt(13)
  v_mfma_f32_16x16x32_bf16 v[40:43], a[40:43], a[200:203], v[40:43]
  s_waitcnt vmcnt(43) lgkmcnt(12)
  ds_read_b128 a[240:243], v8 offset:9216
  ds_read_b128 a[244:247], v8 offset:23552
  v_mfma_f32_16x16x32_bf16 v[44:47], a[40:43], a[204:207], v[44:47]
  buffer_load_dwordx4 a[28:31], v4, s[8:11], s48 offen offset:3072 sc1
  v_mfma_f32_16x16x32_bf16 v[48:51], a[44:47], a[192:195], v[48:51]
  v_mfma_f32_16x16x32_bf16 v[52:55], a[44:47], a[196:199], v[52:55]
  s_waitcnt vmcnt(43) lgkmcnt(13)
  ds_read_b128 a[248:251], v9 offset:9216
  ds_read_b128 a[252:255], v9 offset:23552
  v_mfma_f32_16x16x32_bf16 v[56:59], a[44:47], a[200:203], v[56:59]
  s_add_u32 s49, s25, 0
  v_mfma_f32_16x16x32_bf16 v[60:63], a[44:47], a[204:207], v[60:63]
  buffer_load_dwordx4 a[32:35], v4, s[8:11], s49 offen offset:0 sc1
  v_mfma_f32_16x16x32_bf16 v[32:35], a[48:51], v[128:131], v[32:35]
  ds_read_b128 v[176:179], v8 offset:5120
  ds_read_b128 v[180:183], v8 offset:19456
  v_mfma_f32_16x16x32_bf16 v[36:39], a[48:51], v[132:135], v[36:39]
  s_waitcnt lgkmcnt(14)
  v_mfma_f32_16x16x32_bf16 v[40:43], a[48:51], v[136:139], v[40:43]
  buffer_load_dwordx4 a[36:39], v4, s[8:11], s49 offen offset:1024 sc1
  v_mfma_f32_16x16x32_bf16 v[44:47], a[48:51], v[140:143], v[44:47]
  s_waitcnt vmcnt(44)
  ds_read_b128 v[184:187], v9 offset:5120
  ds_read_b128 v[188:191], v9 offset:19456
  v_mfma_f32_16x16x32_bf16 v[48:51], a[52:55], v[128:131], v[48:51]
  v_mfma_f32_16x16x32_bf16 v[52:55], a[52:55], v[132:135], v[52:55]
  s_add_u32 s46, s25, 24576
  v_mfma_f32_16x16x32_bf16 v[56:59], a[52:55], v[136:139], v[56:59]
  s_waitcnt vmcnt(43) lgkmcnt(14)
  ds_read_b128 v[192:195], v8 offset:8192
  ds_read_b128 v[196:199], v8 offset:22528
  v_mfma_f32_16x16x32_bf16 v[60:63], a[52:55], v[140:143], v[60:63]
  buffer_load_dwordx4 a[40:43], v4, s[8:11], s46 offen offset:2048 sc1
  v_mfma_f32_16x16x32_bf16 v[32:35], a[56:59], a[208:211], v[32:35]
  v_mfma_f32_16x16x32_bf16 v[36:39], a[56:59], a[212:215], v[36:39]
  ds_read_b128 v[200:203], v9 offset:8192
  ds_read_b128 v[204:207], v9 offset:22528
  v_mfma_f32_16x16x32_bf16 v[40:43], a[56:59], a[216:219], v[40:43]
  buffer_load_dwordx4 a[44:47], v4, s[8:11], s46 offen offset:3072 sc1
  v_mfma_f32_16x16x32_bf16 v[44:47], a[56:59], a[220:223], v[44:47]
  s_waitcnt vmcnt(44)
  v_mfma_f32_16x16x32_bf16 v[48:51], a[60:63], a[208:211], v[48:51]
  ds_read_b128 v[144:147], v8 offset:6144
  ds_read_b128 v[148:151], v8 offset:20480
  v_mfma_f32_16x16x32_bf16 v[52:55], a[60:63], a[212:215], v[52:55]
  buffer_load_dwordx4 a[48:51], v4, s[8:11], s49 offen offset:2048 sc1
  v_mfma_f32_16x16x32_bf16 v[56:59], a[60:63], a[216:219], v[56:59]
  v_mfma_f32_16x16x32_bf16 v[60:63], a[60:63], a[220:223], v[60:63]
  s_waitcnt vmcnt(44) lgkmcnt(14)
  ds_read_b128 v[152:155], v9 offset:6144
  ds_read_b128 v[156:159], v9 offset:20480
  v_mfma_f32_16x16x32_bf16 v[32:35], a[64:67], a[224:227], v[32:35]
  v_mfma_f32_16x16x32_bf16 v[36:39], a[64:67], a[228:231], v[36:39]
  buffer_load_dwordx4 a[52:55], v4, s[8:11], s49 offen offset:3072 sc1
  v_mfma_f32_16x16x32_bf16 v[40:43], a[64:67], a[232:235], v[40:43]
  ds_read_b128 v[160:163], v8 offset:7168
  ds_read_b128 v[164:167], v8 offset:21504
  v_mfma_f32_16x16x32_bf16 v[44:47], a[64:67], a[236:239], v[44:47]
  s_waitcnt vmcnt(44)
  v_mfma_f32_16x16x32_bf16 v[48:51], a[68:71], a[224:227], v[48:51]
  v_mfma_f32_16x16x32_bf16 v[52:55], a[68:71], a[228:231], v[52:55]
  ds_read_b128 v[168:171], v9 offset:7168
  ds_read_b128 v[172:175], v9 offset:21504
  v_mfma_f32_16x16x32_bf16 v[56:59], a[68:71], a[232:235], v[56:59]
  buffer_load_dwordx4 a[56:59], v4, s[8:11], s46 offen offset:0 sc1
  v_mfma_f32_16x16x32_bf16 v[60:63], a[68:71], a[236:239], v[60:63]
  s_waitcnt vmcnt(44)
  v_mfma_f32_16x16x32_bf16 v[32:35], a[72:75], a[240:243], v[32:35]
  s_waitcnt lgkmcnt(14)
  v_mfma_f32_16x16x32_bf16 v[36:39], a[72:75], a[244:247], v[36:39]
  buffer_load_dwordx4 a[60:63], v4, s[8:11], s46 offen offset:1024 sc1
  v_mfma_f32_16x16x32_bf16 v[40:43], a[72:75], a[248:251], v[40:43]
  s_waitcnt vmcnt(44)
  v_mfma_f32_16x16x32_bf16 v[44:47], a[72:75], a[252:255], v[44:47]
  s_add_u32 s47, s25, 4096
  v_mfma_f32_16x16x32_bf16 v[48:51], a[76:79], a[240:243], v[48:51]
  buffer_load_dwordx4 a[64:67], v4, s[8:11], s47 offen offset:0 sc1
  v_mfma_f32_16x16x32_bf16 v[52:55], a[76:79], a[244:247], v[52:55]
  v_mfma_f32_16x16x32_bf16 v[56:59], a[76:79], a[248:251], v[56:59]
  v_mfma_f32_16x16x32_bf16 v[60:63], a[76:79], a[252:255], v[60:63]
  s_waitcnt vmcnt(44)
  v_mfma_f32_16x16x32_bf16 v[32:35], a[80:83], v[176:179], v[32:35]
  buffer_load_dwordx4 a[68:71], v4, s[8:11], s47 offen offset:1024 sc1
  v_mfma_f32_16x16x32_bf16 v[36:39], a[80:83], v[180:183], v[36:39]
  s_waitcnt lgkmcnt(13)
  v_mfma_f32_16x16x32_bf16 v[40:43], a[80:83], v[184:187], v[40:43]
  s_waitcnt vmcnt(44) lgkmcnt(12)
  v_mfma_f32_16x16x32_bf16 v[44:47], a[80:83], v[188:191], v[44:47]
  s_add_u32 s48, s25, 20480
  v_mfma_f32_16x16x32_bf16 v[48:51], a[84:87], v[176:179], v[48:51]
  buffer_load_dwordx4 a[72:75], v4, s[8:11], s48 offen offset:2048 sc1
  v_mfma_f32_16x16x32_bf16 v[52:55], a[84:87], v[180:183], v[52:55]
  v_mfma_f32_16x16x32_bf16 v[56:59], a[84:87], v[184:187], v[56:59]
  v_mfma_f32_16x16x32_bf16 v[60:63], a[84:87], v[188:191], v[60:63]
  s_waitcnt vmcnt(44) lgkmcnt(10)
  v_mfma_f32_16x16x32_bf16 v[32:35], a[88:91], v[192:195], v[32:35]
  buffer_load_dwordx4 a[76:79], v4, s[8:11], s48 offen offset:3072 sc1
  v_mfma_f32_16x16x32_bf16 v[36:39], a[88:91], v[196:199], v[36:39]
  s_waitcnt lgkmcnt(9)
  v_mfma_f32_16x16x32_bf16 v[40:43], a[88:91], v[200:203], v[40:43]
  s_waitcnt lgkmcnt(8)
  v_add_u32 v13, s62, v4
  v_add_u32 v13, 57344, v13
  v_mfma_f32_16x16x32_bf16 v[44:47], a[88:91], v[204:207], v[44:47]
  s_waitcnt vmcnt(44)
  v_mfma_f32_16x16x32_bf16 v[48:51], a[92:95], v[192:195], v[48:51]
  buffer_load_dwordx4 a[80:83], v4, s[8:11], s47 offen offset:2048 sc1
  v_mfma_f32_16x16x32_bf16 v[52:55], a[92:95], v[196:199], v[52:55]
  v_mfma_f32_16x16x32_bf16 v[56:59], a[92:95], v[200:203], v[56:59]
  s_waitcnt vmcnt(44) lgkmcnt(7)
  v_mfma_f32_16x16x32_bf16 v[60:63], a[92:95], v[204:207], v[60:63]
  buffer_load_dwordx4 a[84:87], v4, s[8:11], s47 offen offset:3072 sc1
  v_mfma_f32_16x16x32_bf16 v[32:35], a[96:99], v[144:147], v[32:35]
  s_waitcnt lgkmcnt(6)
  v_mfma_f32_16x16x32_bf16 v[36:39], a[96:99], v[148:151], v[36:39]
  s_waitcnt lgkmcnt(5)
  v_mfma_f32_16x16x32_bf16 v[40:43], a[96:99], v[152:155], v[40:43]
  s_waitcnt vmcnt(44) lgkmcnt(4)
  v_mfma_f32_16x16x32_bf16 v[44:47], a[96:99], v[156:159], v[44:47]
  buffer_load_dwordx4 a[88:91], v4, s[8:11], s48 offen offset:0 sc1
  v_mfma_f32_16x16x32_bf16 v[48:51], a[100:103], v[144:147], v[48:51]
  v_mfma_f32_16x16x32_bf16 v[52:55], a[100:103], v[148:151], v[52:55]
  v_mfma_f32_16x16x32_bf16 v[56:59], a[100:103], v[152:155], v[56:59]
  s_waitcnt vmcnt(44) lgkmcnt(3)
  v_mfma_f32_16x16x32_bf16 v[60:63], a[100:103], v[156:159], v[60:63]
  buffer_load_dwordx4 a[92:95], v4, s[8:11], s48 offen offset:1024 sc1
  v_mfma_f32_16x16x32_bf16 v[32:35], a[104:107], v[160:163], v[32:35]
  s_waitcnt lgkmcnt(2)
  v_mfma_f32_16x16x32_bf16 v[36:39], a[104:107], v[164:167], v[36:39]
  s_waitcnt vmcnt(44) lgkmcnt(0)
  v_mfma_f32_16x16x32_bf16 v[40:43], a[104:107], v[168:171], v[40:43]
  s_add_u32 s49, s25, 8192
  v_mfma_f32_16x16x32_bf16 v[44:47], a[104:107], v[172:175], v[44:47]
  buffer_load_dwordx4 a[96:99], v4, s[8:11], s49 offen offset:0 sc1
  v_mfma_f32_16x16x32_bf16 v[48:51], a[108:111], v[160:163], v[48:51]
  v_mfma_f32_16x16x32_bf16 v[52:55], a[108:111], v[164:167], v[52:55]
  v_mfma_f32_16x16x32_bf16 v[56:59], a[108:111], v[168:171], v[56:59]
  s_waitcnt vmcnt(44)
  v_mfma_f32_16x16x32_bf16 v[60:63], a[108:111], v[172:175], v[60:63]
  buffer_load_dwordx4 a[100:103], v4, s[8:11], s49 offen offset:1024 sc1
  v_mfma_f32_16x16x32_bf16 v[64:67], a[112:115], v[208:211], 0
  v_mfma_f32_16x16x32_bf16 v[68:71], a[112:115], v[212:215], 0
  s_add_u32 s46, s25, 16384
  v_mfma_f32_16x16x32_bf16 v[72:75], a[112:115], v[216:219], 0
  buffer_load_dwordx4 a[104:107], v4, s[8:11], s46 offen offset:2048 sc1
  v_mfma_f32_16x16x32_bf16 v[76:79], a[112:115], v[220:223], 0
  s_waitcnt vmcnt(45)
  v_exp_f32 v24, v32
  v_mfma_f32_16x16x32_bf16 v[80:83], a[116:119], v[208:211], 0
  v_exp_f32 v25, v33
  v_mfma_f32_16x16x32_bf16 v[84:87], a[116:119], v[212:215], 0
  v_exp_f32 v26, v34
  v_mfma_f32_16x16x32_bf16 v[88:91], a[116:119], v[216:219], 0
  buffer_load_dwordx4 a[108:111], v4, s[8:11], s46 offen offset:3072 sc1
  v_mfma_f32_16x16x32_bf16 v[92:95], a[116:119], v[220:223], 0
  s_waitcnt vmcnt(45)
  v_exp_f32 v27, v35
  v_mfma_f32_16x16x32_bf16 v[64:67], a[120:123], v[224:227], v[64:67]
  v_mul_f32 v32, v32, v48
  v_mul_f32 v33, v33, v49
  v_mfma_f32_16x16x32_bf16 v[68:71], a[120:123], v[228:231], v[68:71]
  v_mul_f32 v34, v34, v50
  v_mul_f32 v35, v35, v51
  v_mfma_f32_16x16x32_bf16 v[72:75], a[120:123], v[232:235], v[72:75]
  buffer_load_dwordx4 a[112:115], v4, s[8:11], s49 offen offset:2048 sc1
  v_mfma_f32_16x16x32_bf16 v[76:79], a[120:123], v[236:239], v[76:79]
  s_waitcnt vmcnt(45)
  v_fma_f32 v24, v24, s54, s54
  v_fma_f32 v25, v25, s54, s54
  v_mfma_f32_16x16x32_bf16 v[80:83], a[124:127], v[224:227], v[80:83]
  v_fma_f32 v26, v26, s54, s54
  v_fma_f32 v27, v27, s54, s54
  v_mfma_f32_16x16x32_bf16 v[84:87], a[124:127], v[228:231], v[84:87]
  v_rcp_f32 v24, v24
  v_mfma_f32_16x16x32_bf16 v[88:91], a[124:127], v[232:235], v[88:91]
  buffer_load_dwordx4 a[116:119], v4, s[8:11], s49 offen offset:3072 sc1
  v_mfma_f32_16x16x32_bf16 v[92:95], a[124:127], v[236:239], v[92:95]
  s_waitcnt vmcnt(45)
  v_rcp_f32 v25, v25
  v_mfma_f32_16x16x32_bf16 v[64:67], a[128:131], v[240:243], v[64:67]
  v_rcp_f32 v26, v26
  v_mfma_f32_16x16x32_bf16 v[68:71], a[128:131], v[244:247], v[68:71]
  v_rcp_f32 v27, v27
  v_mfma_f32_16x16x32_bf16 v[72:75], a[128:131], v[248:251], v[72:75]
  buffer_load_dwordx4 a[120:123], v4, s[8:11], s46 offen offset:0 sc1
  v_mfma_f32_16x16x32_bf16 v[76:79], a[128:131], v[252:255], v[76:79]
  s_waitcnt vmcnt(45)
  v_mul_f32 v24, v24, v32
  v_mul_f32 v25, v25, v33
  v_mfma_f32_16x16x32_bf16 v[80:83], a[132:135], v[240:243], v[80:83]
  v_mul_f32 v26, v26, v34
  v_mul_f32 v27, v27, v35
  v_mfma_f32_16x16x32_bf16 v[84:87], a[132:135], v[244:247], v[84:87]
  buffer_load_dwordx4 a[124:127], v4, s[8:11], s46 offen offset:1024 sc1
  v_mfma_f32_16x16x32_bf16 v[88:91], a[132:135], v[248:251], v[88:91]
  v_cvt_pk_bf16_f32 v32, v24, v25
  v_cvt_pk_bf16_f32 v33, v26, v27
  v_mfma_f32_16x16x32_bf16 v[92:95], a[132:135], v[252:255], v[92:95]
  s_waitcnt vmcnt(45)
  v_exp_f32 v28, v36
  v_mfma_f32_16x16x32_bf16 v[64:67], a[136:139], v[96:99], v[64:67]
  s_add_u32 s47, s25, 12288
  v_exp_f32 v29, v37
  v_mfma_f32_16x16x32_bf16 v[68:71], a[136:139], v[100:103], v[68:71]
  buffer_load_dwordx4 a[128:131], v4, s[8:11], s47 offen offset:0 sc1
  v_mfma_f32_16x16x32_bf16 v[72:75], a[136:139], v[104:107], v[72:75]
  v_exp_f32 v30, v38
  v_mfma_f32_16x16x32_bf16 v[76:79], a[136:139], v[108:111], v[76:79]
  s_waitcnt vmcnt(45)
  v_exp_f32 v31, v39
  v_mfma_f32_16x16x32_bf16 v[80:83], a[140:143], v[96:99], v[80:83]
  v_mul_f32 v36, v36, v52
  v_mul_f32 v37, v37, v53
  v_mfma_f32_16x16x32_bf16 v[84:87], a[140:143], v[100:103], v[84:87]
  buffer_load_dwordx4 a[132:135], v4, s[8:11], s47 offen offset:1024 sc1
  v_mfma_f32_16x16x32_bf16 v[88:91], a[140:143], v[104:107], v[88:91]
  v_mul_f32 v38, v38, v54
  v_mul_f32 v39, v39, v55
  v_mfma_f32_16x16x32_bf16 v[92:95], a[140:143], v[108:111], v[92:95]
  s_waitcnt vmcnt(45)
  v_fma_f32 v28, v28, s54, s54
  v_fma_f32 v29, v29, s54, s54
  v_mfma_f32_16x16x32_bf16 v[64:67], a[144:147], v[112:115], v[64:67]
  v_fma_f32 v30, v30, s54, s54
  v_fma_f32 v31, v31, s54, s54
  v_mfma_f32_16x16x32_bf16 v[68:71], a[144:147], v[116:119], v[68:71]
  buffer_load_dwordx4 a[136:139], v4, s[8:11], s47 offen offset:2048 sc1
  v_mfma_f32_16x16x32_bf16 v[72:75], a[144:147], v[120:123], v[72:75]
  v_rcp_f32 v28, v28
  v_mfma_f32_16x16x32_bf16 v[76:79], a[144:147], v[124:127], v[76:79]
  s_waitcnt vmcnt(45)
  v_rcp_f32 v29, v29
  v_mfma_f32_16x16x32_bf16 v[80:83], a[148:151], v[112:115], v[80:83]
  v_rcp_f32 v30, v30
  v_mfma_f32_16x16x32_bf16 v[84:87], a[148:151], v[116:119], v[84:87]
  buffer_load_dwordx4 a[140:143], v4, s[8:11], s47 offen offset:3072 sc1
  v_mfma_f32_16x16x32_bf16 v[88:91], a[148:151], v[120:123], v[88:91]
  v_rcp_f32 v31, v31
  v_mfma_f32_16x16x32_bf16 v[92:95], a[148:151], v[124:127], v[92:95]
  s_waitcnt vmcnt(45)
  v_mul_f32 v28, v28, v36
  v_mul_f32 v29, v29, v37
  v_mfma_f32_16x16x32_bf16 v[64:67], a[152:155], a[192:195], v[64:67]
  s_add_u32 s48, s38, 24576
  v_mul_f32 v30, v30, v38
  v_mul_f32 v31, v31, v39
  v_mfma_f32_16x16x32_bf16 v[68:71], a[152:155], a[196:199], v[68:71]
  buffer_load_dwordx4 a[144:147], v4, s[8:11], s48 offen offset:0 sc1
  v_mfma_f32_16x16x32_bf16 v[72:75], a[152:155], a[200:203], v[72:75]
  s_waitcnt vmcnt(45)
  v_cvt_pk_bf16_f32 v34, v28, v29
  v_cvt_pk_bf16_f32 v35, v30, v31
  v_mfma_f32_16x16x32_bf16 v[76:79], a[152:155], a[204:207], v[76:79]
  s_add_u32 s49, s38, 4096
  v_permlane32_swap_b32 v32, v34
  v_permlane32_swap_b32 v33, v35
  v_mfma_f32_16x16x32_bf16 v[80:83], a[156:159], a[192:195], v[80:83]
  buffer_load_dwordx4 a[148:151], v4, s[8:11], s49 offen offset:0 sc1
  v_mfma_f32_16x16x32_bf16 v[84:87], a[156:159], a[196:199], v[84:87]
  v_and_b32 v32, -2, v32
  v_mfma_f32_16x16x32_bf16 v[88:91], a[156:159], a[200:203], v[88:91]
  buffer_store_dwordx4 v[32:35], v10, s[8:11], s42 offen sc1
  v_mfma_f32_16x16x32_bf16 v[92:95], a[156:159], a[204:207], v[92:95]
  s_waitcnt vmcnt(46)
  v_exp_f32 v24, v40
  v_mfma_f32_16x16x32_bf16 v[64:67], a[160:163], v[128:131], v[64:67]
  buffer_load_dwordx4 a[152:155], v4, s[8:11], s49 offen offset:2048 sc1
  v_mfma_f32_16x16x32_bf16 v[68:71], a[160:163], v[132:135], v[68:71]
  v_exp_f32 v25, v41
  v_mfma_f32_16x16x32_bf16 v[72:75], a[160:163], v[136:139], v[72:75]
  s_waitcnt vmcnt(46)
  v_exp_f32 v26, v42
  v_mfma_f32_16x16x32_bf16 v[76:79], a[160:163], v[140:143], v[76:79]
  s_add_u32 s46, s38, 8192
  v_exp_f32 v27, v43
  v_mfma_f32_16x16x32_bf16 v[80:83], a[164:167], v[128:131], v[80:83]
  buffer_load_dwordx4 a[156:159], v4, s[8:11], s46 offen offset:2048 sc1
  v_mfma_f32_16x16x32_bf16 v[84:87], a[164:167], v[132:135], v[84:87]
  v_mul_f32 v40, v40, v56
  v_mul_f32 v41, v41, v57
  v_mfma_f32_16x16x32_bf16 v[88:91], a[164:167], v[136:139], v[88:91]
  v_mul_f32 v42, v42, v58
  v_mul_f32 v43, v43, v59
  v_mfma_f32_16x16x32_bf16 v[92:95], a[164:167], v[140:143], v[92:95]
  s_waitcnt vmcnt(46)
  v_fma_f32 v24, v24, s54, s54
  v_fma_f32 v25, v25, s54, s54
  v_mfma_f32_16x16x32_bf16 v[64:67], a[168:171], a[208:211], v[64:67]
  v_fma_f32 v26, v26, s54, s54
  v_fma_f32 v27, v27, s54, s54
  v_mfma_f32_16x16x32_bf16 v[68:71], a[168:171], a[212:215], v[68:71]
  v_rcp_f32 v24, v24
  v_mfma_f32_16x16x32_bf16 v[72:75], a[168:171], a[216:219], v[72:75]
  v_rcp_f32 v25, v25
  v_mfma_f32_16x16x32_bf16 v[76:79], a[168:171], a[220:223], v[76:79]
  s_waitcnt vmcnt(45)
  v_rcp_f32 v26, v26
  v_mfma_f32_16x16x32_bf16 v[80:83], a[172:175], a[208:211], v[80:83]
  v_rcp_f32 v27, v27
  v_mfma_f32_16x16x32_bf16 v[84:87], a[172:175], a[212:215], v[84:87]
  s_waitcnt vmcnt(44)
  v_mul_f32 v24, v24, v40
  v_mul_f32 v25, v25, v41
  v_mfma_f32_16x16x32_bf16 v[88:91], a[172:175], a[216:219], v[88:91]
  s_add_u32 s47, s38, 16384
  v_mul_f32 v26, v26, v42
  v_mul_f32 v27, v27, v43
  v_mfma_f32_16x16x32_bf16 v[92:95], a[172:175], a[220:223], v[92:95]
  buffer_load_dwordx4 a[172:175], v4, s[8:11], s47 offen offset:0 sc1
  v_mfma_f32_16x16x32_bf16 v[64:67], a[176:179], a[224:227], v[64:67]
  v_cvt_pk_bf16_f32 v40, v24, v25
  v_cvt_pk_bf16_f32 v41, v26, v27
  v_mfma_f32_16x16x32_bf16 v[68:71], a[176:179], a[228:231], v[68:71]
  s_waitcnt vmcnt(44)
  v_exp_f32 v28, v44
  v_mfma_f32_16x16x32_bf16 v[72:75], a[176:179], a[232:235], v[72:75]
  s_add_u32 s48, s38, 0
  v_exp_f32 v29, v45
  v_mfma_f32_16x16x32_bf16 v[76:79], a[176:179], a[236:239], v[76:79]
  buffer_load_dwordx4 a[176:179], v4, s[8:11], s48 offen offset:0 sc1
  v_mfma_f32_16x16x32_bf16 v[80:83], a[180:183], a[224:227], v[80:83]
  v_exp_f32 v30, v46
  v_mfma_f32_16x16x32_bf16 v[84:87], a[180:183], a[228:231], v[84:87]
  s_waitcnt vmcnt(44)
  v_exp_f32 v31, v47
  v_mfma_f32_16x16x32_bf16 v[88:91], a[180:183], a[232:235], v[88:91]
  s_add_u32 s49, s38, 24576
  v_mul_f32 v44, v44, v60
  v_mul_f32 v45, v45, v61
  v_mfma_f32_16x16x32_bf16 v[92:95], a[180:183], a[236:239], v[92:95]
  buffer_load_dwordx4 a[180:183], v4, s[8:11], s49 offen offset:2048 sc1
  v_mfma_f32_16x16x32_bf16 v[64:67], a[184:187], a[240:243], v[64:67]
  v_mul_f32 v46, v46, v62
  v_mul_f32 v47, v47, v63
  v_mfma_f32_16x16x32_bf16 v[68:71], a[184:187], a[244:247], v[68:71]
  v_fma_f32 v28, v28, s54, s54
  v_fma_f32 v29, v29, s54, s54
  v_mfma_f32_16x16x32_bf16 v[72:75], a[184:187], a[248:251], v[72:75]
  s_waitcnt vmcnt(44)
  v_fma_f32 v30, v30, s54, s54
  v_fma_f32 v31, v31, s54, s54
  v_mfma_f32_16x16x32_bf16 v[76:79], a[184:187], a[252:255], v[76:79]
  buffer_load_dwordx4 a[184:187], v4, s[8:11], s48 offen offset:2048 sc1
  v_mfma_f32_16x16x32_bf16 v[80:83], a[188:191], a[240:243], v[80:83]
  v_rcp_f32 v28, v28
  v_mfma_f32_16x16x32_bf16 v[84:87], a[188:191], a[244:247], v[84:87]
  s_waitcnt vmcnt(44)
  v_rcp_f32 v29, v29
  v_mfma_f32_16x16x32_bf16 v[88:91], a[188:191], a[248:251], v[88:91]
  s_add_u32 s46, s38, 20480
  v_rcp_f32 v30, v30
  v_mfma_f32_16x16x32_bf16 v[92:95], a[188:191], a[252:255], v[92:95]
  buffer_load_dwordx4 a[188:191], v4, s[8:11], s46 offen offset:2048 sc1
  v_mfma_f32_16x16x32_bf16 v[64:67], a[0:3], v[176:179], v[64:67]
  v_rcp_f32 v31, v31
  v_mfma_f32_16x16x32_bf16 v[68:71], a[0:3], v[180:183], v[68:71]
  v_mul_f32 v28, v28, v44
  v_mul_f32 v29, v29, v45
  v_mfma_f32_16x16x32_bf16 v[72:75], a[0:3], v[184:187], v[72:75]
  s_waitcnt vmcnt(44)
  v_mul_f32 v30, v30, v46
  v_mul_f32 v31, v31, v47
  v_mfma_f32_16x16x32_bf16 v[76:79], a[0:3], v[188:191], v[76:79]
  buffer_load_dwordx4 a[0:3], v4, s[8:11], s46 offen offset:0 sc1
  v_mfma_f32_16x16x32_bf16 v[80:83], a[4:7], v[176:179], v[80:83]
  v_cvt_pk_bf16_f32 v42, v28, v29
  v_cvt_pk_bf16_f32 v43, v30, v31
  v_mfma_f32_16x16x32_bf16 v[84:87], a[4:7], v[180:183], v[84:87]
  s_waitcnt vmcnt(44)
  v_permlane32_swap_b32 v40, v42
  v_permlane32_swap_b32 v41, v43
  v_mfma_f32_16x16x32_bf16 v[88:91], a[4:7], v[184:187], v[88:91]
  s_add_u32 s47, s38, 12288
  v_and_b32 v40, -2, v40
  v_mfma_f32_16x16x32_bf16 v[92:95], a[4:7], v[188:191], v[92:95]
  buffer_load_dwordx4 a[4:7], v4, s[8:11], s47 offen offset:0 sc1
  v_mfma_f32_16x16x32_bf16 v[64:67], a[8:11], v[192:195], v[64:67]
  buffer_load_dword v19, v20, s[8:11], s34 offen sc1
  v_mfma_f32_16x16x32_bf16 v[68:71], a[8:11], v[196:199], v[68:71]
  buffer_store_dwordx4 v[40:43], v11, s[8:11], s42 offen sc1
  v_mfma_f32_16x16x32_bf16 v[72:75], a[8:11], v[200:203], v[72:75]
  s_waitcnt vmcnt(46)
  v_mfma_f32_16x16x32_bf16 v[76:79], a[8:11], v[204:207], v[76:79]
  buffer_load_dwordx4 a[8:11], v4, s[8:11], s47 offen offset:2048 sc1
  v_mfma_f32_16x16x32_bf16 v[80:83], a[12:15], v[192:195], v[80:83]
  v_mfma_f32_16x16x32_bf16 v[84:87], a[12:15], v[196:199], v[84:87]
  s_waitcnt vmcnt(46)
  v_mfma_f32_16x16x32_bf16 v[88:91], a[12:15], v[200:203], v[88:91]
  s_add_u32 s48, s38, 8192
  v_mfma_f32_16x16x32_bf16 v[92:95], a[12:15], v[204:207], v[92:95]
  buffer_load_dwordx4 a[12:15], v4, s[8:11], s48 offen offset:0 sc1
  v_mfma_f32_16x16x32_bf16 v[64:67], a[16:19], v[144:147], v[64:67]
  v_mfma_f32_16x16x32_bf16 v[68:71], a[16:19], v[148:151], v[68:71]
  s_waitcnt vmcnt(46)
  v_mfma_f32_16x16x32_bf16 v[72:75], a[16:19], v[152:155], v[72:75]
  s_add_u32 s49, s38, 16384
  v_mfma_f32_16x16x32_bf16 v[76:79], a[16:19], v[156:159], v[76:79]
  buffer_load_dwordx4 a[16:19], v4, s[8:11], s49 offen offset:2048 sc1
  v_mfma_f32_16x16x32_bf16 v[80:83], a[20:23], v[144:147], v[80:83]
  v_mfma_f32_16x16x32_bf16 v[84:87], a[20:23], v[148:151], v[84:87]
  s_waitcnt vmcnt(46)
  v_mfma_f32_16x16x32_bf16 v[88:91], a[20:23], v[152:155], v[88:91]
  s_add_u32 s46, s26, 0
  v_mfma_f32_16x16x32_bf16 v[92:95], a[20:23], v[156:159], v[92:95]
  buffer_load_dwordx4 a[20:23], v4, s[8:11], s46 offen offset:0 sc1
  v_mfma_f32_16x16x32_bf16 v[64:67], a[24:27], v[160:163], v[64:67]
  v_mfma_f32_16x16x32_bf16 v[68:71], a[24:27], v[164:167], v[68:71]
  v_mfma_f32_16x16x32_bf16 v[72:75], a[24:27], v[168:171], v[72:75]
  s_waitcnt vmcnt(46)
  v_mfma_f32_16x16x32_bf16 v[76:79], a[24:27], v[172:175], v[76:79]
  buffer_load_dwordx4 a[24:27], v4, s[8:11], s46 offen offset:1024 sc1
  v_mfma_f32_16x16x32_bf16 v[80:83], a[28:31], v[160:163], v[80:83]
  v_mfma_f32_16x16x32_bf16 v[84:87], a[28:31], v[164:167], v[84:87]
  v_mfma_f32_16x16x32_bf16 v[88:91], a[28:31], v[168:171], v[88:91]
  s_waitcnt vmcnt(46)
  v_mfma_f32_16x16x32_bf16 v[92:95], a[28:31], v[172:175], v[92:95]
  buffer_load_dwordx4 a[28:31], v4, s[8:11], s46 offen offset:2048 sc1
  v_mfma_f32_16x16x32_bf16 v[32:35], a[32:35], v[208:211], 0
  v_mfma_f32_16x16x32_bf16 v[36:39], a[32:35], v[212:215], 0
  v_mfma_f32_16x16x32_bf16 v[40:43], a[32:35], v[216:219], 0
  s_waitcnt vmcnt(46)
  v_exp_f32 v24, v64
  v_mfma_f32_16x16x32_bf16 v[44:47], a[32:35], v[220:223], 0
  buffer_load_dwordx4 a[32:35], v4, s[8:11], s46 offen offset:3072 sc1
  v_mfma_f32_16x16x32_bf16 v[48:51], a[36:39], v[208:211], 0
  v_exp_f32 v25, v65
  v_mfma_f32_16x16x32_bf16 v[52:55], a[36:39], v[212:215], 0
  s_waitcnt vmcnt(46)
  v_exp_f32 v26, v66
  v_mfma_f32_16x16x32_bf16 v[56:59], a[36:39], v[216:219], 0
  s_add_u32 s47, s26, 4096
  v_exp_f32 v27, v67
  v_mfma_f32_16x16x32_bf16 v[60:63], a[36:39], v[220:223], 0
  buffer_load_dwordx4 a[36:39], v4, s[8:11], s47 offen offset:0 sc1
  v_mfma_f32_16x16x32_bf16 v[32:35], a[40:43], v[224:227], v[32:35]
  v_mul_f32 v64, v64, v80
  v_mul_f32 v65, v65, v81
  v_mfma_f32_16x16x32_bf16 v[36:39], a[40:43], v[228:231], v[36:39]
  v_mul_f32 v66, v66, v82
  v_mul_f32 v67, v67, v83
  v_mfma_f32_16x16x32_bf16 v[40:43], a[40:43], v[232:235], v[40:43]
  s_waitcnt vmcnt(46)
  v_fma_f32 v24, v24, s54, s54
  v_fma_f32 v25, v25, s54, s54
  v_mfma_f32_16x16x32_bf16 v[44:47], a[40:43], v[236:239], v[44:47]
  buffer_load_dwordx4 a[40:43], v4, s[8:11], s47 offen offset:1024 sc1
  v_mfma_f32_16x16x32_bf16 v[48:51], a[44:47], v[224:227], v[48:51]
  v_fma_f32 v26, v26, s54, s54
  v_fma_f32 v27, v27, s54, s54
  v_mfma_f32_16x16x32_bf16 v[52:55], a[44:47], v[228:231], v[52:55]
  v_rcp_f32 v24, v24
  v_mfma_f32_16x16x32_bf16 v[56:59], a[44:47], v[232:235], v[56:59]
  s_waitcnt vmcnt(46)
  v_rcp_f32 v25, v25
  v_mfma_f32_16x16x32_bf16 v[60:63], a[44:47], v[236:239], v[60:63]
  buffer_load_dwordx4 a[44:47], v4, s[8:11], s47 offen offset:2048 sc1
  v_mfma_f32_16x16x32_bf16 v[32:35], a[48:51], v[240:243], v[32:35]
  v_rcp_f32 v26, v26
  v_mfma_f32_16x16x32_bf16 v[36:39], a[48:51], v[244:247], v[36:39]
  v_rcp_f32 v27, v27
  v_mfma_f32_16x16x32_bf16 v[40:43], a[48:51], v[248:251], v[40:43]
  s_waitcnt vmcnt(46)
  v_mul_f32 v24, v24, v64
  v_mul_f32 v25, v25, v65
  v_mfma_f32_16x16x32_bf16 v[44:47], a[48:51], v[252:255], v[44:47]
  buffer_load_dwordx4 a[48:51], v4, s[8:11], s47 offen offset:3072 sc1
  v_mfma_f32_16x16x32_bf16 v[48:51], a[52:55], v[240:243], v[48:51]
  v_mul_f32 v26, v26, v66
  v_mul_f32 v27, v27, v67
  v_mfma_f32_16x16x32_bf16 v[52:55], a[52:55], v[244:247], v[52:55]
  s_waitcnt vmcnt(46)
  v_cvt_pk_bf16_f32 v64, v24, v25
  v_cvt_pk_bf16_f32 v65, v26, v27
  v_mfma_f32_16x16x32_bf16 v[56:59], a[52:55], v[248:251], v[56:59]
  s_add_u32 s48, s26, 8192
  v_exp_f32 v28, v68
  v_mfma_f32_16x16x32_bf16 v[60:63], a[52:55], v[252:255], v[60:63]
  buffer_load_dwordx4 a[52:55], v4, s[8:11], s48 offen offset:0 sc1
  v_mfma_f32_16x16x32_bf16 v[32:35], a[56:59], v[96:99], v[32:35]
  v_exp_f32 v29, v69
  v_mfma_f32_16x16x32_bf16 v[36:39], a[56:59], v[100:103], v[36:39]
  v_exp_f32 v30, v70
  v_mfma_f32_16x16x32_bf16 v[40:43], a[56:59], v[104:107], v[40:43]
  s_waitcnt vmcnt(46)
  v_exp_f32 v31, v71
  v_mfma_f32_16x16x32_bf16 v[44:47], a[56:59], v[108:111], v[44:47]
  buffer_load_dwordx4 a[56:59], v4, s[8:11], s48 offen offset:1024 sc1
  v_mfma_f32_16x16x32_bf16 v[48:51], a[60:63], v[96:99], v[48:51]
  v_mul_f32 v68, v68, v84
  v_mul_f32 v69, v69, v85
  v_mfma_f32_16x16x32_bf16 v[52:55], a[60:63], v[100:103], v[52:55]
  v_mul_f32 v70, v70, v86
  v_mul_f32 v71, v71, v87
  v_mfma_f32_16x16x32_bf16 v[56:59], a[60:63], v[104:107], v[56:59]
  s_waitcnt vmcnt(46)
  v_fma_f32 v28, v28, s54, s54
  v_fma_f32 v29, v29, s54, s54
  v_mfma_f32_16x16x32_bf16 v[60:63], a[60:63], v[108:111], v[60:63]
  buffer_load_dwordx4 a[60:63], v4, s[8:11], s48 offen offset:2048 sc1
  v_mfma_f32_16x16x32_bf16 v[32:35], a[64:67], v[112:115], v[32:35]
  v_fma_f32 v30, v30, s54, s54
  v_fma_f32 v31, v31, s54, s54
  v_mfma_f32_16x16x32_bf16 v[36:39], a[64:67], v[116:119], v[36:39]
  v_rcp_f32 v28, v28
  v_mfma_f32_16x16x32_bf16 v[40:43], a[64:67], v[120:123], v[40:43]
  s_waitcnt vmcnt(46)
  v_rcp_f32 v29, v29
  v_mfma_f32_16x16x32_bf16 v[44:47], a[64:67], v[124:127], v[44:47]
  buffer_load_dwordx4 a[64:67], v4, s[8:11], s48 offen offset:3072 sc1
  v_mfma_f32_16x16x32_bf16 v[48:51], a[68:71], v[112:115], v[48:51]
  v_rcp_f32 v30, v30
  v_mfma_f32_16x16x32_bf16 v[52:55], a[68:71], v[116:119], v[52:55]
  s_waitcnt vmcnt(46)
  v_rcp_f32 v31, v31
  v_mfma_f32_16x16x32_bf16 v[56:59], a[68:71], v[120:123], v[56:59]
  s_add_u32 s49, s26, 12288
  v_mul_f32 v28, v28, v68
  v_mul_f32 v29, v29, v69
  v_mfma_f32_16x16x32_bf16 v[60:63], a[68:71], v[124:127], v[60:63]
  buffer_load_dwordx4 a[68:71], v4, s[8:11], s49 offen offset:0 sc1
  v_mfma_f32_16x16x32_bf16 v[32:35], a[72:75], a[192:195], v[32:35]
  v_mul_f32 v30, v30, v70
  v_mul_f32 v31, v31, v71
  v_mfma_f32_16x16x32_bf16 v[36:39], a[72:75], a[196:199], v[36:39]
  s_waitcnt vmcnt(46)
  v_cvt_pk_bf16_f32 v66, v28, v29
  v_cvt_pk_bf16_f32 v67, v30, v31
  v_mfma_f32_16x16x32_bf16 v[40:43], a[72:75], a[200:203], v[40:43]
  s_add_u32 s44, s42, 8192
  v_permlane32_swap_b32 v64, v66
  v_permlane32_swap_b32 v65, v67
  v_mfma_f32_16x16x32_bf16 v[44:47], a[72:75], a[204:207], v[44:47]
  buffer_load_dwordx4 a[72:75], v4, s[8:11], s49 offen offset:1024 sc1
  v_mfma_f32_16x16x32_bf16 v[48:51], a[76:79], a[192:195], v[48:51]
  v_and_b32 v64, -2, v64
  v_mfma_f32_16x16x32_bf16 v[52:55], a[76:79], a[196:199], v[52:55]
  buffer_store_dwordx4 v[64:67], v10, s[8:11], s44 offen sc1
  v_mfma_f32_16x16x32_bf16 v[56:59], a[76:79], a[200:203], v[56:59]
  s_waitcnt vmcnt(47)
  v_exp_f32 v24, v72
  v_mfma_f32_16x16x32_bf16 v[60:63], a[76:79], a[204:207], v[60:63]
  buffer_load_dwordx4 a[76:79], v4, s[8:11], s49 offen offset:2048 sc1
  v_mfma_f32_16x16x32_bf16 v[32:35], a[80:83], v[128:131], v[32:35]
  v_exp_f32 v25, v73
  v_mfma_f32_16x16x32_bf16 v[36:39], a[80:83], v[132:135], v[36:39]
  v_exp_f32 v26, v74
  v_mfma_f32_16x16x32_bf16 v[40:43], a[80:83], v[136:139], v[40:43]
  s_waitcnt vmcnt(47)
  v_exp_f32 v27, v75
  v_mfma_f32_16x16x32_bf16 v[44:47], a[80:83], v[140:143], v[44:47]
  buffer_load_dwordx4 a[80:83], v4, s[8:11], s49 offen offset:3072 sc1
  v_mfma_f32_16x16x32_bf16 v[48:51], a[84:87], v[128:131], v[48:51]
  s_add_u32 s46, s31, 0
  v_mul_f32 v72, v72, v88
  v_mul_f32 v73, v73, v89
  v_mfma_f32_16x16x32_bf16 v[52:55], a[84:87], v[132:135], v[52:55]
  s_add_u32 m0, s62, 57344
  v_mul_f32 v74, v74, v90
  v_mul_f32 v75, v75, v91
  v_mfma_f32_16x16x32_bf16 v[56:59], a[84:87], v[136:139], v[56:59]
  buffer_load_dwordx4 v4, s[8:11], s46 offen offset:0 sc1 lds
  v_mfma_f32_16x16x32_bf16 v[60:63], a[84:87], v[140:143], v[60:63]
  s_add_u32 m0, s62, 60416
  v_fma_f32 v24, v24, s54, s54
  v_fma_f32 v25, v25, s54, s54
  s_waitcnt vmcnt(48)
  v_mfma_f32_16x16x32_bf16 v[32:35], a[88:91], a[208:211], v[32:35]
  buffer_load_dwordx4 v4, s[8:11], s46 offen offset:1024 sc1 lds
  v_mfma_f32_16x16x32_bf16 v[36:39], a[88:91], a[212:215], v[36:39]
  s_add_u32 m0, s62, 63488
  v_fma_f32 v26, v26, s54, s54
  v_fma_f32 v27, v27, s54, s54
  v_mfma_f32_16x16x32_bf16 v[40:43], a[88:91], a[216:219], v[40:43]
  buffer_load_dwordx4 v4, s[8:11], s46 offen offset:2048 sc1 lds
  v_mfma_f32_16x16x32_bf16 v[44:47], a[88:91], a[220:223], v[44:47]
  s_add_u32 m0, s62, 66560
  v_rcp_f32 v24, v24
  s_waitcnt vmcnt(49)
  v_mfma_f32_16x16x32_bf16 v[48:51], a[92:95], a[208:211], v[48:51]
  buffer_load_dwordx4 v4, s[8:11], s46 offen offset:3072 sc1 lds
  v_mfma_f32_16x16x32_bf16 v[52:55], a[92:95], a[212:215], v[52:55]
  s_add_u32 s47, s31, 4096
  v_rcp_f32 v25, v25
  v_mfma_f32_16x16x32_bf16 v[56:59], a[92:95], a[216:219], v[56:59]
  s_add_u32 m0, s62, 73728
  v_rcp_f32 v26, v26
  v_mfma_f32_16x16x32_bf16 v[60:63], a[92:95], a[220:223], v[60:63]
  buffer_load_dwordx4 v4, s[8:11], s47 offen offset:0 sc1 lds
  s_waitcnt vmcnt(50)
  v_mfma_f32_16x16x32_bf16 v[32:35], a[96:99], a[224:227], v[32:35]
  s_add_u32 m0, s62, 76800
  v_rcp_f32 v27, v27
  v_mfma_f32_16x16x32_bf16 v[36:39], a[96:99], a[228:231], v[36:39]
  buffer_load_dwordx4 v4, s[8:11], s47 offen offset:1024 sc1 lds
  v_mfma_f32_16x16x32_bf16 v[40:43], a[96:99], a[232:235], v[40:43]
  s_add_u32 m0, s62, 79872
  v_mul_f32 v24, v24, v72
  v_mul_f32 v25, v25, v73
  v_mfma_f32_16x16x32_bf16 v[44:47], a[96:99], a[236:239], v[44:47]
  buffer_load_dwordx4 v4, s[8:11], s47 offen offset:2048 sc1 lds
  s_waitcnt vmcnt(51)
  v_mfma_f32_16x16x32_bf16 v[48:51], a[100:103], a[224:227], v[48:51]
  v_mul_f32 v26, v26, v74
  v_mul_f32 v27, v27, v75
  v_mfma_f32_16x16x32_bf16 v[52:55], a[100:103], a[228:231], v[52:55]
  s_add_u32 m0, s62, 82944
  v_cvt_pk_bf16_f32 v72, v24, v25
  v_cvt_pk_bf16_f32 v73, v26, v27
  v_mfma_f32_16x16x32_bf16 v[56:59], a[100:103], a[232:235], v[56:59]
  buffer_load_dwordx4 v4, s[8:11], s47 offen offset:3072 sc1 lds
  v_mfma_f32_16x16x32_bf16 v[60:63], a[100:103], a[236:239], v[60:63]
  s_waitcnt vmcnt(51)
  v_exp_f32 v28, v76
  v_mfma_f32_16x16x32_bf16 v[32:35], a[104:107], a[240:243], v[32:35]
  v_exp_f32 v29, v77
  v_mfma_f32_16x16x32_bf16 v[36:39], a[104:107], a[244:247], v[36:39]
  s_add_u32 s48, s31, 8192
  v_exp_f32 v30, v78
  v_mfma_f32_16x16x32_bf16 v[40:43], a[104:107], a[248:251], v[40:43]
  s_add_u32 m0, s62, 90112
  v_exp_f32 v31, v79
  v_mfma_f32_16x16x32_bf16 v[44:47], a[104:107], a[252:255], v[44:47]
  buffer_load_dwordx4 v4, s[8:11], s48 offen offset:0 sc1 lds
  s_waitcnt vmcnt(51)
  v_mfma_f32_16x16x32_bf16 v[48:51], a[108:111], a[240:243], v[48:51]
  v_mul_f32 v76, v76, v92
  v_mul_f32 v77, v77, v93
  v_mfma_f32_16x16x32_bf16 v[52:55], a[108:111], a[244:247], v[52:55]
  buffer_load_dwordx4 a[84:87], v4, s[8:11], s48 offen offset:1024 sc1
  v_mfma_f32_16x16x32_bf16 v[56:59], a[108:111], a[248:251], v[56:59]
  v_mul_f32 v78, v78, v94
  v_mul_f32 v79, v79, v95
  v_mfma_f32_16x16x32_bf16 v[60:63], a[108:111], a[252:255], v[60:63]
  s_waitcnt vmcnt(51)
  v_fma_f32 v28, v28, s54, s54
  v_fma_f32 v29, v29, s54, s54
  v_mfma_f32_16x16x32_bf16 v[32:35], a[112:115], v[176:179], v[32:35]
  v_fma_f32 v30, v30, s54, s54
  v_fma_f32 v31, v31, s54, s54
  v_mfma_f32_16x16x32_bf16 v[36:39], a[112:115], v[180:183], v[36:39]
  buffer_load_dwordx4 a[88:91], v4, s[8:11], s48 offen offset:2048 sc1
  v_mfma_f32_16x16x32_bf16 v[40:43], a[112:115], v[184:187], v[40:43]
  v_rcp_f32 v28, v28
  v_mfma_f32_16x16x32_bf16 v[44:47], a[112:115], v[188:191], v[44:47]
  s_waitcnt vmcnt(51)
  v_rcp_f32 v29, v29
  v_mfma_f32_16x16x32_bf16 v[48:51], a[116:119], v[176:179], v[48:51]
  buffer_load_dwordx4 a[92:95], v4, s[8:11], s48 offen offset:3072 sc1
  v_mfma_f32_16x16x32_bf16 v[52:55], a[116:119], v[180:183], v[52:55]
  v_rcp_f32 v30, v30
  v_mfma_f32_16x16x32_bf16 v[56:59], a[116:119], v[184:187], v[56:59]
  s_waitcnt vmcnt(51)
  v_rcp_f32 v31, v31
  v_mfma_f32_16x16x32_bf16 v[60:63], a[116:119], v[188:191], v[60:63]
  s_add_u32 s49, s31, 12288
  v_mul_f32 v28, v28, v76
  v_mul_f32 v29, v29, v77
  v_mfma_f32_16x16x32_bf16 v[32:35], a[120:123], v[192:195], v[32:35]
  buffer_load_dwordx4 a[96:99], v4, s[8:11], s49 offen offset:0 sc1
  v_mfma_f32_16x16x32_bf16 v[36:39], a[120:123], v[196:199], v[36:39]
  v_mul_f32 v30, v30, v78
  v_mul_f32 v31, v31, v79
  v_mfma_f32_16x16x32_bf16 v[40:43], a[120:123], v[200:203], v[40:43]
  v_cvt_pk_bf16_f32 v74, v28, v29
  v_cvt_pk_bf16_f32 v75, v30, v31
  v_mfma_f32_16x16x32_bf16 v[44:47], a[120:123], v[204:207], v[44:47]
  s_waitcnt vmcnt(51)
  v_permlane32_swap_b32 v72, v74
  v_permlane32_swap_b32 v73, v75
  v_mfma_f32_16x16x32_bf16 v[48:51], a[124:127], v[192:195], v[48:51]
  buffer_load_dwordx4 a[100:103], v4, s[8:11], s49 offen offset:1024 sc1
  v_mfma_f32_16x16x32_bf16 v[52:55], a[124:127], v[196:199], v[52:55]
  v_and_b32 v72, -2, v72
  v_mfma_f32_16x16x32_bf16 v[56:59], a[124:127], v[200:203], v[56:59]
  buffer_store_dwordx4 v[72:75], v11, s[8:11], s44 offen sc1
  v_mfma_f32_16x16x32_bf16 v[60:63], a[124:127], v[204:207], v[60:63]
  s_waitcnt vmcnt(52)
  v_lshl_add_u32 v88, s20, 10, v4
  v_xor_b32 v89, 1024, v88
  v_mfma_f32_16x16x32_bf16 v[32:35], a[128:131], v[144:147], v[32:35]
  s_waitcnt vmcnt(36)
  v_cmp_ne_u32 vcc, 0, v19
  v_xor_b32 v90, 2048, v88
  v_mfma_f32_16x16x32_bf16 v[36:39], a[128:131], v[148:151], v[36:39]
  s_cbranch_vccnz k_p2
k_p2b:
  v_xor_b32 v91, 3072, v88
  v_mfma_f32_16x16x32_bf16 v[40:43], a[128:131], v[152:155], v[40:43]
  buffer_load_dwordx4 a[104:107], v4, s[8:11], s49 offen offset:2048 sc1
  v_mfma_f32_16x16x32_bf16 v[44:47], a[128:131], v[156:159], v[44:47]
  v_mfma_f32_16x16x32_bf16 v[48:51], a[132:135], v[144:147], v[48:51]
  buffer_load_dwordx4 a[108:111], v4, s[8:11], s49 offen offset:3072 sc1
  v_mfma_f32_16x16x32_bf16 v[52:55], a[132:135], v[148:151], v[52:55]
  v_mfma_f32_16x16x32_bf16 v[56:59], a[132:135], v[152:155], v[56:59]
  s_add_u32 s46, s33, 0
  v_mfma_f32_16x16x32_bf16 v[60:63], a[132:135], v[156:159], v[60:63]
  buffer_load_dwordx4 a[160:163], v4, s[8:11], s46 offen offset:0 sc1
  v_mfma_f32_16x16x32_bf16 v[32:35], a[136:139], v[160:163], v[32:35]
  v_mfma_f32_16x16x32_bf16 v[36:39], a[136:139], v[164:167], v[36:39]
  v_mfma_f32_16x16x32_bf16 v[40:43], a[136:139], v[168:171], v[40:43]
  v_mfma_f32_16x16x32_bf16 v[44:47], a[136:139], v[172:175], v[44:47]
  buffer_load_dwordx4 a[164:167], v4, s[8:11], s46 offen offset:1024 sc1
  v_mfma_f32_16x16x32_bf16 v[48:51], a[140:143], v[160:163], v[48:51]
  v_mfma_f32_16x16x32_bf16 v[52:55], a[140:143], v[164:167], v[52:55]
  v_mfma_f32_16x16x32_bf16 v[56:59], a[140:143], v[168:171], v[56:59]
  v_mfma_f32_16x16x32_bf16 v[60:63], a[140:143], v[172:175], v[60:63]
  buffer_load_dwordx4 a[168:171], v4, s[8:11], s46 offen offset:2048 sc1
  v_mfma_f32_16x16x32_bf16 v[64:67], a[144:147], v[96:99], 0
  v_mfma_f32_16x16x32_bf16 v[68:71], a[144:147], v[100:103], 0
  v_mfma_f32_16x16x32_bf16 v[72:75], a[144:147], v[104:107], 0
  s_add_u32 s47, s43, 0
  v_exp_f32 v24, v32
  v_exp_f32 v25, v33
  v_mfma_f32_16x16x32_bf16 v[76:79], a[144:147], v[108:111], 0
  buffer_load_dwordx4 v[96:99], v88, s[8:11], s47 offen sc1
  v_exp_f32 v26, v34
  v_mfma_f32_16x16x32_bf16 v[64:67], a[148:151], v[112:115], v[64:67]
  v_exp_f32 v27, v35
  v_mul_f32 v32, v32, v48
  v_mul_f32 v33, v33, v49
  v_mfma_f32_16x16x32_bf16 v[68:71], a[148:151], v[116:119], v[68:71]
  v_mul_f32 v34, v34, v50
  v_mul_f32 v35, v35, v51
  v_fma_f32 v24, v24, s54, s54
  v_fma_f32 v25, v25, s54, s54
  v_mfma_f32_16x16x32_bf16 v[72:75], a[148:151], v[120:123], v[72:75]
  buffer_load_dwordx4 v[100:103], v89, s[8:11], s47 offen sc1
  v_fma_f32 v26, v26, s54, s54
  v_fma_f32 v27, v27, s54, s54
  v_mfma_f32_16x16x32_bf16 v[76:79], a[148:151], v[124:127], v[76:79]
  v_rcp_f32 v24, v24
  v_rcp_f32 v25, v25
  v_mfma_f32_16x16x32_bf16 v[64:67], a[152:155], v[128:131], v[64:67]
  buffer_load_dwordx4 v[104:107], v90, s[8:11], s47 offen sc1
  v_rcp_f32 v26, v26
  v_mfma_f32_16x16x32_bf16 v[68:71], a[152:155], v[132:135], v[68:71]
  v_rcp_f32 v27, v27
  v_mul_f32 v24, v24, v32
  v_mul_f32 v25, v25, v33
  v_mfma_f32_16x16x32_bf16 v[72:75], a[152:155], v[136:139], v[72:75]
  v_mul_f32 v26, v26, v34
  v_mul_f32 v27, v27, v35
  v_cvt_pk_bf16_f32 v32, v24, v25
  v_cvt_pk_bf16_f32 v33, v26, v27
  v_mfma_f32_16x16x32_bf16 v[76:79], a[152:155], v[140:143], v[76:79]
  buffer_load_dwordx4 v[108:111], v91, s[8:11], s47 offen sc1
  v_exp_f32 v28, v36
  v_mfma_f32_16x16x32_bf16 v[64:67], a[156:159], v[176:179], v[64:67]
  v_exp_f32 v29, v37
  v_exp_f32 v30, v38
  v_mfma_f32_16x16x32_bf16 v[68:71], a[156:159], v[180:183], v[68:71]
  s_add_u32 s48, s43, 1835008
  v_exp_f32 v31, v39
  v_mul_f32 v36, v36, v52
  v_mul_f32 v37, v37, v53
  v_mfma_f32_16x16x32_bf16 v[72:75], a[156:159], v[184:187], v[72:75]
  buffer_load_dwordx4 v[112:115], v88, s[8:11], s48 offen sc1
  v_mul_f32 v38, v38, v54
  v_mul_f32 v39, v39, v55
  v_mfma_f32_16x16x32_bf16 v[76:79], a[156:159], v[188:191], v[76:79]
  v_fma_f32 v28, v28, s54, s54
  v_fma_f32 v29, v29, s54, s54
  v_fma_f32 v30, v30, s54, s54
  v_fma_f32 v31, v31, s54, s54
  v_mfma_f32_16x16x32_bf16 v[64:67], a[172:175], v[192:195], v[64:67]
  v_rcp_f32 v28, v28
  v_rcp_f32 v29, v29
  v_mfma_f32_16x16x32_bf16 v[68:71], a[172:175], v[196:199], v[68:71]
  buffer_load_dwordx4 v[116:119], v89, s[8:11], s48 offen sc1
  v_rcp_f32 v30, v30
  v_mfma_f32_16x16x32_bf16 v[72:75], a[172:175], v[200:203], v[72:75]
  v_rcp_f32 v31, v31
  v_mul_f32 v28, v28, v36
  v_mul_f32 v29, v29, v37
  v_mfma_f32_16x16x32_bf16 v[76:79], a[172:175], v[204:207], v[76:79]
  v_mul_f32 v30, v30, v38
  v_mul_f32 v31, v31, v39
  v_cvt_pk_bf16_f32 v34, v28, v29
  v_cvt_pk_bf16_f32 v35, v30, v31
  v_mfma_f32_16x16x32_bf16 v[64:67], a[176:179], v[208:211], v[64:67]
  buffer_load_dwordx4 v[120:123], v90, s[8:11], s48 offen sc1
  v_mfma_f32_16x16x32_bf16 v[68:71], a[176:179], v[212:215], v[68:71]
  s_add_u32 s44, s42, 16384
  v_permlane32_swap_b32 v32, v34
  v_permlane32_swap_b32 v33, v35
  v_and_b32 v32, -2, v32
  v_mfma_f32_16x16x32_bf16 v[72:75], a[176:179], v[216:219], v[72:75]
  buffer_load_dwordx4 v[124:127], v91, s[8:11], s48 offen sc1
  v_mfma_f32_16x16x32_bf16 v[76:79], a[176:179], v[220:223], v[76:79]
  buffer_store_dwordx4 v[32:35], v10, s[8:11], s44 offen sc1
  v_exp_f32 v24, v40
  v_mfma_f32_16x16x32_bf16 v[64:67], a[180:183], v[224:227], v[64:67]
  s_add_u32 s49, s43, 4096
  v_exp_f32 v25, v41
  v_exp_f32 v26, v42
  v_mfma_f32_16x16x32_bf16 v[68:71], a[180:183], v[228:231], v[68:71]
  buffer_load_dwordx4 v[128:131], v88, s[8:11], s49 offen sc1
  v_exp_f32 v27, v43
  v_mfma_f32_16x16x32_bf16 v[72:75], a[180:183], v[232:235], v[72:75]
  v_mul_f32 v40, v40, v56
  v_mul_f32 v41, v41, v57
  v_mul_f32 v42, v42, v58
  v_mul_f32 v43, v43, v59
  v_mfma_f32_16x16x32_bf16 v[76:79], a[180:183], v[236:239], v[76:79]
  v_fma_f32 v24, v24, s54, s54
  v_fma_f32 v25, v25, s54, s54
  v_fma_f32 v26, v26, s54, s54
  v_fma_f32 v27, v27, s54, s54
  v_mfma_f32_16x16x32_bf16 v[64:67], a[184:187], v[240:243], v[64:67]
  buffer_load_dwordx4 v[132:135], v89, s[8:11], s49 offen sc1
  v_rcp_f32 v24, v24
  v_mfma_f32_16x16x32_bf16 v[68:71], a[184:187], v[244:247], v[68:71]
  v_rcp_f32 v25, v25
  v_rcp_f32 v26, v26
  v_mfma_f32_16x16x32_bf16 v[72:75], a[184:187], v[248:251], v[72:75]
  v_rcp_f32 v27, v27
  v_mul_f32 v24, v24, v40
  v_mul_f32 v25, v25, v41
  v_mfma_f32_16x16x32_bf16 v[76:79], a[184:187], v[252:255], v[76:79]
  buffer_load_dwordx4 v[136:139], v90, s[8:11], s49 offen sc1
  v_mul_f32 v26, v26, v42
  v_mul_f32 v27, v27, v43
  v_mfma_f32_16x16x32_bf16 v[64:67], a[188:191], a[192:195], v[64:67]
  v_cvt_pk_bf16_f32 v40, v24, v25
  v_cvt_pk_bf16_f32 v41, v26, v27
  v_exp_f32 v28, v44
  v_mfma_f32_16x16x32_bf16 v[68:71], a[188:191], a[196:199], v[68:71]
  v_exp_f32 v29, v45
  v_exp_f32 v30, v46
  v_mfma_f32_16x16x32_bf16 v[72:75], a[188:191], a[200:203], v[72:75]
  buffer_load_dwordx4 v[140:143], v91, s[8:11], s49 offen sc1
  v_exp_f32 v31, v47
  v_mfma_f32_16x16x32_bf16 v[76:79], a[188:191], a[204:207], v[76:79]
  s_add_u32 s46, s43, 1839104
  v_mul_f32 v44, v44, v60
  v_mul_f32 v45, v45, v61
  v_mul_f32 v46, v46, v62
  v_mul_f32 v47, v47, v63
  v_mfma_f32_16x16x32_bf16 v[64:67], a[0:3], a[208:211], v[64:67]
  buffer_load_dwordx4 v[208:211], v88, s[8:11], s46 offen sc1
  v_fma_f32 v28, v28, s54, s54
  v_fma_f32 v29, v29, s54, s54
  v_mfma_f32_16x16x32_bf16 v[68:71], a[0:3], a[212:215], v[68:71]
  v_fma_f32 v30, v30, s54, s54
  v_fma_f32 v31, v31, s54, s54
  v_rcp_f32 v28, v28
  v_mfma_f32_16x16x32_bf16 v[72:75], a[0:3], a[216:219], v[72:75]
  v_rcp_f32 v29, v29
  v_rcp_f32 v30, v30
  v_mfma_f32_16x16x32_bf16 v[76:79], a[0:3], a[220:223], v[76:79]
  buffer_load_dwordx4 v[212:215], v89, s[8:11], s46 offen sc1
  v_rcp_f32 v31, v31
  v_mfma_f32_16x16x32_bf16 v[64:67], a[4:7], v[144:147], v[64:67]
  v_mul_f32 v28, v28, v44
  v_mul_f32 v29, v29, v45
  v_mul_f32 v30, v30, v46
  v_mul_f32 v31, v31, v47
  v_mfma_f32_16x16x32_bf16 v[68:71], a[4:7], v[148:151], v[68:71]
  v_cvt_pk_bf16_f32 v42, v28, v29
  v_cvt_pk_bf16_f32 v43, v30, v31
  s_nop 0
  v_permlane32_swap_b32 v40, v42
  v_permlane32_swap_b32 v41, v43
  v_mfma_f32_16x16x32_bf16 v[72:75], a[4:7], v[152:155], v[72:75]
  buffer_load_dwordx4 v[216:219], v90, s[8:11], s46 offen sc1
  v_and_b32 v40, -2, v40
  v_mfma_f32_16x16x32_bf16 v[76:79], a[4:7], v[156:159], v[76:79]
  buffer_store_dwordx4 v[40:43], v11, s[8:11], s44 offen sc1
  s_waitcnt vmcnt(56)
  v_mfma_f32_16x16x32_bf16 v[64:67], a[8:11], v[160:163], v[64:67]
  v_add_u32 v244, s56, v4
  v_min_u32 v252, 1, v3
  v_add_u32 v253, s58, v244
  v_mad_i32_i24 v252, v252, s69, v253
  v_mfma_f32_16x16x32_bf16 v[68:71], a[8:11], v[164:167], v[68:71]
  buffer_load_dwordx4 v[220:223], v91, s[8:11], s46 offen sc1
  v_add_u32 v253, s57, v244
  v_lshl_add_u32 v254, s20, 4, v2
  v_mfma_f32_16x16x32_bf16 v[72:75], a[8:11], v[168:171], v[72:75]
  s_waitcnt vmcnt(56)
  v_lshlrev_b32 v254, 3, v254
  v_add_u32 v254, 153600, v254
  ds_read_u16 v252, v252
  ds_read_u16 v253, v253
  v_mfma_f32_16x16x32_bf16 v[76:79], a[8:11], v[172:175], v[76:79]
  s_add_u32 s47, s33, 0
  ds_read_b64 v[254:255], v254
  ds_read_b128 v[248:251], v244 offset:1024
  ds_read_b128 v[244:247], v244
  v_mfma_f32_16x16x32_bf16 v[64:67], a[12:15], a[224:227], v[64:67]
  buffer_load_dwordx4 a[172:175], v4, s[8:11], s47 offen offset:3072 sc1
  v_mfma_f32_16x16x32_bf16 v[68:71], a[12:15], a[228:231], v[68:71]
  s_add_u32 s48, s43, 8192
  v_mfma_f32_16x16x32_bf16 v[72:75], a[12:15], a[232:235], v[72:75]
  buffer_load_dwordx4 v[224:227], v88, s[8:11], s48 offen sc1
  v_mfma_f32_16x16x32_bf16 v[76:79], a[12:15], a[236:239], v[76:79]
  s_waitcnt vmcnt(17)
  v_bitop3_b32 v21, v96, v100, v104 bitop3:0xfe
  s_waitcnt vmcnt(16)
  v_bitop3_b32 v21, v21, v108, 1 bitop3:0xa8
  v_cmp_ne_u32 vcc, 0, v21
  v_mfma_f32_16x16x32_bf16 v[64:67], a[16:19], a[240:243], v[64:67]
  s_cbranch_vccnz k_hs0_0
k_hb0_0:
  v_mfma_f32_16x16x32_bf16 v[68:71], a[16:19], a[244:247], v[68:71]
  buffer_load_dwordx4 v[228:231], v89, s[8:11], s48 offen sc1
  v_mfma_f32_16x16x32_bf16 v[72:75], a[16:19], a[248:251], v[72:75]
  v_mfma_f32_16x16x32_bf16 v[76:79], a[16:19], a[252:255], v[76:79]
  v_mfma_f32_16x16x32_bf16 v[144:147], a[20:23], v[96:99], 0
  buffer_load_dwordx4 v[232:235], v90, s[8:11], s48 offen sc1
  v_mfma_f32_16x16x32_bf16 v[148:151], a[24:27], v[96:99], 0
  v_mfma_f32_16x16x32_bf16 v[152:155], a[28:31], v[96:99], 0
  s_nop 2
  ds_write_b128 v17, v[72:75] offset:0
  v_mfma_f32_16x16x32_bf16 v[156:159], a[32:35], v[96:99], 0
  ds_write_b128 v17, v[76:79] offset:1024
  v_mfma_f32_16x16x32_bf16 v[160:163], a[20:23], v[100:103], 0
  buffer_load_dwordx4 v[236:239], v91, s[8:11], s48 offen sc1
  v_mfma_f32_16x16x32_bf16 v[164:167], a[24:27], v[100:103], 0
  s_waitcnt lgkmcnt(0)
  v_mfma_f32_16x16x32_bf16 v[168:171], a[28:31], v[100:103], 0
  s_barrier
  ds_read_b128 v[80:83], v18 offset:0
  ds_read_b128 v[84:87], v18 offset:1024
  v_mfma_f32_16x16x32_bf16 v[172:175], a[32:35], v[100:103], 0
  s_add_u32 s49, s43, 1843200
  buffer_load_dwordx4 v[240:243], v88, s[8:11], s49 offen sc1
  v_mfma_f32_16x16x32_bf16 v[176:179], a[20:23], v[104:107], 0
  buffer_load_dwordx4 v[32:35], v89, s[8:11], s49 offen sc1
  v_mfma_f32_16x16x32_bf16 v[180:183], a[24:27], v[104:107], 0
  v_mfma_f32_16x16x32_bf16 v[184:187], a[28:31], v[104:107], 0
  s_waitcnt lgkmcnt(1)
  v_cndmask_b32 v24, v64, v80, s[52:53]
  v_cndmask_b32 v25, v65, v81, s[52:53]
  v_cndmask_b32 v26, v66, v82, s[52:53]
  v_cndmask_b32 v27, v67, v83, s[52:53]
  v_mfma_f32_16x16x32_bf16 v[188:191], a[32:35], v[104:107], 0
  s_waitcnt vmcnt(18)
  v_bitop3_b32 v21, v112, v116, v120 bitop3:0xfe
  s_waitcnt vmcnt(17)
  v_bitop3_b32 v21, v21, v124, 1 bitop3:0xa8
  v_cmp_ne_u32 vcc, 0, v21
  v_mfma_f32_16x16x32_bf16 v[192:195], a[20:23], v[108:111], 0
  s_cbranch_vccnz k_hs0_1
k_hb0_1:
  buffer_load_dwordx4 v[36:39], v90, s[8:11], s49 offen sc1
  v_exp_f32 v24, v24
  v_mfma_f32_16x16x32_bf16 v[196:199], a[24:27], v[108:111], 0
  v_exp_f32 v25, v25
  v_exp_f32 v26, v26
  v_mfma_f32_16x16x32_bf16 v[200:203], a[28:31], v[108:111], 0
  buffer_load_dwordx4 v[40:43], v91, s[8:11], s49 offen sc1
  v_exp_f32 v27, v27
  v_mfma_f32_16x16x32_bf16 v[204:207], a[32:35], v[108:111], 0
  v_mul_f32 v64, v64, v80
  v_mul_f32 v65, v65, v81
  v_mul_f32 v66, v66, v82
  v_mul_f32 v67, v67, v83
  v_mfma_f32_16x16x32_bf16 v[144:147], a[36:39], v[112:115], v[144:147]
  s_add_u32 s46, s43, 12288
  v_fma_f32 v24, v24, s54, s54
  v_fma_f32 v25, v25, s54, s54
  v_fma_f32 v26, v26, s54, s54
  v_fma_f32 v27, v27, s54, s54
  v_mfma_f32_16x16x32_bf16 v[148:151], a[40:43], v[112:115], v[148:151]
  buffer_load_dwordx4 v[96:99], v88, s[8:11], s46 offen sc1
  v_rcp_f32 v24, v24
  v_mfma_f32_16x16x32_bf16 v[152:155], a[44:47], v[112:115], v[152:155]
  v_rcp_f32 v25, v25
  v_rcp_f32 v26, v26
  v_mfma_f32_16x16x32_bf16 v[156:159], a[48:51], v[112:115], v[156:159]
  v_rcp_f32 v27, v27
  v_mul_f32 v24, v24, v64
  v_mul_f32 v25, v25, v65
  v_mfma_f32_16x16x32_bf16 v[160:163], a[36:39], v[116:119], v[160:163]
  buffer_load_dwordx4 v[72:75], v89, s[8:11], s46 offen sc1
  v_mul_f32 v26, v26, v66
  v_mul_f32 v27, v27, v67
  v_mfma_f32_16x16x32_bf16 v[164:167], a[40:43], v[116:119], v[164:167]
  v_cvt_pk_bf16_f32 v64, v24, v25
  v_cvt_pk_bf16_f32 v65, v26, v27
  s_waitcnt lgkmcnt(0)
  v_cndmask_b32 v28, v68, v84, s[52:53]
  v_cndmask_b32 v29, v69, v85, s[52:53]
  v_mfma_f32_16x16x32_bf16 v[168:171], a[44:47], v[116:119], v[168:171]
  buffer_load_dwordx4 v[76:79], v90, s[8:11], s46 offen sc1
  v_cndmask_b32 v30, v70, v86, s[52:53]
  v_cndmask_b32 v31, v71, v87, s[52:53]
  v_mfma_f32_16x16x32_bf16 v[172:175], a[48:51], v[116:119], v[172:175]
  v_exp_f32 v28, v28
  v_exp_f32 v29, v29
  v_mfma_f32_16x16x32_bf16 v[176:179], a[36:39], v[120:123], v[176:179]
  v_exp_f32 v30, v30
  v_exp_f32 v31, v31
  v_mfma_f32_16x16x32_bf16 v[180:183], a[40:43], v[120:123], v[180:183]
  buffer_load_dwordx4 v[100:103], v91, s[8:11], s46 offen sc1
  v_mul_f32 v68, v68, v84
  v_mul_f32 v69, v69, v85
  v_mfma_f32_16x16x32_bf16 v[184:187], a[44:47], v[120:123], v[184:187]
  v_mul_f32 v70, v70, v86
  v_mul_f32 v71, v71, v87
  v_fma_f32 v28, v28, s54, s54
  v_fma_f32 v29, v29, s54, s54
  v_mfma_f32_16x16x32_bf16 v[188:191], a[48:51], v[120:123], v[188:191]
  s_waitcnt vmcnt(19)
  v_bitop3_b32 v21, v128, v132, v136 bitop3:0xfe
  s_waitcnt vmcnt(18)
  v_bitop3_b32 v21, v21, v140, 1 bitop3:0xa8
  v_cmp_ne_u32 vcc, 0, v21
  v_fma_f32 v30, v30, s54, s54
  v_mfma_f32_16x16x32_bf16 v[192:195], a[36:39], v[124:127], v[192:195]
  s_cbranch_vccnz k_hs0_2
k_hb0_2:
  v_fma_f32 v31, v31, s54, s54
  v_rcp_f32 v28, v28
  v_mfma_f32_16x16x32_bf16 v[196:199], a[40:43], v[124:127], v[196:199]
  s_add_u32 s47, s43, 1847296
  buffer_load_dwordx4 v[104:107], v88, s[8:11], s47 offen sc1
  v_rcp_f32 v29, v29
  v_mfma_f32_16x16x32_bf16 v[200:203], a[44:47], v[124:127], v[200:203]
  v_rcp_f32 v30, v30
  v_rcp_f32 v31, v31
  v_mfma_f32_16x16x32_bf16 v[204:207], a[48:51], v[124:127], v[204:207]
  buffer_load_dwordx4 v[108:111], v89, s[8:11], s47 offen sc1
  v_mul_f32 v28, v28, v68
  v_mul_f32 v29, v29, v69
  v_mfma_f32_16x16x32_bf16 v[144:147], a[52:55], v[128:131], v[144:147]
  v_mul_f32 v30, v30, v70
  v_mul_f32 v31, v31, v71
  v_cvt_pk_bf16_f32 v66, v28, v29
  v_cvt_pk_bf16_f32 v67, v30, v31
  v_mfma_f32_16x16x32_bf16 v[148:151], a[56:59], v[128:131], v[148:151]
  v_permlane32_swap_b32 v64, v66
  v_permlane32_swap_b32 v65, v67
  v_and_b32 v64, -2, v64
  v_mfma_f32_16x16x32_bf16 v[152:155], a[60:63], v[128:131], v[152:155]
  buffer_load_dwordx4 v[112:115], v90, s[8:11], s47 offen sc1
  v_mfma_f32_16x16x32_bf16 v[156:159], a[64:67], v[128:131], v[156:159]
  buffer_store_dwordx4 v[64:67], v12, s[8:11], s42 offen sc1
  v_lshlrev_b32 v48, 16, v252
  s_waitcnt vmcnt(11)
  v_perm_b32 v49, v244, v243, s59
  v_mfma_f32_16x16x32_bf16 v[160:163], a[52:55], v[132:135], v[160:163]
  buffer_load_dwordx4 v[116:119], v91, s[8:11], s47 offen sc1
  v_perm_b32 v50, v245, v244, s60
  v_perm_b32 v51, v245, v244, s59
  v_mfma_f32_16x16x32_bf16 v[164:167], a[56:59], v[132:135], v[164:167]
  v_perm_b32 v52, v246, v245, s60
  v_perm_b32 v53, v246, v245, s59
  v_perm_b32 v54, v247, v246, s60
  v_perm_b32 v55, v247, v246, s59
  v_mfma_f32_16x16x32_bf16 v[168:171], a[60:63], v[132:135], v[168:171]
  s_add_u32 s48, s33, 4096
  v_lshlrev_b32 v56, 16, v253
  v_perm_b32 v57, v248, v247, s59
  v_perm_b32 v58, v249, v248, s60
  v_perm_b32 v59, v249, v248, s59
  v_mfma_f32_16x16x32_bf16 v[172:175], a[64:67], v[132:135], v[172:175]
  buffer_load_dwordx4 a[176:179], v4, s[8:11], s48 offen offset:0 sc1
  v_perm_b32 v60, v250, v249, s60
  v_perm_b32 v61, v250, v249, s59
  v_mfma_f32_16x16x32_bf16 v[176:179], a[52:55], v[136:139], v[176:179]
  v_perm_b32 v62, v251, v250, s60
  v_perm_b32 v63, v251, v250, s59
  v_fma_f32 v48, v48, v255, v254
  v_fma_f32 v49, v49, v255, v254
  v_mfma_f32_16x16x32_bf16 v[180:183], a[56:59], v[136:139], v[180:183]
  v_fma_f32 v50, v50, v255, v254
  v_fma_f32 v51, v51, v255, v254
  v_fma_f32 v52, v52, v255, v254
  v_fma_f32 v53, v53, v255, v254
  v_mfma_f32_16x16x32_bf16 v[184:187], a[60:63], v[136:139], v[184:187]
  buffer_load_dwordx4 a[180:183], v4, s[8:11], s48 offen offset:1024 sc1
  v_fma_f32 v54, v54, v255, v254
  v_fma_f32 v55, v55, v255, v254
  v_mfma_f32_16x16x32_bf16 v[188:191], a[64:67], v[136:139], v[188:191]
  v_bitop3_b32 v21, v208, v212, v216 bitop3:0xfe
  v_bitop3_b32 v21, v21, v220, 1 bitop3:0xa8
  v_cmp_ne_u32 vcc, 0, v21
  v_fma_f32 v56, v56, v255, v254
  v_mfma_f32_16x16x32_bf16 v[192:195], a[52:55], v[140:143], v[192:195]
  s_cbranch_vccnz k_hs0_3
k_hb0_3:
  v_fma_f32 v57, v57, v255, v254
  v_fma_f32 v58, v58, v255, v254
  v_fma_f32 v59, v59, v255, v254
  v_fma_f32 v60, v60, v255, v254
  v_mfma_f32_16x16x32_bf16 v[196:199], a[56:59], v[140:143], v[196:199]
  buffer_load_dwordx4 a[184:187], v4, s[8:11], s48 offen offset:2048 sc1
  v_fma_f32 v61, v61, v255, v254
  v_fma_f32 v62, v62, v255, v254
  v_mfma_f32_16x16x32_bf16 v[200:203], a[60:63], v[140:143], v[200:203]
  v_fma_f32 v63, v63, v255, v254
  v_mul_u32_u24 v94, s61, v2
  v_mad_u32_u24 v94, v3, s63, v94
  v_add_u32 v94, s55, v94
  v_mfma_f32_16x16x32_bf16 v[204:207], a[64:67], v[140:143], v[204:207]
  v_add_u32 v95, 1, v3
  v_lshrrev_b32 v95, 2, v95
  v_lshl_add_u32 v95, v95, 31, v94
  v_lshl_add_u32 v95, s63, 2, v95
  v_mfma_f32_16x16x32_bf16 v[144:147], a[68:71], v[208:211], v[144:147]
  buffer_load_dwordx4 a[188:191], v4, s[8:11], s48 offen offset:3072 sc1
  v_add_u32 v47, s39, v4
  v_mfma_f32_16x16x32_bf16 v[148:151], a[72:75], v[208:211], v[148:151]
  s_add_u32 s49, s33, 8192
  v_mfma_f32_16x16x32_bf16 v[152:155], a[76:79], v[208:211], v[152:155]
  ds_read_b128 a[112:115], v13 offset:0
  v_mfma_f32_16x16x32_bf16 v[156:159], a[80:83], v[208:211], v[156:159]
  ds_read_b128 a[116:119], v13 offset:4096
  v_mfma_f32_16x16x32_bf16 v[160:163], a[68:71], v[212:215], v[160:163]
  ds_read_b128 a[120:123], v13 offset:8192
  v_mfma_f32_16x16x32_bf16 v[164:167], a[72:75], v[212:215], v[164:167]
  ds_read_b128 a[124:127], v13 offset:12288
  v_mfma_f32_16x16x32_bf16 v[168:171], a[76:79], v[212:215], v[168:171]
  buffer_load_dwordx4 a[192:195], v4, s[8:11], s49 offen offset:0 sc1
  v_mfma_f32_16x16x32_bf16 v[172:175], a[80:83], v[212:215], v[172:175]
  buffer_load_dwordx4 a[196:199], v4, s[8:11], s49 offen offset:1024 sc1
  v_mfma_f32_16x16x32_bf16 v[176:179], a[68:71], v[216:219], v[176:179]
  buffer_load_dwordx4 a[200:203], v4, s[8:11], s49 offen offset:2048 sc1
  v_mfma_f32_16x16x32_bf16 v[180:183], a[72:75], v[216:219], v[180:183]
  s_xor_b32 s34, s20, 1
  v_mfma_f32_16x16x32_bf16 v[184:187], a[76:79], v[216:219], v[184:187]
  s_add_u32 s46, s43, 16384
  v_mfma_f32_16x16x32_bf16 v[188:191], a[80:83], v[216:219], v[188:191]
  v_bitop3_b32 v21, v224, v228, v232 bitop3:0xfe
  v_bitop3_b32 v21, v21, v236, 1 bitop3:0xa8
  v_cmp_ne_u32 vcc, 0, v21
  v_mfma_f32_16x16x32_bf16 v[192:195], a[68:71], v[220:223], v[192:195]
  s_cbranch_vccnz k_hs0_4
k_hb0_4:
  buffer_load_dwordx4 v[120:123], v88, s[8:11], s46 offen sc1
  v_mfma_f32_16x16x32_bf16 v[196:199], a[72:75], v[220:223], v[196:199]
  s_mul_i32 s34, s34, 14336
  v_add_u32 v44, s34, v4
  v_mfma_f32_16x16x32_bf16 v[200:203], a[76:79], v[220:223], v[200:203]
  buffer_load_dwordx4 v[124:127], v89, s[8:11], s46 offen sc1
  v_mfma_f32_16x16x32_bf16 v[204:207], a[80:83], v[220:223], v[204:207]
  s_xor_b32 s34, s20, 2
  s_waitcnt lgkmcnt(3)
  v_mfma_f32_16x16x32_bf16 v[144:147], a[112:115], v[224:227], v[144:147]
  buffer_load_dwordx4 v[128:131], v90, s[8:11], s46 offen sc1
  s_waitcnt lgkmcnt(2)
  v_mfma_f32_16x16x32_bf16 v[148:151], a[116:119], v[224:227], v[148:151]
  s_mul_i32 s34, s34, 14336
  v_add_u32 v45, s34, v4
  s_waitcnt lgkmcnt(1)
  v_mfma_f32_16x16x32_bf16 v[152:155], a[120:123], v[224:227], v[152:155]
  s_waitcnt lgkmcnt(0)
  ds_read_b128 a[128:131], v13 offset:16384
  v_mfma_f32_16x16x32_bf16 v[156:159], a[124:127], v[224:227], v[156:159]
  ds_read_b128 a[132:135], v13 offset:20480
  v_mfma_f32_16x16x32_bf16 v[160:163], a[112:115], v[228:231], v[160:163]
  ds_read_b128 a[136:139], v13 offset:24576
  v_mfma_f32_16x16x32_bf16 v[164:167], a[116:119], v[228:231], v[164:167]
  ds_read_b128 a[140:143], v13 offset:28672
  v_mfma_f32_16x16x32_bf16 v[168:171], a[120:123], v[228:231], v[168:171]
  buffer_load_dwordx4 v[132:135], v91, s[8:11], s46 offen sc1
  v_mfma_f32_16x16x32_bf16 v[172:175], a[124:127], v[228:231], v[172:175]
  s_add_u32 s47, s43, 1851392
  buffer_load_dwordx4 v[136:139], v88, s[8:11], s47 offen sc1
  v_mfma_f32_16x16x32_bf16 v[176:179], a[112:115], v[232:235], v[176:179]
  s_xor_b32 s34, s20, 3
  v_mfma_f32_16x16x32_bf16 v[180:183], a[116:119], v[232:235], v[180:183]
  buffer_load_dwordx4 v[140:143], v89, s[8:11], s47 offen sc1
  v_mfma_f32_16x16x32_bf16 v[184:187], a[120:123], v[232:235], v[184:187]
  s_mul_i32 s34, s34, 14336
  v_add_u32 v46, s34, v4
  v_mfma_f32_16x16x32_bf16 v[188:191], a[124:127], v[232:235], v[188:191]
  s_waitcnt vmcnt(23)
  v_bitop3_b32 v21, v240, v32, v36 bitop3:0xfe
  s_waitcnt vmcnt(22)
  v_bitop3_b32 v21, v21, v40, 1 bitop3:0xa8
  v_mfma_f32_16x16x32_bf16 v[192:195], a[112:115], v[236:239], v[192:195]
  v_cmp_ne_u32 vcc, 0, v21
  v_mfma_f32_16x16x32_bf16 v[196:199], a[116:119], v[236:239], v[196:199]
  s_cbranch_vccnz k_hs0_5
k_hb0_5:
  v_mfma_f32_16x16x32_bf16 v[200:203], a[120:123], v[236:239], v[200:203]
  buffer_load_dwordx4 v[208:211], v90, s[8:11], s47 offen sc1
  v_mfma_f32_16x16x32_bf16 v[204:207], a[124:127], v[236:239], v[204:207]
  buffer_load_dwordx4 v[212:215], v91, s[8:11], s47 offen sc1
  s_waitcnt lgkmcnt(3)
  v_mfma_f32_16x16x32_bf16 v[144:147], a[128:131], v[240:243], v[144:147]
  s_add_u32 s48, s43, 20480
  s_waitcnt lgkmcnt(2)
  v_mfma_f32_16x16x32_bf16 v[148:151], a[132:135], v[240:243], v[148:151]
  buffer_load_dwordx4 v[216:219], v88, s[8:11], s48 offen sc1
  s_waitcnt lgkmcnt(1)
  v_mfma_f32_16x16x32_bf16 v[152:155], a[136:139], v[240:243], v[152:155]
  s_waitcnt lgkmcnt(0)
  ds_read_b128 a[144:147], v13 offset:32768
  v_mfma_f32_16x16x32_bf16 v[156:159], a[140:143], v[240:243], v[156:159]
  v_mfma_f32_16x16x32_bf16 v[160:163], a[128:131], v[32:35], v[160:163]
  buffer_load_dwordx4 v[220:223], v89, s[8:11], s48 offen sc1
  v_mfma_f32_16x16x32_bf16 v[164:167], a[132:135], v[32:35], v[164:167]
  v_mfma_f32_16x16x32_bf16 v[168:171], a[136:139], v[32:35], v[168:171]
  v_mfma_f32_16x16x32_bf16 v[172:175], a[140:143], v[32:35], v[172:175]
  buffer_load_dwordx4 v[224:227], v90, s[8:11], s48 offen sc1
  v_mfma_f32_16x16x32_bf16 v[176:179], a[128:131], v[36:39], v[176:179]
  v_mfma_f32_16x16x32_bf16 v[180:183], a[132:135], v[36:39], v[180:183]
  v_mfma_f32_16x16x32_bf16 v[184:187], a[136:139], v[36:39], v[184:187]
  buffer_load_dwordx4 v[228:231], v91, s[8:11], s48 offen sc1
  v_mfma_f32_16x16x32_bf16 v[188:191], a[140:143], v[36:39], v[188:191]
  s_waitcnt vmcnt(25)
  v_bitop3_b32 v21, v96, v72, v76 bitop3:0xfe
  s_waitcnt vmcnt(24)
  v_bitop3_b32 v21, v21, v100, 1 bitop3:0xa8
  v_mfma_f32_16x16x32_bf16 v[192:195], a[128:131], v[40:43], v[192:195]
  v_cmp_ne_u32 vcc, 0, v21
  v_mfma_f32_16x16x32_bf16 v[196:199], a[132:135], v[40:43], v[196:199]
  s_cbranch_vccnz k_hs0_6
k_hb0_6:
  v_mfma_f32_16x16x32_bf16 v[200:203], a[136:139], v[40:43], v[200:203]
  buffer_load_dwordx4 a[204:207], v4, s[8:11], s49 offen offset:3072 sc1
  v_mfma_f32_16x16x32_bf16 v[204:207], a[140:143], v[40:43], v[204:207]
  s_add_u32 s49, s43, 1855488
  s_waitcnt lgkmcnt(0)
  v_mfma_f32_16x16x32_bf16 v[144:147], a[144:147], v[96:99], v[144:147]
  buffer_load_dwordx4 v[64:67], v89, s[8:11], s49 offen sc1
  v_mfma_f32_16x16x32_bf16 v[148:151], a[84:87], v[96:99], v[148:151]
  s_add_u32 s46, s33, 12288
  v_mfma_f32_16x16x32_bf16 v[152:155], a[88:91], v[96:99], v[152:155]
  buffer_load_dwordx4 a[208:211], v4, s[8:11], s46 offen offset:0 sc1
  v_mfma_f32_16x16x32_bf16 v[156:159], a[92:95], v[96:99], v[156:159]
  v_mfma_f32_16x16x32_bf16 v[160:163], a[144:147], v[72:75], v[160:163]
  v_mfma_f32_16x16x32_bf16 v[164:167], a[84:87], v[72:75], v[164:167]
  buffer_load_dwordx4 a[212:215], v4, s[8:11], s46 offen offset:1024 sc1
  v_mfma_f32_16x16x32_bf16 v[168:171], a[88:91], v[72:75], v[168:171]
  v_mfma_f32_16x16x32_bf16 v[172:175], a[92:95], v[72:75], v[172:175]
  v_mfma_f32_16x16x32_bf16 v[176:179], a[144:147], v[76:79], v[176:179]
  buffer_load_dwordx4 a[216:219], v4, s[8:11], s46 offen offset:2048 sc1
  v_mfma_f32_16x16x32_bf16 v[180:183], a[84:87], v[76:79], v[180:183]
  v_mfma_f32_16x16x32_bf16 v[184:187], a[88:91], v[76:79], v[184:187]
  buffer_load_dwordx4 a[220:223], v4, s[8:11], s46 offen offset:3072 sc1
  v_mfma_f32_16x16x32_bf16 v[188:191], a[92:95], v[76:79], v[188:191]
  s_waitcnt vmcnt(27)
  v_bitop3_b32 v21, v104, v108, v112 bitop3:0xfe
  s_waitcnt vmcnt(25)
  v_bitop3_b32 v21, v21, v116, 1 bitop3:0xa8
  v_mfma_f32_16x16x32_bf16 v[192:195], a[144:147], v[100:103], v[192:195]
  v_cmp_ne_u32 vcc, 0, v21
  v_mfma_f32_16x16x32_bf16 v[196:199], a[84:87], v[100:103], v[196:199]
  s_cbranch_vccnz k_hs0_7
k_hb0_7:
  v_mfma_f32_16x16x32_bf16 v[200:203], a[88:91], v[100:103], v[200:203]
  s_add_u32 s47, s41, 49152
  v_mfma_f32_16x16x32_bf16 v[204:207], a[92:95], v[100:103], v[204:207]
  buffer_load_dwordx4 a[224:227], v4, s[8:11], s47 offen offset:0 sc1
  v_mfma_f32_16x16x32_bf16 v[144:147], a[96:99], v[104:107], v[144:147]
  buffer_load_dwordx4 a[228:231], v4, s[8:11], s47 offen offset:1024 sc1
  v_mfma_f32_16x16x32_bf16 v[148:151], a[100:103], v[104:107], v[148:151]
  v_mfma_f32_16x16x32_bf16 v[152:155], a[104:107], v[104:107], v[152:155]
  s_add_u32 s48, s43, 24576
  v_mfma_f32_16x16x32_bf16 v[156:159], a[108:111], v[104:107], v[156:159]
  buffer_load_dwordx4 v[68:71], v89, s[8:11], s48 offen sc1
  v_mfma_f32_16x16x32_bf16 v[160:163], a[96:99], v[108:111], v[160:163]
  v_mfma_f32_16x16x32_bf16 v[164:167], a[100:103], v[108:111], v[164:167]
  s_add_u32 s49, s43, 1859584
  v_mfma_f32_16x16x32_bf16 v[168:171], a[104:107], v[108:111], v[168:171]
  buffer_load_dwordx4 v[80:83], v89, s[8:11], s49 offen sc1
  v_mfma_f32_16x16x32_bf16 v[172:175], a[108:111], v[108:111], v[172:175]
  s_add_u32 s46, s43, 1855488
  v_mfma_f32_16x16x32_bf16 v[176:179], a[96:99], v[112:115], v[176:179]
  buffer_load_dwordx4 v[84:87], v90, s[8:11], s46 offen sc1
  v_mfma_f32_16x16x32_bf16 v[180:183], a[100:103], v[112:115], v[180:183]
  v_mfma_f32_16x16x32_bf16 v[184:187], a[104:107], v[112:115], v[184:187]
  v_mfma_f32_16x16x32_bf16 v[188:191], a[108:111], v[112:115], v[188:191]
  s_waitcnt vmcnt(20)
  v_bitop3_b32 v21, v120, v124, v128 bitop3:0xfe
  s_waitcnt vmcnt(19)
  v_bitop3_b32 v21, v21, v132, 1 bitop3:0xa8
  v_mfma_f32_16x16x32_bf16 v[192:195], a[96:99], v[116:119], v[192:195]
  v_cmp_ne_u32 vcc, 0, v21
  v_mfma_f32_16x16x32_bf16 v[196:199], a[100:103], v[116:119], v[196:199]
  s_cbranch_vccnz k_hs0_8
k_hb0_8:
  v_mfma_f32_16x16x32_bf16 v[200:203], a[104:107], v[116:119], v[200:203]
  buffer_load_dwordx4 a[232:235], v4, s[8:11], s47 offen offset:2048 sc1
  v_mfma_f32_16x16x32_bf16 v[204:207], a[108:111], v[116:119], v[204:207]
  buffer_load_dwordx4 a[236:239], v4, s[8:11], s47 offen offset:3072 sc1
  v_mfma_f32_16x16x32_bf16 v[144:147], a[160:163], v[120:123], v[144:147]
  s_add_u32 s47, s41, 53248
  v_mfma_f32_16x16x32_bf16 v[148:151], a[164:167], v[120:123], v[148:151]
  buffer_load_dwordx4 a[240:243], v4, s[8:11], s47 offen offset:0 sc1
  v_mfma_f32_16x16x32_bf16 v[152:155], a[168:171], v[120:123], v[152:155]
  v_mfma_f32_16x16x32_bf16 v[156:159], a[172:175], v[120:123], v[156:159]
  v_mfma_f32_16x16x32_bf16 v[160:163], a[160:163], v[124:127], v[160:163]
  buffer_load_dwordx4 a[244:247], v4, s[8:11], s47 offen offset:1024 sc1
  v_mfma_f32_16x16x32_bf16 v[164:167], a[164:167], v[124:127], v[164:167]
  v_mfma_f32_16x16x32_bf16 v[168:171], a[168:171], v[124:127], v[168:171]
  buffer_load_dwordx4 a[248:251], v4, s[8:11], s47 offen offset:2048 sc1
  v_mfma_f32_16x16x32_bf16 v[172:175], a[172:175], v[124:127], v[172:175]
  v_mfma_f32_16x16x32_bf16 v[176:179], a[160:163], v[128:131], v[176:179]
  v_mfma_f32_16x16x32_bf16 v[180:183], a[164:167], v[128:131], v[180:183]
  buffer_load_dwordx4 v[232:235], v90, s[8:11], s48 offen sc1
  v_mfma_f32_16x16x32_bf16 v[184:187], a[168:171], v[128:131], v[184:187]
  v_mfma_f32_16x16x32_bf16 v[188:191], a[172:175], v[128:131], v[188:191]
  s_waitcnt vmcnt(22)
  v_bitop3_b32 v21, v136, v140, v208 bitop3:0xfe
  s_waitcnt vmcnt(21)
  v_bitop3_b32 v21, v21, v212, 1 bitop3:0xa8
  v_mfma_f32_16x16x32_bf16 v[192:195], a[160:163], v[132:135], v[192:195]
  v_cmp_ne_u32 vcc, 0, v21
  v_mfma_f32_16x16x32_bf16 v[196:199], a[164:167], v[132:135], v[196:199]
  s_cbranch_vccnz k_hs0_9
k_hb0_9:
  v_mfma_f32_16x16x32_bf16 v[200:203], a[168:171], v[132:135], v[200:203]
  buffer_load_dwordx4 v[236:239], v90, s[8:11], s49 offen sc1
  v_mfma_f32_16x16x32_bf16 v[204:207], a[172:175], v[132:135], v[204:207]
  buffer_load_dwordx4 v[240:243], v91, s[8:11], s46 offen sc1
  v_mfma_f32_16x16x32_bf16 v[144:147], a[176:179], v[136:139], v[144:147]
  v_mfma_f32_16x16x32_bf16 v[148:151], a[180:183], v[136:139], v[148:151]
  v_mfma_f32_16x16x32_bf16 v[152:155], a[184:187], v[136:139], v[152:155]
  buffer_load_dwordx4 v[32:35], v91, s[8:11], s48 offen sc1
  v_mfma_f32_16x16x32_bf16 v[156:159], a[188:191], v[136:139], v[156:159]
  v_mfma_f32_16x16x32_bf16 v[160:163], a[176:179], v[140:143], v[160:163]
  buffer_load_dwordx4 a[252:255], v4, s[8:11], s47 offen offset:3072 sc1
  v_mfma_f32_16x16x32_bf16 v[164:167], a[180:183], v[140:143], v[164:167]
  v_mfma_f32_16x16x32_bf16 v[168:171], a[184:187], v[140:143], v[168:171]
  v_mfma_f32_16x16x32_bf16 v[172:175], a[188:191], v[140:143], v[172:175]
  buffer_load_dwordx4 v[36:39], v91, s[8:11], s49 offen sc1
  v_mfma_f32_16x16x32_bf16 v[176:179], a[176:179], v[208:211], v[176:179]
  v_mfma_f32_16x16x32_bf16 v[180:183], a[180:183], v[208:211], v[180:183]
  v_mfma_f32_16x16x32_bf16 v[184:187], a[184:187], v[208:211], v[184:187]
  buffer_load_dwordx4 v[40:43], v88, s[8:11], s46 offen sc1
  v_mfma_f32_16x16x32_bf16 v[188:191], a[188:191], v[208:211], v[188:191]
  s_waitcnt vmcnt(24)
  v_bitop3_b32 v21, v216, v220, v224 bitop3:0xfe
  s_waitcnt vmcnt(23)
  v_bitop3_b32 v21, v21, v228, 1 bitop3:0xa8
  v_mfma_f32_16x16x32_bf16 v[192:195], a[176:179], v[212:215], v[192:195]
  v_cmp_ne_u32 vcc, 0, v21
  v_mfma_f32_16x16x32_bf16 v[196:199], a[180:183], v[212:215], v[196:199]
  s_cbranch_vccnz k_hs0_10
k_hb0_10:
  v_mfma_f32_16x16x32_bf16 v[200:203], a[184:187], v[212:215], v[200:203]
  buffer_load_dwordx4 v[96:99], v88, s[8:11], s48 offen sc1
  v_mfma_f32_16x16x32_bf16 v[204:207], a[188:191], v[212:215], v[204:207]
  v_mfma_f32_16x16x32_bf16 v[144:147], a[192:195], v[216:219], v[144:147]
  buffer_load_dwordx4 v[72:75], v88, s[8:11], s49 offen sc1
  v_mfma_f32_16x16x32_bf16 v[148:151], a[196:199], v[216:219], v[148:151]
  v_mfma_f32_16x16x32_bf16 v[152:155], a[200:203], v[216:219], v[152:155]
  s_waitcnt vmcnt(24)
  v_mfma_f32_16x16x32_bf16 v[156:159], a[204:207], v[216:219], v[156:159]
  v_mfma_f32_16x16x32_bf16 v[160:163], a[192:195], v[220:223], v[160:163]
  v_mfma_f32_16x16x32_bf16 v[164:167], a[196:199], v[220:223], v[164:167]
  v_mfma_f32_16x16x32_bf16 v[168:171], a[200:203], v[220:223], v[168:171]
  v_mfma_f32_16x16x32_bf16 v[172:175], a[204:207], v[220:223], v[172:175]
  v_mfma_f32_16x16x32_bf16 v[176:179], a[192:195], v[224:227], v[176:179]
  v_mfma_f32_16x16x32_bf16 v[180:183], a[196:199], v[224:227], v[180:183]
  v_mfma_f32_16x16x32_bf16 v[184:187], a[200:203], v[224:227], v[184:187]
  v_mfma_f32_16x16x32_bf16 v[188:191], a[204:207], v[224:227], v[188:191]
  s_waitcnt vmcnt(15)
  v_bitop3_b32 v21, v64, v68, v80 bitop3:0xfe
  s_waitcnt vmcnt(14)
  v_bitop3_b32 v21, v21, v84, 1 bitop3:0xa8
  v_mfma_f32_16x16x32_bf16 v[192:195], a[192:195], v[228:231], v[192:195]
  v_cmp_ne_u32 vcc, 0, v21
  v_mfma_f32_16x16x32_bf16 v[196:199], a[196:199], v[228:231], v[196:199]
  s_cbranch_vccnz k_hs0_11
k_hb0_11:
  v_mfma_f32_16x16x32_bf16 v[200:203], a[200:203], v[228:231], v[200:203]
  v_mfma_f32_16x16x32_bf16 v[204:207], a[204:207], v[228:231], v[204:207]
  v_mfma_f32_16x16x32_bf16 v[160:163], a[208:211], v[64:67], v[160:163]
  v_mfma_f32_16x16x32_bf16 v[164:167], a[212:215], v[64:67], v[164:167]
  v_mfma_f32_16x16x32_bf16 v[168:171], a[216:219], v[64:67], v[168:171]
  v_mfma_f32_16x16x32_bf16 v[172:175], a[220:223], v[64:67], v[172:175]
  v_mfma_f32_16x16x32_bf16 v[160:163], a[224:227], v[68:71], v[160:163]
  v_mfma_f32_16x16x32_bf16 v[164:167], a[228:231], v[68:71], v[164:167]
  s_waitcnt vmcnt(13)
  v_mfma_f32_16x16x32_bf16 v[168:171], a[232:235], v[68:71], v[168:171]
  s_waitcnt vmcnt(12)
  v_mfma_f32_16x16x32_bf16 v[172:175], a[236:239], v[68:71], v[172:175]
  s_waitcnt vmcnt(11)
  v_mfma_f32_16x16x32_bf16 v[160:163], a[240:243], v[80:83], v[160:163]
  s_waitcnt vmcnt(10)
  v_mfma_f32_16x16x32_bf16 v[164:167], a[244:247], v[80:83], v[164:167]
  s_waitcnt vmcnt(9)
  v_mfma_f32_16x16x32_bf16 v[168:171], a[248:251], v[80:83], v[168:171]
  s_waitcnt vmcnt(4)
  v_mfma_f32_16x16x32_bf16 v[172:175], a[252:255], v[80:83], v[172:175]
  v_bitop3_b32 v21, v232, v236, v240 bitop3:0xfe
  v_bitop3_b32 v21, v21, v32, 1 bitop3:0xa8
  v_mfma_f32_16x16x32_bf16 v[176:179], a[208:211], v[84:87], v[176:179]
  v_cmp_ne_u32 vcc, 0, v21
  v_mfma_f32_16x16x32_bf16 v[180:183], a[212:215], v[84:87], v[180:183]
  s_cbranch_vccnz k_hs0_12
k_hb0_12:
  v_mfma_f32_16x16x32_bf16 v[184:187], a[216:219], v[84:87], v[184:187]
  ds_write_b128 v44, v[160:163] offset:0
  v_mfma_f32_16x16x32_bf16 v[188:191], a[220:223], v[84:87], v[188:191]
  ds_write_b128 v44, v[164:167] offset:1024
  v_mfma_f32_16x16x32_bf16 v[176:179], a[224:227], v[232:235], v[176:179]
  ds_write_b128 v44, v[168:171] offset:2048
  v_mfma_f32_16x16x32_bf16 v[180:183], a[228:231], v[232:235], v[180:183]
  ds_write_b128 v44, v[172:175] offset:3072
  v_mfma_f32_16x16x32_bf16 v[184:187], a[232:235], v[232:235], v[184:187]
  v_mfma_f32_16x16x32_bf16 v[188:191], a[236:239], v[232:235], v[188:191]
  v_mfma_f32_16x16x32_bf16 v[176:179], a[240:243], v[236:239], v[176:179]
  v_mfma_f32_16x16x32_bf16 v[180:183], a[244:247], v[236:239], v[180:183]
  v_mfma_f32_16x16x32_bf16 v[184:187], a[248:251], v[236:239], v[184:187]
  v_mfma_f32_16x16x32_bf16 v[188:191], a[252:255], v[236:239], v[188:191]
  s_nop 4
  ds_write_b128 v45, v[176:179] offset:4096
  v_mfma_f32_16x16x32_bf16 v[192:195], a[208:211], v[240:243], v[192:195]
  v_mfma_f32_16x16x32_bf16 v[196:199], a[212:215], v[240:243], v[196:199]
  ds_write_b128 v45, v[180:183] offset:5120
  v_mfma_f32_16x16x32_bf16 v[200:203], a[216:219], v[240:243], v[200:203]
  v_mfma_f32_16x16x32_bf16 v[204:207], a[220:223], v[240:243], v[204:207]
  s_waitcnt vmcnt(1)
  v_bitop3_b32 v21, v36, v40, v96 bitop3:0xfe
  s_waitcnt vmcnt(0)
  v_bitop3_b32 v21, v21, v72, 1 bitop3:0xa8
  v_mfma_f32_16x16x32_bf16 v[192:195], a[224:227], v[32:35], v[192:195]
  v_cmp_ne_u32 vcc, 0, v21
  v_mfma_f32_16x16x32_bf16 v[196:199], a[228:231], v[32:35], v[196:199]
  s_cbranch_vccnz k_hs0_13
k_hb0_13:
  v_mfma_f32_16x16x32_bf16 v[200:203], a[232:235], v[32:35], v[200:203]
  ds_write_b128 v45, v[184:187] offset:6144
  v_mfma_f32_16x16x32_bf16 v[204:207], a[236:239], v[32:35], v[204:207]
  ds_write_b128 v45, v[188:191] offset:7168
  v_mfma_f32_16x16x32_bf16 v[192:195], a[240:243], v[36:39], v[192:195]
  v_mfma_f32_16x16x32_bf16 v[196:199], a[244:247], v[36:39], v[196:199]
  v_mfma_f32_16x16x32_bf16 v[200:203], a[248:251], v[36:39], v[200:203]
  v_mfma_f32_16x16x32_bf16 v[204:207], a[252:255], v[36:39], v[204:207]
  s_nop 4
  ds_write_b128 v46, v[192:195] offset:8192
  v_mfma_f32_16x16x32_bf16 v[144:147], a[208:211], v[40:43], v[144:147]
  ds_write_b128 v46, v[196:199] offset:9216
  v_mfma_f32_16x16x32_bf16 v[148:151], a[212:215], v[40:43], v[148:151]
  ds_write_b128 v46, v[200:203] offset:10240
  v_mfma_f32_16x16x32_bf16 v[152:155], a[216:219], v[40:43], v[152:155]
  ds_write_b128 v46, v[204:207] offset:11264
  v_mfma_f32_16x16x32_bf16 v[156:159], a[220:223], v[40:43], v[156:159]
  s_waitcnt lgkmcnt(0)
  v_mfma_f32_16x16x32_bf16 v[144:147], a[224:227], v[96:99], v[144:147]
  s_barrier
  ds_read_b128 v[160:163], v47 offset:0
  ds_read_b128 v[164:167], v47 offset:1024
  v_mfma_f32_16x16x32_bf16 v[148:151], a[228:231], v[96:99], v[148:151]
  ds_read_b128 v[176:179], v47 offset:4096
  ds_read_b128 v[180:183], v47 offset:5120
  v_mfma_f32_16x16x32_bf16 v[152:155], a[232:235], v[96:99], v[152:155]
  ds_read_b128 v[192:195], v47 offset:8192
  ds_read_b128 v[196:199], v47 offset:9216
  v_mfma_f32_16x16x32_bf16 v[156:159], a[236:239], v[96:99], v[156:159]
  ds_read_b128 v[168:171], v47 offset:2048
  ds_read_b128 v[172:175], v47 offset:3072
  v_mfma_f32_16x16x32_bf16 v[144:147], a[240:243], v[72:75], v[144:147]
  ds_read_b128 v[184:187], v47 offset:6144
  ds_read_b128 v[188:191], v47 offset:7168
  v_mfma_f32_16x16x32_bf16 v[148:151], a[244:247], v[72:75], v[148:151]
  ds_read_b128 v[200:203], v47 offset:10240
  ds_read_b128 v[204:207], v47 offset:11264
  v_mfma_f32_16x16x32_bf16 v[152:155], a[248:251], v[72:75], v[152:155]
  v_mfma_f32_16x16x32_bf16 v[156:159], a[252:255], v[72:75], v[156:159]
  s_nop 0
  v_pk_add_f32 v[144:145], v[144:145], v[48:49]
  v_pk_add_f32 v[146:147], v[146:147], v[50:51]
  s_nop 0
  v_pk_add_f32 v[148:149], v[148:149], v[52:53]
  v_pk_add_f32 v[150:151], v[150:151], v[54:55]
  s_nop 0
  v_pk_add_f32 v[152:153], v[152:153], v[56:57]
  v_pk_add_f32 v[154:155], v[154:155], v[58:59]
  v_pk_add_f32 v[156:157], v[156:157], v[60:61]
  v_pk_add_f32 v[158:159], v[158:159], v[62:63]
  s_waitcnt lgkmcnt(11)
  v_pk_add_f32 v[144:145], v[144:145], v[160:161]
  v_pk_add_f32 v[146:147], v[146:147], v[162:163]
  s_waitcnt lgkmcnt(10)
  v_pk_add_f32 v[148:149], v[148:149], v[164:165]
  v_pk_add_f32 v[150:151], v[150:151], v[166:167]
  s_waitcnt lgkmcnt(9)
  v_pk_add_f32 v[144:145], v[144:145], v[176:177]
  v_pk_add_f32 v[146:147], v[146:147], v[178:179]
  s_waitcnt lgkmcnt(8)
  v_pk_add_f32 v[148:149], v[148:149], v[180:181]
  v_pk_add_f32 v[150:151], v[150:151], v[182:183]
  s_waitcnt lgkmcnt(7)
  v_pk_add_f32 v[144:145], v[144:145], v[192:193]
  v_pk_add_f32 v[146:147], v[146:147], v[194:195]
  s_waitcnt lgkmcnt(6)
  v_pk_add_f32 v[148:149], v[148:149], v[196:197]
  v_pk_add_f32 v[150:151], v[150:151], v[198:199]
  v_cvt_pk_bf16_f32 v144, v144, v145
  v_cvt_pk_bf16_f32 v145, v146, v147
  v_cvt_pk_bf16_f32 v146, v148, v149
  v_cvt_pk_bf16_f32 v147, v150, v151
  buffer_store_dwordx4 v[144:147], v94, s[8:11], 0 offen sc1
  s_waitcnt lgkmcnt(5)
  v_pk_add_f32 v[152:153], v[152:153], v[168:169]
  v_pk_add_f32 v[154:155], v[154:155], v[170:171]
  s_waitcnt lgkmcnt(4)
  v_pk_add_f32 v[156:157], v[156:157], v[172:173]
  v_pk_add_f32 v[158:159], v[158:159], v[174:175]
  s_waitcnt lgkmcnt(3)
  v_pk_add_f32 v[152:153], v[152:153], v[184:185]
  v_pk_add_f32 v[154:155], v[154:155], v[186:187]
  s_waitcnt lgkmcnt(2)
  v_pk_add_f32 v[156:157], v[156:157], v[188:189]
  v_pk_add_f32 v[158:159], v[158:159], v[190:191]
  s_waitcnt lgkmcnt(1)
  v_pk_add_f32 v[152:153], v[152:153], v[200:201]
  v_pk_add_f32 v[154:155], v[154:155], v[202:203]
  s_waitcnt lgkmcnt(0)
  v_pk_add_f32 v[156:157], v[156:157], v[204:205]
  v_pk_add_f32 v[158:159], v[158:159], v[206:207]
  v_cvt_pk_bf16_f32 v152, v152, v153
  v_cvt_pk_bf16_f32 v153, v154, v155
  v_cvt_pk_bf16_f32 v154, v156, v157
  v_cvt_pk_bf16_f32 v155, v158, v159
  buffer_store_dwordx4 v[152:155], v95, s[8:11], 0 offen sc1
  s_add_u32 s46, s40, 20480
  buffer_load_dwordx4 a[56:59], v4, s[8:11], s46 offen offset:0 sc1
  buffer_load_dwordx4 a[60:63], v4, s[8:11], s46 offen offset:1024 sc1
  s_add_u32 s47, s40, 8192
  buffer_load_dwordx4 a[64:67], v4, s[8:11], s47 offen offset:0 sc1
  buffer_load_dwordx4 a[68:71], v4, s[8:11], s47 offen offset:1024 sc1
  s_add_u32 s48, s40, 16384
  buffer_load_dwordx4 a[72:75], v4, s[8:11], s48 offen offset:2048 sc1
  buffer_load_dwordx4 a[76:79], v4, s[8:11], s48 offen offset:3072 sc1
  buffer_load_dwordx4 a[80:83], v4, s[8:11], s47 offen offset:2048 sc1
  buffer_load_dwordx4 a[84:87], v4, s[8:11], s47 offen offset:3072 sc1
  v_cvt_f32_u32 v32, v2
  v_add_u32 v33, s30, v2
  v_and_b32 v34, 1, v3
  v_and_b32 v35, 1, v2
  v_and_b32 v36, 1, v33
  v_cvt_f32_u32 v33, v33
  v_cvt_f32_u32 v40, v3
  s_mov_b32 s35, 0x80008000
  v_mul_lo_u32 v34, v34, s35
  v_mul_lo_u32 v35, v35, s35
  v_mul_lo_u32 v36, v36, s35
  v_mul_f32 v32, 0x3d000000, v32
  v_mul_f32 v33, 0xbd000000, v33
  v_add_f32 v41, 4.0, v40
  v_add_f32 v42, 4.0, v41
  v_add_f32 v43, 4.0, v42
  v_mul_f32 v44, v32, v40
  v_mul_f32 v45, v32, v41
  v_mul_f32 v46, v32, v42
  v_mul_f32 v47, v32, v43
  v_fract_f32 v44, v44
  v_fract_f32 v45, v45
  v_fract_f32 v46, v46
  v_fract_f32 v47, v47
  v_sin_f32 v48, v44
  v_cos_f32 v44, v44
  v_sin_f32 v49, v45
  v_cos_f32 v45, v45
  v_sin_f32 v50, v46
  v_cos_f32 v46, v46
  v_sin_f32 v51, v47
  v_cos_f32 v47, v47
  v_cvt_pk_bf16_f32 v64, v44, v48
  v_cvt_pk_bf16_f32 v65, v45, v49
  v_cvt_pk_bf16_f32 v66, v46, v50
  v_cvt_pk_bf16_f32 v67, v47, v51
  v_xor_b32 v68, v35, v64
  v_xor_b32 v69, v35, v65
  v_xor_b32 v70, v35, v66
  v_xor_b32 v71, v35, v67
  v_xor_b32 v72, v34, v64
  v_xor_b32 v73, v34, v65
  v_xor_b32 v74, v34, v66
  v_xor_b32 v75, v34, v67
  v_xor_b32 v76, v34, v68
  v_xor_b32 v77, v34, v69
  v_xor_b32 v78, v34, v70
  v_xor_b32 v79, v34, v71
  v_mul_f32 v44, v33, v40
  v_mul_f32 v45, v33, v41
  v_mul_f32 v46, v33, v42
  v_mul_f32 v47, v33, v43
  v_fract_f32 v44, v44
  v_fract_f32 v45, v45
  v_fract_f32 v46, v46
  v_fract_f32 v47, v47
  v_sin_f32 v48, v44
  v_cos_f32 v44, v44
  v_sin_f32 v49, v45
  v_cos_f32 v45, v45
  v_sin_f32 v50, v46
  v_cos_f32 v46, v46
  v_sin_f32 v51, v47
  v_cos_f32 v47, v47
  v_cvt_pk_bf16_f32 v80, v44, v48
  v_cvt_pk_bf16_f32 v81, v45, v49
  v_cvt_pk_bf16_f32 v82, v46, v50
  v_cvt_pk_bf16_f32 v83, v47, v51
  v_xor_b32 v84, v36, v80
  v_xor_b32 v85, v36, v81
  v_xor_b32 v86, v36, v82
  v_xor_b32 v87, v36, v83
  v_xor_b32 v88, v34, v80
  v_xor_b32 v89, v34, v81
  v_xor_b32 v90, v34, v82
  v_xor_b32 v91, v34, v83
  v_xor_b32 v92, v34, v84
  v_xor_b32 v93, v34, v85
  v_xor_b32 v94, v34, v86
  v_xor_b32 v95, v34, v87
  s_mov_b32 s3, 1
  s_mov_b32 s100, 2048
  s_mov_b32 s101, 0x4000
  s_mov_b32 s4, s8
  s_mov_b32 s5, s9
  s_mov_b32 s6, s10
  s_add_u32 s36, s36, 0x200000
  s_add_u32 s37, s37, 0x200000
  s_lshl_b32 s55, s24, 10
  s_add_u32 s55, s55, s27
  s_mul_i32 s55, s55, 896
  s_mul_i32 s35, s22, 112
  s_add_u32 s55, s55, s35
  s_mov_b32 s61, 57344
  s_mov_b32 s63, 16
k_l2:
  s_lshl_b32 s0, s23, 5
  s_add_u32 s0, s0, s32
  s_lshl_b32 s0, s0, 1
  s_add_u32 s0, s0, s24
  s_mul_i32 s0, s0, 14336
  s_add_u32 s0, s0, 0x8c0000
  s_cmp_ge_u32 s2, 224
  s_cselect_b32 s0, s29, s0
  s_mov_b32 s1, s29
  v_mov_b32 v60, v4
  v_add_u32 v61, 1024, v4
  v_lshlrev_b32 v28, 7, v1
  v_add_u32 v29, 6144, v28
  v_min_u32 v28, 1, v1
  v_mul_u32_u24 v28, 7168, v28
  v_add_u32 v28, 7152, v28
  s_mov_b32 s68, 0
k_pr:
  buffer_load_dword v30, v28, s[8:11], s0 offen sc1
  s_add_u32 s68, s68, 1
  s_waitcnt vmcnt(0)
  v_cmp_eq_u32 vcc, -1, v30
  s_cmp_ge_u32 s68, 0x20000
  s_cbranch_scc1 k_pr_go
  s_nop 2
  s_cbranch_vccnz k_pr
k_pr_go:
  s_cmp_ge_u32 s2, 224
  s_cbranch_scc1 k_res
  buffer_load_dwordx4 a[0:3], v4, s[8:11], s0 offen offset:0 sc1
  buffer_load_dwordx4 a[4:7], v4, s[8:11], s0 offen offset:1024 sc1
  buffer_load_dwordx4 a[8:11], v4, s[8:11], s0 offen offset:2048 sc1
  buffer_load_dwordx4 a[12:15], v4, s[8:11], s0 offen offset:3072 sc1
  s_add_u32 s0, s0, 4096
  buffer_load_dwordx4 a[16:19], v4, s[8:11], s0 offen offset:0 sc1
  buffer_load_dwordx4 a[20:23], v4, s[8:11], s0 offen offset:1024 sc1
  buffer_load_dwordx4 a[24:27], v4, s[8:11], s0 offen offset:2048 sc1
  buffer_load_dwordx4 a[28:31], v4, s[8:11], s0 offen offset:3072 sc1
  s_add_u32 s0, s0, 4096
  buffer_load_dwordx4 a[32:35], v4, s[8:11], s0 offen offset:0 sc1
  buffer_load_dwordx4 a[36:39], v4, s[8:11], s0 offen offset:1024 sc1
  buffer_load_dwordx4 a[40:43], v4, s[8:11], s0 offen offset:2048 sc1
  buffer_load_dwordx4 a[44:47], v4, s[8:11], s0 offen offset:3072 sc1
  s_add_u32 s0, s0, 4096
  buffer_load_dwordx4 a[48:51], v4, s[8:11], s0 offen offset:0 sc1
  buffer_load_dwordx4 a[52:55], v4, s[8:11], s0 offen offset:1024 sc1
  s_branch k_kloop
k_p2g:
  s_barrier
  s_add_u32 m0, s39, 0
  s_add_u32 s35, s36, 0
  buffer_load_dwordx4 v4, s[8:11], s35 offen offset:0 sc1 lds
  buffer_load_dwordx4 v4, s[8:11], s35 offen offset:1024 sc1 lds
  s_add_u32 s35, s36, 2048
  buffer_load_dwordx4 v4, s[8:11], s35 offen offset:2048 sc1 lds
  buffer_load_dwordx4 v4, s[8:11], s35 offen offset:3072 sc1 lds
  s_add_u32 m0, s39, 4096
  s_add_u32 s35, s36, 8192
  buffer_load_dwordx4 v4, s[8:11], s35 offen offset:0 sc1 lds
  buffer_load_dwordx4 v4, s[8:11], s35 offen offset:1024 sc1 lds
  s_add_u32 s35, s36, 10240
  buffer_load_dwordx4 v4, s[8:11], s35 offen offset:2048 sc1 lds
  buffer_load_dwordx4 v4, s[8:11], s35 offen offset:3072 sc1 lds
  s_add_u32 m0, s39, 8192
  s_add_u32 s35, s36, 16384
  buffer_load_dwordx4 v4, s[8:11], s35 offen offset:0 sc1 lds
  buffer_load_dwordx4 v4, s[8:11], s35 offen offset:1024 sc1 lds
  s_add_u32 s35, s36, 18432
  buffer_load_dwordx4 v4, s[8:11], s35 offen offset:2048 sc1 lds
  buffer_load_dwordx4 v4, s[8:11], s35 offen offset:3072 sc1 lds
  s_add_u32 m0, s39, 12288
  s_add_u32 s35, s36, 24576
  buffer_load_dwordx4 v4, s[8:11], s35 offen offset:0 sc1 lds
  buffer_load_dwordx4 v4, s[8:11], s35 offen offset:1024 sc1 lds
  s_waitcnt vmcnt(12)
  ds_read2st64_b32 v[208:209], v5 offset0:0 offset1:1
  ds_read2st64_b32 v[210:211], v5 offset0:2 offset1:3
  ds_read2st64_b32 v[212:213], v5 offset0:4 offset1:5
  ds_read2st64_b32 v[214:215], v5 offset0:6 offset1:7
  s_waitcnt lgkmcnt(2)
  v_max3_u32 v44, v208, v209, v210
  s_waitcnt lgkmcnt(1)
  v_max3_u32 v45, v211, v212, v213
  s_waitcnt lgkmcnt(0)
  v_max3_u32 v44, v44, v214, v215
  v_max_u32 v44, v44, v45
  v_cmp_eq_u32 vcc, -1, v44
  s_cbranch_vccnz k_zs0
k_zb0:
  v_mfma_f32_16x16x32_bf16 v[96:99], v[208:211], v[64:67], v[96:99]
  s_waitcnt vmcnt(10)
  ds_read2st64_b32 v[216:217], v5 offset0:8 offset1:9
  ds_read2st64_b32 v[218:219], v5 offset0:10 offset1:11
  ds_read2st64_b32 v[220:221], v5 offset0:12 offset1:13
  ds_read2st64_b32 v[222:223], v5 offset0:14 offset1:15
  v_mfma_f32_16x16x32_bf16 v[100:103], v[208:211], v[72:75], v[100:103]
  v_mfma_f32_16x16x32_bf16 v[104:107], v[208:211], v[80:83], v[104:107]
  v_mfma_f32_16x16x32_bf16 v[108:111], v[208:211], v[88:91], v[108:111]
  v_mfma_f32_16x16x32_bf16 v[96:99], v[212:215], v[68:71], v[96:99]
  v_mfma_f32_16x16x32_bf16 v[100:103], v[212:215], v[76:79], v[100:103]
  v_mfma_f32_16x16x32_bf16 v[104:107], v[212:215], v[84:87], v[104:107]
  v_mfma_f32_16x16x32_bf16 v[108:111], v[212:215], v[92:95], v[108:111]
  s_waitcnt lgkmcnt(2)
  v_max3_u32 v44, v216, v217, v218
  s_waitcnt lgkmcnt(1)
  v_max3_u32 v45, v219, v220, v221
  s_waitcnt lgkmcnt(0)
  v_max3_u32 v44, v44, v222, v223
  v_max_u32 v44, v44, v45
  v_cmp_eq_u32 vcc, -1, v44
  s_cbranch_vccnz k_zs1
k_zb1:
  v_mfma_f32_16x16x32_bf16 v[112:115], v[216:219], v[64:67], v[112:115]
  s_waitcnt vmcnt(8)
  ds_read2st64_b32 v[224:225], v5 offset0:16 offset1:17
  ds_read2st64_b32 v[226:227], v5 offset0:18 offset1:19
  ds_read2st64_b32 v[228:229], v5 offset0:20 offset1:21
  ds_read2st64_b32 v[230:231], v5 offset0:22 offset1:23
  v_mfma_f32_16x16x32_bf16 v[116:119], v[216:219], v[72:75], v[116:119]
  v_mul_f32 v36, v96, v96
  v_mul_f32 v37, v100, v100
  v_mul_f32 v38, v104, v104
  v_mul_f32 v39, v108, v108
  v_mfma_f32_16x16x32_bf16 v[120:123], v[216:219], v[80:83], v[120:123]
  v_add_f32 v32, v96, v97
  v_fmac_f32 v36, v97, v97
  v_add_f32 v33, v100, v101
  v_fmac_f32 v37, v101, v101
  v_mfma_f32_16x16x32_bf16 v[124:127], v[216:219], v[88:91], v[124:127]
  v_add_f32 v34, v104, v105
  v_fmac_f32 v38, v105, v105
  v_add_f32 v35, v108, v109
  v_fmac_f32 v39, v109, v109
  v_mfma_f32_16x16x32_bf16 v[112:115], v[220:223], v[68:71], v[112:115]
  v_add_f32 v32, v32, v98
  v_fmac_f32 v36, v98, v98
  v_add_f32 v33, v33, v102
  v_fmac_f32 v37, v102, v102
  v_mfma_f32_16x16x32_bf16 v[116:119], v[220:223], v[76:79], v[116:119]
  v_add_f32 v34, v34, v106
  v_fmac_f32 v38, v106, v106
  v_add_f32 v35, v35, v110
  v_fmac_f32 v39, v110, v110
  v_mfma_f32_16x16x32_bf16 v[120:123], v[220:223], v[84:87], v[120:123]
  v_add_f32 v32, v32, v99
  v_fmac_f32 v36, v99, v99
  v_add_f32 v33, v33, v103
  v_fmac_f32 v37, v103, v103
  v_mfma_f32_16x16x32_bf16 v[124:127], v[220:223], v[92:95], v[124:127]
  v_add_f32 v34, v34, v107
  v_fmac_f32 v38, v107, v107
  v_add_f32 v35, v35, v111
  v_fmac_f32 v39, v111, v111
  s_add_u32 s46, s40, 4096
  buffer_load_dwordx4 a[32:35], v4, s[8:11], s46 offen offset:0 sc1
  buffer_load_dwordx4 a[36:39], v4, s[8:11], s46 offen offset:1024 sc1
  s_add_u32 s47, s40, 20480
  buffer_load_dwordx4 a[40:43], v4, s[8:11], s47 offen offset:2048 sc1
  s_waitcnt lgkmcnt(2)
  v_max3_u32 v44, v224, v225, v226
  s_waitcnt lgkmcnt(1)
  v_max3_u32 v45, v227, v228, v229
  s_waitcnt lgkmcnt(0)
  v_max3_u32 v44, v44, v230, v231
  v_max_u32 v44, v44, v45
  v_cmp_eq_u32 vcc, -1, v44
  s_cbranch_vccnz k_zs2
k_zb2:
  v_mfma_f32_16x16x32_bf16 v[176:179], v[224:227], v[64:67], v[176:179]
  s_waitcnt vmcnt(9)
  ds_read2st64_b32 v[208:209], v5 offset0:24 offset1:25
  ds_read2st64_b32 v[210:211], v5 offset0:26 offset1:27
  ds_read2st64_b32 v[212:213], v5 offset0:28 offset1:29
  ds_read2st64_b32 v[214:215], v5 offset0:30 offset1:31
  v_mfma_f32_16x16x32_bf16 v[180:183], v[224:227], v[72:75], v[180:183]
  v_add_f32 v32, v32, v112
  v_fmac_f32 v36, v112, v112
  v_add_f32 v33, v33, v116
  v_fmac_f32 v37, v116, v116
  v_mfma_f32_16x16x32_bf16 v[184:187], v[224:227], v[80:83], v[184:187]
  v_add_f32 v34, v34, v120
  v_fmac_f32 v38, v120, v120
  v_add_f32 v35, v35, v124
  v_fmac_f32 v39, v124, v124
  v_mfma_f32_16x16x32_bf16 v[188:191], v[224:227], v[88:91], v[188:191]
  v_add_f32 v32, v32, v113
  v_fmac_f32 v36, v113, v113
  v_add_f32 v33, v33, v117
  v_fmac_f32 v37, v117, v117
  v_mfma_f32_16x16x32_bf16 v[176:179], v[228:231], v[68:71], v[176:179]
  v_add_f32 v34, v34, v121
  v_fmac_f32 v38, v121, v121
  v_add_f32 v35, v35, v125
  v_fmac_f32 v39, v125, v125
  v_mfma_f32_16x16x32_bf16 v[180:183], v[228:231], v[76:79], v[180:183]
  v_add_f32 v32, v32, v114
  v_fmac_f32 v36, v114, v114
  v_add_f32 v33, v33, v118
  v_fmac_f32 v37, v118, v118
  v_mfma_f32_16x16x32_bf16 v[184:187], v[228:231], v[84:87], v[184:187]
  v_add_f32 v34, v34, v122
  v_fmac_f32 v38, v122, v122
  v_add_f32 v35, v35, v126
  v_fmac_f32 v39, v126, v126
  v_mfma_f32_16x16x32_bf16 v[188:191], v[228:231], v[92:95], v[188:191]
  v_add_f32 v32, v32, v115
  v_fmac_f32 v36, v115, v115
  v_add_f32 v33, v33, v119
  v_fmac_f32 v37, v119, v119
  v_add_f32 v34, v34, v123
  v_fmac_f32 v38, v123, v123
  v_add_f32 v35, v35, v127
  v_fmac_f32 v39, v127, v127
  buffer_load_dwordx4 a[44:47], v4, s[8:11], s47 offen offset:3072 sc1
  buffer_load_dwordx4 a[48:51], v4, s[8:11], s46 offen offset:2048 sc1
  buffer_load_dwordx4 a[52:55], v4, s[8:11], s46 offen offset:3072 sc1
  s_waitcnt lgkmcnt(2)
  v_max3_u32 v44, v208, v209, v210
  s_waitcnt lgkmcnt(1)
  v_max3_u32 v45, v211, v212, v213
  s_waitcnt lgkmcnt(0)
  v_max3_u32 v44, v44, v214, v215
  v_max_u32 v44, v44, v45
  v_cmp_eq_u32 vcc, -1, v44
  s_cbranch_vccnz k_zs3
k_zb3:
  v_mfma_f32_16x16x32_bf16 v[128:131], v[208:211], v[64:67], v[128:131]
  s_waitcnt vmcnt(10)
  ds_read2st64_b32 v[216:217], v5 offset0:32 offset1:33
  ds_read2st64_b32 v[218:219], v5 offset0:34 offset1:35
  ds_read2st64_b32 v[220:221], v5 offset0:36 offset1:37
  ds_read2st64_b32 v[222:223], v5 offset0:38 offset1:39
  v_mfma_f32_16x16x32_bf16 v[132:135], v[208:211], v[72:75], v[132:135]
  v_add_f32 v32, v32, v176
  v_fmac_f32 v36, v176, v176
  v_add_f32 v33, v33, v180
  v_fmac_f32 v37, v180, v180
  v_mfma_f32_16x16x32_bf16 v[136:139], v[208:211], v[80:83], v[136:139]
  v_add_f32 v34, v34, v184
  v_fmac_f32 v38, v184, v184
  v_add_f32 v35, v35, v188
  v_fmac_f32 v39, v188, v188
  v_mfma_f32_16x16x32_bf16 v[140:143], v[208:211], v[88:91], v[140:143]
  v_add_f32 v32, v32, v177
  v_fmac_f32 v36, v177, v177
  v_add_f32 v33, v33, v181
  v_fmac_f32 v37, v181, v181
  v_mfma_f32_16x16x32_bf16 v[128:131], v[212:215], v[68:71], v[128:131]
  v_add_f32 v34, v34, v185
  v_fmac_f32 v38, v185, v185
  v_add_f32 v35, v35, v189
  v_fmac_f32 v39, v189, v189
  v_mfma_f32_16x16x32_bf16 v[132:135], v[212:215], v[76:79], v[132:135]
  v_add_f32 v32, v32, v178
  v_fmac_f32 v36, v178, v178
  v_add_f32 v33, v33, v182
  v_fmac_f32 v37, v182, v182
  v_mfma_f32_16x16x32_bf16 v[136:139], v[212:215], v[84:87], v[136:139]
  v_add_f32 v34, v34, v186
  v_fmac_f32 v38, v186, v186
  v_add_f32 v35, v35, v190
  v_fmac_f32 v39, v190, v190
  v_mfma_f32_16x16x32_bf16 v[140:143], v[212:215], v[92:95], v[140:143]
  v_add_f32 v32, v32, v179
  v_fmac_f32 v36, v179, v179
  v_add_f32 v33, v33, v183
  v_fmac_f32 v37, v183, v183
  v_add_f32 v34, v34, v187
  v_fmac_f32 v38, v187, v187
  v_add_f32 v35, v35, v191
  v_fmac_f32 v39, v191, v191
  s_add_u32 s48, s40, 16384
  buffer_load_dwordx4 a[88:91], v4, s[8:11], s48 offen offset:0 sc1
  buffer_load_dwordx4 a[92:95], v4, s[8:11], s48 offen offset:1024 sc1
  s_add_u32 s49, s40, 12288
  buffer_load_dwordx4 a[96:99], v4, s[8:11], s49 offen offset:0 sc1
  s_waitcnt lgkmcnt(2)
  v_max3_u32 v44, v216, v217, v218
  s_waitcnt lgkmcnt(1)
  v_max3_u32 v45, v219, v220, v221
  s_waitcnt lgkmcnt(0)
  v_max3_u32 v44, v44, v222, v223
  v_max_u32 v44, v44, v45
  v_cmp_eq_u32 vcc, -1, v44
  s_cbranch_vccnz k_zs4
k_zb4:
  v_mfma_f32_16x16x32_bf16 v[192:195], v[216:219], v[64:67], v[192:195]
  s_waitcnt vmcnt(11)
  ds_read2st64_b32 v[224:225], v5 offset0:40 offset1:41
  ds_read2st64_b32 v[226:227], v5 offset0:42 offset1:43
  ds_read2st64_b32 v[228:229], v5 offset0:44 offset1:45
  ds_read2st64_b32 v[230:231], v5 offset0:46 offset1:47
  v_mfma_f32_16x16x32_bf16 v[196:199], v[216:219], v[72:75], v[196:199]
  v_add_f32 v32, v32, v128
  v_fmac_f32 v36, v128, v128
  v_add_f32 v33, v33, v132
  v_fmac_f32 v37, v132, v132
  v_mfma_f32_16x16x32_bf16 v[200:203], v[216:219], v[80:83], v[200:203]
  v_add_f32 v34, v34, v136
  v_fmac_f32 v38, v136, v136
  v_add_f32 v35, v35, v140
  v_fmac_f32 v39, v140, v140
  v_mfma_f32_16x16x32_bf16 v[204:207], v[216:219], v[88:91], v[204:207]
  v_add_f32 v32, v32, v129
  v_fmac_f32 v36, v129, v129
  v_add_f32 v33, v33, v133
  v_fmac_f32 v37, v133, v133
  v_mfma_f32_16x16x32_bf16 v[192:195], v[220:223], v[68:71], v[192:195]
  v_add_f32 v34, v34, v137
  v_fmac_f32 v38, v137, v137
  v_add_f32 v35, v35, v141
  v_fmac_f32 v39, v141, v141
  v_mfma_f32_16x16x32_bf16 v[196:199], v[220:223], v[76:79], v[196:199]
  v_add_f32 v32, v32, v130
  v_fmac_f32 v36, v130, v130
  v_add_f32 v33, v33, v134
  v_fmac_f32 v37, v134, v134
  v_mfma_f32_16x16x32_bf16 v[200:203], v[220:223], v[84:87], v[200:203]
  v_add_f32 v34, v34, v138
  v_fmac_f32 v38, v138, v138
  v_add_f32 v35, v35, v142
  v_fmac_f32 v39, v142, v142
  v_mfma_f32_16x16x32_bf16 v[204:207], v[220:223], v[92:95], v[204:207]
  v_add_f32 v32, v32, v131
  v_fmac_f32 v36, v131, v131
  v_add_f32 v33, v33, v135
  v_fmac_f32 v37, v135, v135
  v_add_f32 v34, v34, v139
  v_fmac_f32 v38, v139, v139
  v_add_f32 v35, v35, v143
  v_fmac_f32 v39, v143, v143
  buffer_load_dwordx4 a[100:103], v4, s[8:11], s49 offen offset:1024 sc1
  buffer_load_dwordx4 a[104:107], v4, s[8:11], s49 offen offset:2048 sc1
  buffer_load_dwordx4 a[108:111], v4, s[8:11], s49 offen offset:3072 sc1
  s_waitcnt lgkmcnt(2)
  v_max3_u32 v44, v224, v225, v226
  s_waitcnt lgkmcnt(1)
  v_max3_u32 v45, v227, v228, v229
  s_waitcnt lgkmcnt(0)
  v_max3_u32 v44, v44, v230, v231
  v_max_u32 v44, v44, v45
  v_cmp_eq_u32 vcc, -1, v44
  s_cbranch_vccnz k_zs5
k_zb5:
  v_mfma_f32_16x16x32_bf16 v[144:147], v[224:227], v[64:67], v[144:147]
  s_waitcnt vmcnt(12)
  ds_read2st64_b32 v[208:209], v5 offset0:48 offset1:49
  ds_read2st64_b32 v[210:211], v5 offset0:50 offset1:51
  ds_read2st64_b32 v[212:213], v5 offset0:52 offset1:53
  ds_read2st64_b32 v[214:215], v5 offset0:54 offset1:55
  v_mfma_f32_16x16x32_bf16 v[148:151], v[224:227], v[72:75], v[148:151]
  v_add_f32 v32, v32, v192
  v_fmac_f32 v36, v192, v192
  v_add_f32 v33, v33, v196
  v_fmac_f32 v37, v196, v196
  v_mfma_f32_16x16x32_bf16 v[152:155], v[224:227], v[80:83], v[152:155]
  v_add_f32 v34, v34, v200
  v_fmac_f32 v38, v200, v200
  v_add_f32 v35, v35, v204
  v_fmac_f32 v39, v204, v204
  v_mfma_f32_16x16x32_bf16 v[156:159], v[224:227], v[88:91], v[156:159]
  v_add_f32 v32, v32, v193
  v_fmac_f32 v36, v193, v193
  v_add_f32 v33, v33, v197
  v_fmac_f32 v37, v197, v197
  v_mfma_f32_16x16x32_bf16 v[144:147], v[228:231], v[68:71], v[144:147]
  v_add_f32 v34, v34, v201
  v_fmac_f32 v38, v201, v201
  v_add_f32 v35, v35, v205
  v_fmac_f32 v39, v205, v205
  v_mfma_f32_16x16x32_bf16 v[148:151], v[228:231], v[76:79], v[148:151]
  v_add_f32 v32, v32, v194
  v_fmac_f32 v36, v194, v194
  v_add_f32 v33, v33, v198
  v_fmac_f32 v37, v198, v198
  v_mfma_f32_16x16x32_bf16 v[152:155], v[228:231], v[84:87], v[152:155]
  v_add_f32 v34, v34, v202
  v_fmac_f32 v38, v202, v202
  v_add_f32 v35, v35, v206
  v_fmac_f32 v39, v206, v206
  v_mfma_f32_16x16x32_bf16 v[156:159], v[228:231], v[92:95], v[156:159]
  v_add_f32 v32, v32, v195
  v_fmac_f32 v36, v195, v195
  v_add_f32 v33, v33, v199
  v_fmac_f32 v37, v199, v199
  v_add_f32 v34, v34, v203
  v_fmac_f32 v38, v203, v203
  v_add_f32 v35, v35, v207
  v_fmac_f32 v39, v207, v207
  s_add_u32 s46, s21, 0
  buffer_load_dwordx4 a[112:115], v4, s[8:11], s46 offen offset:0 sc1
  buffer_load_dwordx4 a[116:119], v4, s[8:11], s46 offen offset:1024 sc1
  s_add_u32 s47, s21, 24576
  buffer_load_dwordx4 a[120:123], v4, s[8:11], s47 offen offset:2048 sc1
  s_waitcnt lgkmcnt(2)
  v_max3_u32 v44, v208, v209, v210
  s_waitcnt lgkmcnt(1)
  v_max3_u32 v45, v211, v212, v213
  s_waitcnt lgkmcnt(0)
  v_max3_u32 v44, v44, v214, v215
  v_max_u32 v44, v44, v45
  v_cmp_eq_u32 vcc, -1, v44
  s_cbranch_vccnz k_zs6
k_zb6:
  v_mfma_f32_16x16x32_bf16 v[160:163], v[208:211], v[64:67], v[160:163]
  v_add_f32 v32, v32, v144
  v_fmac_f32 v36, v144, v144
  v_add_f32 v33, v33, v148
  v_fmac_f32 v37, v148, v148
  v_mfma_f32_16x16x32_bf16 v[164:167], v[208:211], v[72:75], v[164:167]
  v_add_f32 v34, v34, v152
  v_fmac_f32 v38, v152, v152
  v_add_f32 v35, v35, v156
  v_fmac_f32 v39, v156, v156
  v_mfma_f32_16x16x32_bf16 v[168:171], v[208:211], v[80:83], v[168:171]
  v_add_f32 v32, v32, v145
  v_fmac_f32 v36, v145, v145
  v_add_f32 v33, v33, v149
  v_fmac_f32 v37, v149, v149
  v_mfma_f32_16x16x32_bf16 v[172:175], v[208:211], v[88:91], v[172:175]
  v_add_f32 v34, v34, v153
  v_fmac_f32 v38, v153, v153
  v_add_f32 v35, v35, v157
  v_fmac_f32 v39, v157, v157
  v_mfma_f32_16x16x32_bf16 v[160:163], v[212:215], v[68:71], v[160:163]
  v_add_f32 v32, v32, v146
  v_fmac_f32 v36, v146, v146
  v_add_f32 v33, v33, v150
  v_fmac_f32 v37, v150, v150
  v_mfma_f32_16x16x32_bf16 v[164:167], v[212:215], v[76:79], v[164:167]
  v_add_f32 v34, v34, v154
  v_fmac_f32 v38, v154, v154
  v_add_f32 v35, v35, v158
  v_fmac_f32 v39, v158, v158
  v_mfma_f32_16x16x32_bf16 v[168:171], v[212:215], v[84:87], v[168:171]
  v_add_f32 v32, v32, v147
  v_fmac_f32 v36, v147, v147
  v_add_f32 v33, v33, v151
  v_fmac_f32 v37, v151, v151
  v_mfma_f32_16x16x32_bf16 v[172:175], v[212:215], v[92:95], v[172:175]
  v_add_f32 v34, v34, v155
  v_fmac_f32 v38, v155, v155
  v_add_f32 v35, v35, v159
  v_fmac_f32 v39, v159, v159
  buffer_load_dwordx4 a[124:127], v4, s[8:11], s47 offen offset:3072 sc1
  buffer_load_dwordx4 a[128:131], v4, s[8:11], s46 offen offset:2048 sc1
  buffer_load_dwordx4 a[132:135], v4, s[8:11], s46 offen offset:3072 sc1
  v_cndmask_b32 v171, v171, v40, s[50:51]
  v_cndmask_b32 v175, v175, v41, s[50:51]
  v_add_f32 v32, v32, v160
  v_fmac_f32 v36, v160, v160
  v_add_f32 v33, v33, v164
  v_fmac_f32 v37, v164, v164
  v_add_f32 v34, v34, v168
  v_fmac_f32 v38, v168, v168
  v_add_f32 v35, v35, v172
  v_fmac_f32 v39, v172, v172
  v_add_f32 v32, v32, v161
  v_fmac_f32 v36, v161, v161
  v_add_f32 v33, v33, v165
  v_fmac_f32 v37, v165, v165
  v_add_f32 v34, v34, v169
  v_fmac_f32 v38, v169, v169
  v_add_f32 v35, v35, v173
  v_fmac_f32 v39, v173, v173
  v_add_f32 v32, v32, v162
  v_fmac_f32 v36, v162, v162
  v_add_f32 v33, v33, v166
  v_fmac_f32 v37, v166, v166
  v_add_f32 v34, v34, v170
  v_fmac_f32 v38, v170, v170
  v_add_f32 v35, v35, v174
  v_fmac_f32 v39, v174, v174
  v_add_f32 v32, v32, v163
  v_fmac_f32 v36, v163, v163
  v_add_f32 v33, v33, v167
  v_fmac_f32 v37, v167, v167
  v_add_f32 v34, v34, v171
  v_fmac_f32 v38, v171, v171
  v_add_f32 v35, v35, v175
  v_fmac_f32 v39, v175, v175
  v_permlane32_swap_b32 v32, v34
  v_permlane32_swap_b32 v33, v35
  v_permlane32_swap_b32 v36, v38
  v_permlane32_swap_b32 v37, v39
  v_add_f32 v32, v32, v34
  v_add_f32 v33, v33, v35
  v_add_f32 v36, v36, v38
  v_add_f32 v37, v37, v39
  v_permlane16_swap_b32 v32, v33
  s_nop 0
  v_permlane16_swap_b32 v36, v37
  v_add_f32 v40, v32, v33
  v_add_f32 v41, v36, v37
  ds_write_b64 v14, v[40:41]
  s_mov_b32 s35, 0x3b124925
  v_mov_b32 v28, 0x3727c5ac
  buffer_load_dwordx4 a[136:139], v4, s[8:11], s47 offen offset:0 sc1
  buffer_load_dwordx4 a[140:143], v4, s[8:11], s47 offen offset:1024 sc1
  s_add_u32 s48, s21, 4096
  buffer_load_dwordx4 a[144:147], v4, s[8:11], s48 offen offset:0 sc1
  s_waitcnt lgkmcnt(0)
  s_barrier
  ds_read_b128 v[44:47], v15
  ds_read_b128 v[48:51], v15 offset:16
  buffer_load_dwordx4 a[148:151], v4, s[8:11], s48 offen offset:1024 sc1
  s_add_u32 s49, s21, 20480
  buffer_load_dwordx4 a[152:155], v4, s[8:11], s49 offen offset:2048 sc1
  buffer_load_dwordx4 a[156:159], v4, s[8:11], s49 offen offset:3072 sc1
  s_waitcnt lgkmcnt(1)
  v_pk_add_f32 v[44:45], v[44:45], v[46:47]
  s_waitcnt lgkmcnt(0)
  v_pk_add_f32 v[48:49], v[48:49], v[50:51]
  v_pk_add_f32 v[44:45], v[44:45], v[48:49]
  v_mul_f32 v44, s35, v44
  v_fma_f32 v45, v45, s35, v28
  v_fma_f32 v45, -v44, v44, v45
  v_rsq_f32 v46, v45
  v_mul_f32 v45, 0xbf317218, v45
  v_mul_f32 v64, 0xbfb8aa3b, v46
  v_mul_f32 v65, -v44, v64
  v_mul_f32 v66, 0xbfb8aa3b, v46
  v_mul_f32 v67, -v44, v64
  v_mul_f32 v45, v45, v46
  v_permlane16_swap_b32 v64, v66
  v_permlane16_swap_b32 v65, v67
  ds_write_b64 v16, v[44:45]
  v_mov_b32 v68, v64
  v_mov_b32 v69, v65
  v_mov_b32 v70, v66
  v_mov_b32 v71, v67
  v_permlane32_swap_b32 v64, v68
  v_permlane32_swap_b32 v65, v69
  v_permlane32_swap_b32 v66, v70
  v_permlane32_swap_b32 v67, v71
  v_pk_fma_f32 v[96:97], v[96:97], v[64:65], v[64:65] op_sel:[0,0,1] op_sel_hi:[1,0,1]
  v_pk_fma_f32 v[98:99], v[98:99], v[64:65], v[64:65] op_sel:[0,0,1] op_sel_hi:[1,0,1]
  v_pk_fma_f32 v[100:101], v[100:101], v[66:67], v[66:67] op_sel:[0,0,1] op_sel_hi:[1,0,1]
  v_pk_fma_f32 v[102:103], v[102:103], v[66:67], v[66:67] op_sel:[0,0,1] op_sel_hi:[1,0,1]
  v_pk_fma_f32 v[104:105], v[104:105], v[68:69], v[68:69] op_sel:[0,0,1] op_sel_hi:[1,0,1]
  v_pk_fma_f32 v[106:107], v[106:107], v[68:69], v[68:69] op_sel:[0,0,1] op_sel_hi:[1,0,1]
  v_pk_fma_f32 v[108:109], v[108:109], v[70:71], v[70:71] op_sel:[0,0,1] op_sel_hi:[1,0,1]
  v_pk_fma_f32 v[110:111], v[110:111], v[70:71], v[70:71] op_sel:[0,0,1] op_sel_hi:[1,0,1]
  v_cvt_pk_bf16_f32 v96, v96, v97
  v_cvt_pk_bf16_f32 v97, v98, v99
  ds_write_b64 v6, v[96:97] offset:0
  v_cvt_pk_bf16_f32 v100, v100, v101
  v_cvt_pk_bf16_f32 v101, v102, v103
  ds_write_b64 v6, v[100:101] offset:14336
  v_cvt_pk_bf16_f32 v105, v105, v104
  v_cvt_pk_bf16_f32 v104, v107, v106
  ds_write_b64 v7, v[104:105] offset:6144
  v_cvt_pk_bf16_f32 v109, v109, v108
  v_cvt_pk_bf16_f32 v108, v111, v110
  ds_write_b64 v7, v[108:109] offset:20480
  v_pk_fma_f32 v[112:113], v[112:113], v[64:65], v[64:65] op_sel:[0,0,1] op_sel_hi:[1,0,1]
  v_pk_fma_f32 v[114:115], v[114:115], v[64:65], v[64:65] op_sel:[0,0,1] op_sel_hi:[1,0,1]
  v_pk_fma_f32 v[116:117], v[116:117], v[66:67], v[66:67] op_sel:[0,0,1] op_sel_hi:[1,0,1]
  v_pk_fma_f32 v[118:119], v[118:119], v[66:67], v[66:67] op_sel:[0,0,1] op_sel_hi:[1,0,1]
  v_pk_fma_f32 v[120:121], v[120:121], v[68:69], v[68:69] op_sel:[0,0,1] op_sel_hi:[1,0,1]
  v_pk_fma_f32 v[122:123], v[122:123], v[68:69], v[68:69] op_sel:[0,0,1] op_sel_hi:[1,0,1]
  v_pk_fma_f32 v[124:125], v[124:125], v[70:71], v[70:71] op_sel:[0,0,1] op_sel_hi:[1,0,1]
  v_pk_fma_f32 v[126:127], v[126:127], v[70:71], v[70:71] op_sel:[0,0,1] op_sel_hi:[1,0,1]
  v_cvt_pk_bf16_f32 v112, v112, v113
  v_cvt_pk_bf16_f32 v113, v114, v115
  ds_write_b64 v6, v[112:113] offset:1024
  v_cvt_pk_bf16_f32 v116, v116, v117
  v_cvt_pk_bf16_f32 v117, v118, v119
  ds_write_b64 v6, v[116:117] offset:15360
  v_cvt_pk_bf16_f32 v121, v121, v120
  v_cvt_pk_bf16_f32 v120, v123, v122
  ds_write_b64 v7, v[120:121] offset:5120
  v_cvt_pk_bf16_f32 v125, v125, v124
  v_cvt_pk_bf16_f32 v124, v127, v126
  ds_write_b64 v7, v[124:125] offset:19456
  v_pk_fma_f32 v[176:177], v[176:177], v[64:65], v[64:65] op_sel:[0,0,1] op_sel_hi:[1,0,1]
  v_pk_fma_f32 v[178:179], v[178:179], v[64:65], v[64:65] op_sel:[0,0,1] op_sel_hi:[1,0,1]
  v_pk_fma_f32 v[180:181], v[180:181], v[66:67], v[66:67] op_sel:[0,0,1] op_sel_hi:[1,0,1]
  v_pk_fma_f32 v[182:183], v[182:183], v[66:67], v[66:67] op_sel:[0,0,1] op_sel_hi:[1,0,1]
  v_pk_fma_f32 v[184:185], v[184:185], v[68:69], v[68:69] op_sel:[0,0,1] op_sel_hi:[1,0,1]
  v_pk_fma_f32 v[186:187], v[186:187], v[68:69], v[68:69] op_sel:[0,0,1] op_sel_hi:[1,0,1]
  v_pk_fma_f32 v[188:189], v[188:189], v[70:71], v[70:71] op_sel:[0,0,1] op_sel_hi:[1,0,1]
  v_pk_fma_f32 v[190:191], v[190:191], v[70:71], v[70:71] op_sel:[0,0,1] op_sel_hi:[1,0,1]
  v_cvt_pk_bf16_f32 v176, v176, v177
  v_cvt_pk_bf16_f32 v177, v178, v179
  ds_write_b64 v6, v[176:177] offset:2048
  v_cvt_pk_bf16_f32 v180, v180, v181
  v_cvt_pk_bf16_f32 v181, v182, v183
  ds_write_b64 v6, v[180:181] offset:16384
  v_cvt_pk_bf16_f32 v185, v185, v184
  v_cvt_pk_bf16_f32 v184, v187, v186
  ds_write_b64 v7, v[184:185] offset:4096
  v_cvt_pk_bf16_f32 v189, v189, v188
  v_cvt_pk_bf16_f32 v188, v191, v190
  ds_write_b64 v7, v[188:189] offset:18432
  v_pk_fma_f32 v[128:129], v[128:129], v[64:65], v[64:65] op_sel:[0,0,1] op_sel_hi:[1,0,1]
  v_pk_fma_f32 v[130:131], v[130:131], v[64:65], v[64:65] op_sel:[0,0,1] op_sel_hi:[1,0,1]
  v_pk_fma_f32 v[132:133], v[132:133], v[66:67], v[66:67] op_sel:[0,0,1] op_sel_hi:[1,0,1]
  v_pk_fma_f32 v[134:135], v[134:135], v[66:67], v[66:67] op_sel:[0,0,1] op_sel_hi:[1,0,1]
  v_pk_fma_f32 v[136:137], v[136:137], v[68:69], v[68:69] op_sel:[0,0,1] op_sel_hi:[1,0,1]
  v_pk_fma_f32 v[138:139], v[138:139], v[68:69], v[68:69] op_sel:[0,0,1] op_sel_hi:[1,0,1]
  v_pk_fma_f32 v[140:141], v[140:141], v[70:71], v[70:71] op_sel:[0,0,1] op_sel_hi:[1,0,1]
  v_pk_fma_f32 v[142:143], v[142:143], v[70:71], v[70:71] op_sel:[0,0,1] op_sel_hi:[1,0,1]
  v_cvt_pk_bf16_f32 v128, v128, v129
  v_cvt_pk_bf16_f32 v129, v130, v131
  ds_write_b64 v6, v[128:129] offset:3072
  v_cvt_pk_bf16_f32 v132, v132, v133
  v_cvt_pk_bf16_f32 v133, v134, v135
  ds_write_b64 v6, v[132:133] offset:17408
  v_cvt_pk_bf16_f32 v137, v137, v136
  v_cvt_pk_bf16_f32 v136, v139, v138
  ds_write_b64 v7, v[136:137] offset:3072
  v_cvt_pk_bf16_f32 v141, v141, v140
  v_cvt_pk_bf16_f32 v140, v143, v142
  ds_write_b64 v7, v[140:141] offset:17408
  v_pk_fma_f32 v[192:193], v[192:193], v[64:65], v[64:65] op_sel:[0,0,1] op_sel_hi:[1,0,1]
  v_pk_fma_f32 v[194:195], v[194:195], v[64:65], v[64:65] op_sel:[0,0,1] op_sel_hi:[1,0,1]
  v_pk_fma_f32 v[196:197], v[196:197], v[66:67], v[66:67] op_sel:[0,0,1] op_sel_hi:[1,0,1]
  v_pk_fma_f32 v[198:199], v[198:199], v[66:67], v[66:67] op_sel:[0,0,1] op_sel_hi:[1,0,1]
  v_pk_fma_f32 v[200:201], v[200:201], v[68:69], v[68:69] op_sel:[0,0,1] op_sel_hi:[1,0,1]
  v_pk_fma_f32 v[202:203], v[202:203], v[68:69], v[68:69] op_sel:[0,0,1] op_sel_hi:[1,0,1]
  v_pk_fma_f32 v[204:205], v[204:205], v[70:71], v[70:71] op_sel:[0,0,1] op_sel_hi:[1,0,1]
  v_pk_fma_f32 v[206:207], v[206:207], v[70:71], v[70:71] op_sel:[0,0,1] op_sel_hi:[1,0,1]
  v_cvt_pk_bf16_f32 v192, v192, v193
  v_cvt_pk_bf16_f32 v193, v194, v195
  ds_write_b64 v6, v[192:193] offset:4096
  v_cvt_pk_bf16_f32 v196, v196, v197
  v_cvt_pk_bf16_f32 v197, v198, v199
  ds_write_b64 v6, v[196:197] offset:18432
  v_cvt_pk_bf16_f32 v201, v201, v200
  v_cvt_pk_bf16_f32 v200, v203, v202
  ds_write_b64 v7, v[200:201] offset:2048
  v_cvt_pk_bf16_f32 v205, v205, v204
  v_cvt_pk_bf16_f32 v204, v207, v206
  ds_write_b64 v7, v[204:205] offset:16384
  v_pk_fma_f32 v[144:145], v[144:145], v[64:65], v[64:65] op_sel:[0,0,1] op_sel_hi:[1,0,1]
  v_pk_fma_f32 v[146:147], v[146:147], v[64:65], v[64:65] op_sel:[0,0,1] op_sel_hi:[1,0,1]
  v_pk_fma_f32 v[148:149], v[148:149], v[66:67], v[66:67] op_sel:[0,0,1] op_sel_hi:[1,0,1]
  v_pk_fma_f32 v[150:151], v[150:151], v[66:67], v[66:67] op_sel:[0,0,1] op_sel_hi:[1,0,1]
  v_pk_fma_f32 v[152:153], v[152:153], v[68:69], v[68:69] op_sel:[0,0,1] op_sel_hi:[1,0,1]
  v_pk_fma_f32 v[154:155], v[154:155], v[68:69], v[68:69] op_sel:[0,0,1] op_sel_hi:[1,0,1]
  v_pk_fma_f32 v[156:157], v[156:157], v[70:71], v[70:71] op_sel:[0,0,1] op_sel_hi:[1,0,1]
  v_pk_fma_f32 v[158:159], v[158:159], v[70:71], v[70:71] op_sel:[0,0,1] op_sel_hi:[1,0,1]
  v_cvt_pk_bf16_f32 v144, v144, v145
  v_cvt_pk_bf16_f32 v145, v146, v147
  ds_write_b64 v6, v[144:145] offset:5120
  v_cvt_pk_bf16_f32 v148, v148, v149
  v_cvt_pk_bf16_f32 v149, v150, v151
  ds_write_b64 v6, v[148:149] offset:19456
  v_cvt_pk_bf16_f32 v153, v153, v152
  v_cvt_pk_bf16_f32 v152, v155, v154
  ds_write_b64 v7, v[152:153] offset:1024
  v_cvt_pk_bf16_f32 v157, v157, v156
  v_cvt_pk_bf16_f32 v156, v159, v158
  ds_write_b64 v7, v[156:157] offset:15360
  v_pk_fma_f32 v[160:161], v[160:161], v[64:65], v[64:65] op_sel:[0,0,1] op_sel_hi:[1,0,1]
  v_pk_fma_f32 v[162:163], v[162:163], v[64:65], v[64:65] op_sel:[0,0,1] op_sel_hi:[1,0,1]
  v_pk_fma_f32 v[164:165], v[164:165], v[66:67], v[66:67] op_sel:[0,0,1] op_sel_hi:[1,0,1]
  v_pk_fma_f32 v[166:167], v[166:167], v[66:67], v[66:67] op_sel:[0,0,1] op_sel_hi:[1,0,1]
  v_pk_fma_f32 v[168:169], v[168:169], v[68:69], v[68:69] op_sel:[0,0,1] op_sel_hi:[1,0,1]
  v_pk_fma_f32 v[170:171], v[170:171], v[68:69], v[68:69] op_sel:[0,0,1] op_sel_hi:[1,0,1]
  v_pk_fma_f32 v[172:173], v[172:173], v[70:71], v[70:71] op_sel:[0,0,1] op_sel_hi:[1,0,1]
  v_pk_fma_f32 v[174:175], v[174:175], v[70:71], v[70:71] op_sel:[0,0,1] op_sel_hi:[1,0,1]
  v_cvt_pk_bf16_f32 v160, v160, v161
  v_cvt_pk_bf16_f32 v161, v162, v163
  ds_write_b64 v6, v[160:161] offset:6144
  v_cvt_pk_bf16_f32 v164, v164, v165
  v_cvt_pk_bf16_f32 v165, v166, v167
  ds_write_b64 v6, v[164:165] offset:20480
  v_cvt_pk_bf16_f32 v169, v169, v168
  v_cvt_pk_bf16_f32 v168, v171, v170
  ds_write_b64 v7, v[168:169] offset:0
  v_cvt_pk_bf16_f32 v173, v173, v172
  v_cvt_pk_bf16_f32 v172, v175, v174
  ds_write_b64 v7, v[172:173] offset:14336
  s_waitcnt lgkmcnt(0)
  s_barrier
  ds_read_b128 v[208:211], v8 offset:0
  ds_read_b128 v[212:215], v8 offset:14336
  ds_read_b128 v[216:219], v9 offset:0
  ds_read_b128 v[220:223], v9 offset:14336
  ds_read_b128 v[224:227], v8 offset:13312
  ds_read_b128 v[228:231], v8 offset:27648
  ds_read_b128 v[232:235], v9 offset:13312
  ds_read_b128 v[236:239], v9 offset:27648
  s_waitcnt lgkmcnt(7)
  v_mfma_f32_16x16x32_bf16 v[32:35], a[0:3], v[208:211], 0
  s_waitcnt lgkmcnt(6)
  ds_read_b128 v[240:243], v8 offset:1024
  ds_read_b128 v[244:247], v8 offset:15360
  v_mfma_f32_16x16x32_bf16 v[36:39], a[0:3], v[212:215], 0
  s_waitcnt lgkmcnt(6)
  v_mfma_f32_16x16x32_bf16 v[40:43], a[0:3], v[216:219], 0
  s_add_u32 s46, s21, 4096
  v_mfma_f32_16x16x32_bf16 v[44:47], a[0:3], v[220:223], 0
  ds_read_b128 v[248:251], v9 offset:1024
  ds_read_b128 v[252:255], v9 offset:15360
  v_mfma_f32_16x16x32_bf16 v[48:51], a[4:7], v[208:211], 0
  buffer_load_dwordx4 a[0:3], v4, s[8:11], s46 offen offset:2048 sc1
  v_mfma_f32_16x16x32_bf16 v[52:55], a[4:7], v[212:215], 0
  v_mfma_f32_16x16x32_bf16 v[56:59], a[4:7], v[216:219], 0
  s_waitcnt lgkmcnt(7)
  ds_read_b128 v[96:99], v8 offset:12288
  ds_read_b128 v[100:103], v8 offset:26624
  v_mfma_f32_16x16x32_bf16 v[60:63], a[4:7], v[220:223], 0
  buffer_load_dwordx4 a[4:7], v4, s[8:11], s46 offen offset:3072 sc1
  v_mfma_f32_16x16x32_bf16 v[32:35], a[8:11], v[224:227], v[32:35]
  s_waitcnt lgkmcnt(8)
  v_mfma_f32_16x16x32_bf16 v[36:39], a[8:11], v[228:231], v[36:39]
  s_waitcnt lgkmcnt(6)
  ds_read_b128 v[104:107], v9 offset:12288
  ds_read_b128 v[108:111], v9 offset:26624
  v_mfma_f32_16x16x32_bf16 v[40:43], a[8:11], v[232:235], v[40:43]
  s_add_u32 s47, s21, 20480
  v_mfma_f32_16x16x32_bf16 v[44:47], a[8:11], v[236:239], v[44:47]
  buffer_load_dwordx4 a[8:11], v4, s[8:11], s47 offen offset:0 sc1
  v_mfma_f32_16x16x32_bf16 v[48:51], a[12:15], v[224:227], v[48:51]
  ds_read_b128 v[112:115], v8 offset:2048
  ds_read_b128 v[116:119], v8 offset:16384
  v_mfma_f32_16x16x32_bf16 v[52:55], a[12:15], v[228:231], v[52:55]
  v_mfma_f32_16x16x32_bf16 v[56:59], a[12:15], v[232:235], v[56:59]
  v_mfma_f32_16x16x32_bf16 v[60:63], a[12:15], v[236:239], v[60:63]
  s_waitcnt lgkmcnt(8)
  ds_read_b128 v[120:123], v9 offset:2048
  ds_read_b128 v[124:127], v9 offset:16384
  v_mfma_f32_16x16x32_bf16 v[32:35], a[16:19], v[240:243], v[32:35]
  buffer_load_dwordx4 a[12:15], v4, s[8:11], s47 offen offset:1024 sc1
  v_mfma_f32_16x16x32_bf16 v[36:39], a[16:19], v[244:247], v[36:39]
  s_waitcnt lgkmcnt(9)
  v_mfma_f32_16x16x32_bf16 v[40:43], a[16:19], v[248:251], v[40:43]
  s_waitcnt lgkmcnt(8)
  ds_read_b128 v[176:179], v8 offset:11264
  ds_read_b128 v[180:183], v8 offset:25600
  v_mfma_f32_16x16x32_bf16 v[44:47], a[16:19], v[252:255], v[44:47]
  s_add_u32 s48, s21, 8192
  v_mfma_f32_16x16x32_bf16 v[48:51], a[20:23], v[240:243], v[48:51]
  buffer_load_dwordx4 a[16:19], v4, s[8:11], s48 offen offset:0 sc1
  v_mfma_f32_16x16x32_bf16 v[52:55], a[20:23], v[244:247], v[52:55]
  ds_read_b128 v[184:187], v9 offset:11264
  ds_read_b128 v[188:191], v9 offset:25600
  v_mfma_f32_16x16x32_bf16 v[56:59], a[20:23], v[248:251], v[56:59]
  s_waitcnt lgkmcnt(11)
  v_mfma_f32_16x16x32_bf16 v[60:63], a[20:23], v[252:255], v[60:63]
  buffer_load_dwordx4 a[20:23], v4, s[8:11], s48 offen offset:1024 sc1
  v_mfma_f32_16x16x32_bf16 v[32:35], a[24:27], v[96:99], v[32:35]
  s_waitcnt lgkmcnt(10)
  ds_read_b128 v[128:131], v8 offset:3072
  ds_read_b128 v[132:135], v8 offset:17408
  v_mfma_f32_16x16x32_bf16 v[36:39], a[24:27], v[100:103], v[36:39]
  s_waitcnt lgkmcnt(11)
  v_mfma_f32_16x16x32_bf16 v[40:43], a[24:27], v[104:107], v[40:43]
  s_waitcnt lgkmcnt(10)
  v_mfma_f32_16x16x32_bf16 v[44:47], a[24:27], v[108:111], v[44:47]
  ds_read_b128 v[136:139], v9 offset:3072
  ds_read_b128 v[140:143], v9 offset:17408
  v_mfma_f32_16x16x32_bf16 v[48:51], a[28:31], v[96:99], v[48:51]
  s_add_u32 s49, s21, 16384
  v_mfma_f32_16x16x32_bf16 v[52:55], a[28:31], v[100:103], v[52:55]
  buffer_load_dwordx4 a[24:27], v4, s[8:11], s49 offen offset:2048 sc1
  v_mfma_f32_16x16x32_bf16 v[56:59], a[28:31], v[104:107], v[56:59]
  ds_read_b128 v[192:195], v8 offset:10240
  ds_read_b128 v[196:199], v8 offset:24576
  v_mfma_f32_16x16x32_bf16 v[60:63], a[28:31], v[108:111], v[60:63]
  s_waitcnt vmcnt(30) lgkmcnt(12)
  v_mfma_f32_16x16x32_bf16 v[32:35], a[32:35], v[112:115], v[32:35]
  buffer_load_dwordx4 a[28:31], v4, s[8:11], s49 offen offset:3072 sc1
  v_mfma_f32_16x16x32_bf16 v[36:39], a[32:35], v[116:119], v[36:39]
  s_waitcnt lgkmcnt(11)
  ds_read_b128 v[200:203], v9 offset:10240
  ds_read_b128 v[204:207], v9 offset:24576
  v_mfma_f32_16x16x32_bf16 v[40:43], a[32:35], v[120:123], v[40:43]
  s_waitcnt lgkmcnt(12)
  v_mfma_f32_16x16x32_bf16 v[44:47], a[32:35], v[124:127], v[44:47]
  s_waitcnt vmcnt(30)
  v_mfma_f32_16x16x32_bf16 v[48:51], a[36:39], v[112:115], v[48:51]
  v_mfma_f32_16x16x32_bf16 v[52:55], a[36:39], v[116:119], v[52:55]
  buffer_load_dwordx4 a[32:35], v4, s[8:11], s48 offen offset:2048 sc1
  v_mfma_f32_16x16x32_bf16 v[56:59], a[36:39], v[120:123], v[56:59]
  v_mfma_f32_16x16x32_bf16 v[60:63], a[36:39], v[124:127], v[60:63]
  s_waitcnt vmcnt(30) lgkmcnt(11)
  v_mfma_f32_16x16x32_bf16 v[32:35], a[40:43], v[176:179], v[32:35]
  s_waitcnt lgkmcnt(9)
  v_mfma_f32_16x16x32_bf16 v[36:39], a[40:43], v[180:183], v[36:39]
  buffer_load_dwordx4 a[36:39], v4, s[8:11], s48 offen offset:3072 sc1
  v_mfma_f32_16x16x32_bf16 v[40:43], a[40:43], v[184:187], v[40:43]
  s_waitcnt lgkmcnt(8)
  v_mfma_f32_16x16x32_bf16 v[44:47], a[40:43], v[188:191], v[44:47]
  s_waitcnt vmcnt(30)
  v_mfma_f32_16x16x32_bf16 v[48:51], a[44:47], v[176:179], v[48:51]
  v_mfma_f32_16x16x32_bf16 v[52:55], a[44:47], v[180:183], v[52:55]
  v_mfma_f32_16x16x32_bf16 v[56:59], a[44:47], v[184:187], v[56:59]
  buffer_load_dwordx4 a[40:43], v4, s[8:11], s49 offen offset:0 sc1
  v_mfma_f32_16x16x32_bf16 v[60:63], a[44:47], v[188:191], v[60:63]
  s_waitcnt vmcnt(30) lgkmcnt(7)
  v_mfma_f32_16x16x32_bf16 v[32:35], a[48:51], v[128:131], v[32:35]
  s_waitcnt lgkmcnt(6)
  ds_read_b128 v[176:179], v8 offset:4096
  ds_read_b128 v[180:183], v8 offset:18432
  v_mfma_f32_16x16x32_bf16 v[36:39], a[48:51], v[132:135], v[36:39]
  s_waitcnt lgkmcnt(7)
  v_mfma_f32_16x16x32_bf16 v[40:43], a[48:51], v[136:139], v[40:43]
  s_waitcnt vmcnt(29) lgkmcnt(6)
  ds_read_b128 v[184:187], v9 offset:4096
  ds_read_b128 v[188:191], v9 offset:18432
  v_mfma_f32_16x16x32_bf16 v[44:47], a[48:51], v[140:143], v[44:47]
  buffer_load_dwordx4 a[44:47], v4, s[8:11], s49 offen offset:1024 sc1
  v_mfma_f32_16x16x32_bf16 v[48:51], a[52:55], v[128:131], v[48:51]
  v_mfma_f32_16x16x32_bf16 v[52:55], a[52:55], v[132:135], v[52:55]
  s_waitcnt lgkmcnt(7)
  v_mfma_f32_16x16x32_bf16 v[56:59], a[52:55], v[136:139], v[56:59]
  s_add_u32 s46, s21, 12288
  v_mfma_f32_16x16x32_bf16 v[60:63], a[52:55], v[140:143], v[60:63]
  buffer_load_dwordx4 a[48:51], v4, s[8:11], s46 offen offset:0 sc1
  v_mfma_f32_16x16x32_bf16 v[32:35], a[56:59], v[192:195], v[32:35]
  s_waitcnt lgkmcnt(6)
  v_mfma_f32_16x16x32_bf16 v[36:39], a[56:59], v[196:199], v[36:39]
  s_waitcnt lgkmcnt(5)
  v_mfma_f32_16x16x32_bf16 v[40:43], a[56:59], v[200:203], v[40:43]
  s_waitcnt lgkmcnt(4)
  v_mfma_f32_16x16x32_bf16 v[44:47], a[56:59], v[204:207], v[44:47]
  buffer_load_dwordx4 a[52:55], v4, s[8:11], s46 offen offset:1024 sc1
  v_mfma_f32_16x16x32_bf16 v[48:51], a[60:63], v[192:195], v[48:51]
  ds_read_b128 v[144:147], v8 offset:6144
  ds_read_b128 v[148:151], v8 offset:20480
  v_mfma_f32_16x16x32_bf16 v[52:55], a[60:63], v[196:199], v[52:55]
  v_mfma_f32_16x16x32_bf16 v[56:59], a[60:63], v[200:203], v[56:59]
  v_mfma_f32_16x16x32_bf16 v[60:63], a[60:63], v[204:207], v[60:63]
  s_waitcnt lgkmcnt(5)
  ds_read_b128 v[152:155], v9 offset:6144
  ds_read_b128 v[156:159], v9 offset:20480
  v_mfma_f32_16x16x32_bf16 v[32:35], a[64:67], v[176:179], v[32:35]
  s_waitcnt lgkmcnt(5)
  ds_read_b128 v[192:195], v8 offset:9216
  ds_read_b128 v[196:199], v8 offset:23552
  v_mfma_f32_16x16x32_bf16 v[36:39], a[64:67], v[180:183], v[36:39]
  buffer_load_dwordx4 a[56:59], v4, s[8:11], s46 offen offset:2048 sc1
  v_mfma_f32_16x16x32_bf16 v[40:43], a[64:67], v[184:187], v[40:43]
  s_waitcnt lgkmcnt(6)
  ds_read_b128 v[200:203], v9 offset:9216
  ds_read_b128 v[204:207], v9 offset:23552
  v_mfma_f32_16x16x32_bf16 v[44:47], a[64:67], v[188:191], v[44:47]
  ds_read_b128 v[160:163], v8 offset:7168
  ds_read_b128 v[164:167], v8 offset:21504
  v_mfma_f32_16x16x32_bf16 v[48:51], a[68:71], v[176:179], v[48:51]
  buffer_load_dwordx4 a[60:63], v4, s[8:11], s46 offen offset:3072 sc1
  v_mfma_f32_16x16x32_bf16 v[52:55], a[68:71], v[180:183], v[52:55]
  ds_read_b128 v[168:171], v9 offset:7168
  ds_read_b128 v[172:175], v9 offset:21504
  v_mfma_f32_16x16x32_bf16 v[56:59], a[68:71], v[184:187], v[56:59]
  v_mfma_f32_16x16x32_bf16 v[60:63], a[68:71], v[188:191], v[60:63]
  s_waitcnt lgkmcnt(7)
  v_mfma_f32_16x16x32_bf16 v[32:35], a[72:75], v[192:195], v[32:35]
  s_waitcnt lgkmcnt(5)
  ds_read_b128 v[176:179], v8 offset:5120
  ds_read_b128 v[180:183], v8 offset:19456
  v_mfma_f32_16x16x32_bf16 v[36:39], a[72:75], v[196:199], v[36:39]
  s_add_u32 s47, s25, 0
  v_mfma_f32_16x16x32_bf16 v[40:43], a[72:75], v[200:203], v[40:43]
  s_waitcnt lgkmcnt(6)
  ds_read_b128 v[184:187], v9 offset:5120
  ds_read_b128 v[188:191], v9 offset:19456
  v_mfma_f32_16x16x32_bf16 v[44:47], a[72:75], v[204:207], v[44:47]
  buffer_load_dwordx4 a[64:67], v4, s[8:11], s47 offen offset:0 sc1
  v_mfma_f32_16x16x32_bf16 v[48:51], a[76:79], v[192:195], v[48:51]
  v_mfma_f32_16x16x32_bf16 v[52:55], a[76:79], v[196:199], v[52:55]
  buffer_load_dwordx4 a[68:71], v4, s[8:11], s47 offen offset:1024 sc1
  v_mfma_f32_16x16x32_bf16 v[56:59], a[76:79], v[200:203], v[56:59]
  v_mfma_f32_16x16x32_bf16 v[60:63], a[76:79], v[204:207], v[60:63]
  s_waitcnt lgkmcnt(3)
  v_mfma_f32_16x16x32_bf16 v[32:35], a[80:83], v[176:179], v[32:35]
  s_waitcnt lgkmcnt(1)
  ds_read_b128 v[192:195], v8 offset:8192
  ds_read_b128 v[196:199], v8 offset:22528
  v_mfma_f32_16x16x32_bf16 v[36:39], a[80:83], v[180:183], v[36:39]
  s_add_u32 s48, s25, 24576
  v_mfma_f32_16x16x32_bf16 v[40:43], a[80:83], v[184:187], v[40:43]
  s_waitcnt lgkmcnt(2)
  ds_read_b128 v[200:203], v9 offset:8192
  ds_read_b128 v[204:207], v9 offset:22528
  v_mfma_f32_16x16x32_bf16 v[44:47], a[80:83], v[188:191], v[44:47]
  buffer_load_dwordx4 a[72:75], v4, s[8:11], s48 offen offset:2048 sc1
  v_mfma_f32_16x16x32_bf16 v[48:51], a[84:87], v[176:179], v[48:51]
  v_mfma_f32_16x16x32_bf16 v[52:55], a[84:87], v[180:183], v[52:55]
  v_mfma_f32_16x16x32_bf16 v[56:59], a[84:87], v[184:187], v[56:59]
  buffer_load_dwordx4 a[76:79], v4, s[8:11], s48 offen offset:3072 sc1
  v_mfma_f32_16x16x32_bf16 v[60:63], a[84:87], v[188:191], v[60:63]
  s_waitcnt vmcnt(37) lgkmcnt(3)
  v_mfma_f32_16x16x32_bf16 v[32:35], a[88:91], v[192:195], v[32:35]
  s_waitcnt lgkmcnt(2)
  ds_read_b128 v[176:179], v8 offset:11264
  ds_read_b128 v[180:183], v8 offset:25600
  v_mfma_f32_16x16x32_bf16 v[36:39], a[88:91], v[196:199], v[36:39]
  s_waitcnt lgkmcnt(3)
  v_mfma_f32_16x16x32_bf16 v[40:43], a[88:91], v[200:203], v[40:43]
  s_waitcnt vmcnt(36) lgkmcnt(2)
  ds_read_b128 v[184:187], v9 offset:11264
  ds_read_b128 v[188:191], v9 offset:25600
  v_mfma_f32_16x16x32_bf16 v[44:47], a[88:91], v[204:207], v[44:47]
  buffer_load_dwordx4 a[80:83], v4, s[8:11], s47 offen offset:2048 sc1
  v_mfma_f32_16x16x32_bf16 v[48:51], a[92:95], v[192:195], v[48:51]
  v_add_u32 v20, s62, v4
  v_mfma_f32_16x16x32_bf16 v[52:55], a[92:95], v[196:199], v[52:55]
  v_mfma_f32_16x16x32_bf16 v[56:59], a[92:95], v[200:203], v[56:59]
  s_waitcnt vmcnt(36)
  v_mfma_f32_16x16x32_bf16 v[60:63], a[92:95], v[204:207], v[60:63]
  buffer_load_dwordx4 a[84:87], v4, s[8:11], s47 offen offset:3072 sc1
  v_mfma_f32_16x16x32_bf16 v[32:35], a[96:99], v[144:147], v[32:35]
  ds_read_b128 v[192:195], v8 offset:10240
  ds_read_b128 v[196:199], v8 offset:24576
  v_mfma_f32_16x16x32_bf16 v[36:39], a[96:99], v[148:151], v[36:39]
  v_mfma_f32_16x16x32_bf16 v[40:43], a[96:99], v[152:155], v[40:43]
  ds_read_b128 v[200:203], v9 offset:10240
  ds_read_b128 v[204:207], v9 offset:24576
  v_mfma_f32_16x16x32_bf16 v[44:47], a[96:99], v[156:159], v[44:47]
  s_waitcnt vmcnt(36)
  v_mfma_f32_16x16x32_bf16 v[48:51], a[100:103], v[144:147], v[48:51]
  buffer_load_dwordx4 a[88:91], v4, s[8:11], s48 offen offset:0 sc1
  v_mfma_f32_16x16x32_bf16 v[52:55], a[100:103], v[148:151], v[52:55]
  v_mfma_f32_16x16x32_bf16 v[56:59], a[100:103], v[152:155], v[56:59]
  v_mfma_f32_16x16x32_bf16 v[60:63], a[100:103], v[156:159], v[60:63]
  s_waitcnt vmcnt(36)
  v_mfma_f32_16x16x32_bf16 v[32:35], a[104:107], v[160:163], v[32:35]
  buffer_load_dwordx4 a[92:95], v4, s[8:11], s48 offen offset:1024 sc1
  v_mfma_f32_16x16x32_bf16 v[36:39], a[104:107], v[164:167], v[36:39]
  v_mfma_f32_16x16x32_bf16 v[40:43], a[104:107], v[168:171], v[40:43]
  v_mfma_f32_16x16x32_bf16 v[44:47], a[104:107], v[172:175], v[44:47]
  s_waitcnt vmcnt(36)
  v_mfma_f32_16x16x32_bf16 v[48:51], a[108:111], v[160:163], v[48:51]
  s_add_u32 s49, s25, 4096
  v_mfma_f32_16x16x32_bf16 v[52:55], a[108:111], v[164:167], v[52:55]
  buffer_load_dwordx4 a[96:99], v4, s[8:11], s49 offen offset:0 sc1
  v_mfma_f32_16x16x32_bf16 v[56:59], a[108:111], v[168:171], v[56:59]
  v_mfma_f32_16x16x32_bf16 v[60:63], a[108:111], v[172:175], v[60:63]
  s_waitcnt vmcnt(36)
  v_mfma_f32_16x16x32_bf16 v[64:67], a[112:115], v[208:211], 0
  v_mfma_f32_16x16x32_bf16 v[68:71], a[112:115], v[212:215], 0
  buffer_load_dwordx4 a[100:103], v4, s[8:11], s49 offen offset:1024 sc1
  v_mfma_f32_16x16x32_bf16 v[72:75], a[112:115], v[216:219], 0
  v_exp_f32 v24, v32
  v_mfma_f32_16x16x32_bf16 v[76:79], a[112:115], v[220:223], 0
  s_waitcnt vmcnt(36)
  v_exp_f32 v25, v33
  v_mfma_f32_16x16x32_bf16 v[80:83], a[116:119], v[208:211], 0
  v_exp_f32 v26, v34
  v_mfma_f32_16x16x32_bf16 v[84:87], a[116:119], v[212:215], 0
  s_add_u32 s46, s25, 20480
  v_exp_f32 v27, v35
  v_mfma_f32_16x16x32_bf16 v[88:91], a[116:119], v[216:219], 0
  buffer_load_dwordx4 a[104:107], v4, s[8:11], s46 offen offset:2048 sc1
  v_mfma_f32_16x16x32_bf16 v[92:95], a[116:119], v[220:223], 0
  s_waitcnt vmcnt(36)
  v_mul_f32 v32, v32, v48
  v_mul_f32 v33, v33, v49
  v_mfma_f32_16x16x32_bf16 v[64:67], a[120:123], v[224:227], v[64:67]
  v_mul_f32 v34, v34, v50
  v_mul_f32 v35, v35, v51
  v_mfma_f32_16x16x32_bf16 v[68:71], a[120:123], v[228:231], v[68:71]
  v_fma_f32 v24, v24, s54, s54
  v_fma_f32 v25, v25, s54, s54
  v_mfma_f32_16x16x32_bf16 v[72:75], a[120:123], v[232:235], v[72:75]
  buffer_load_dwordx4 a[108:111], v4, s[8:11], s46 offen offset:3072 sc1
  v_mfma_f32_16x16x32_bf16 v[76:79], a[120:123], v[236:239], v[76:79]
  s_waitcnt vmcnt(36)
  v_fma_f32 v26, v26, s54, s54
  v_fma_f32 v27, v27, s54, s54
  v_mfma_f32_16x16x32_bf16 v[80:83], a[124:127], v[224:227], v[80:83]
  v_rcp_f32 v24, v24
  v_mfma_f32_16x16x32_bf16 v[84:87], a[124:127], v[228:231], v[84:87]
  v_rcp_f32 v25, v25
  v_mfma_f32_16x16x32_bf16 v[88:91], a[124:127], v[232:235], v[88:91]
  s_waitcnt vmcnt(35)
  v_rcp_f32 v26, v26
  v_mfma_f32_16x16x32_bf16 v[92:95], a[124:127], v[236:239], v[92:95]
  buffer_load_dwordx4 a[112:115], v4, s[8:11], s49 offen offset:2048 sc1
  v_mfma_f32_16x16x32_bf16 v[64:67], a[128:131], v[240:243], v[64:67]
  v_rcp_f32 v27, v27
  v_mfma_f32_16x16x32_bf16 v[68:71], a[128:131], v[244:247], v[68:71]
  v_mul_f32 v24, v24, v32
  v_mul_f32 v25, v25, v33
  v_mfma_f32_16x16x32_bf16 v[72:75], a[128:131], v[248:251], v[72:75]
  s_waitcnt vmcnt(35)
  v_mul_f32 v26, v26, v34
  v_mul_f32 v27, v27, v35
  v_mfma_f32_16x16x32_bf16 v[76:79], a[128:131], v[252:255], v[76:79]
  buffer_load_dwordx4 a[116:119], v4, s[8:11], s49 offen offset:3072 sc1
  v_mfma_f32_16x16x32_bf16 v[80:83], a[132:135], v[240:243], v[80:83]
  v_cvt_pk_bf16_f32 v32, v24, v25
  v_cvt_pk_bf16_f32 v33, v26, v27
  v_mfma_f32_16x16x32_bf16 v[84:87], a[132:135], v[244:247], v[84:87]
  v_exp_f32 v28, v36
  v_mfma_f32_16x16x32_bf16 v[88:91], a[132:135], v[248:251], v[88:91]
  v_exp_f32 v29, v37
  v_mfma_f32_16x16x32_bf16 v[92:95], a[132:135], v[252:255], v[92:95]
  s_waitcnt vmcnt(35)
  v_exp_f32 v30, v38
  v_mfma_f32_16x16x32_bf16 v[64:67], a[136:139], v[96:99], v[64:67]
  buffer_load_dwordx4 a[120:123], v4, s[8:11], s46 offen offset:0 sc1
  v_mfma_f32_16x16x32_bf16 v[68:71], a[136:139], v[100:103], v[68:71]
  v_exp_f32 v31, v39
  v_mfma_f32_16x16x32_bf16 v[72:75], a[136:139], v[104:107], v[72:75]
  v_mul_f32 v36, v36, v52
  v_mul_f32 v37, v37, v53
  v_mfma_f32_16x16x32_bf16 v[76:79], a[136:139], v[108:111], v[76:79]
  s_waitcnt vmcnt(35)
  v_mul_f32 v38, v38, v54
  v_mul_f32 v39, v39, v55
  v_mfma_f32_16x16x32_bf16 v[80:83], a[140:143], v[96:99], v[80:83]
  buffer_load_dwordx4 a[124:127], v4, s[8:11], s46 offen offset:1024 sc1
  v_mfma_f32_16x16x32_bf16 v[84:87], a[140:143], v[100:103], v[84:87]
  v_fma_f32 v28, v28, s54, s54
  v_fma_f32 v29, v29, s54, s54
  v_mfma_f32_16x16x32_bf16 v[88:91], a[140:143], v[104:107], v[88:91]
  v_fma_f32 v30, v30, s54, s54
  v_fma_f32 v31, v31, s54, s54
  v_mfma_f32_16x16x32_bf16 v[92:95], a[140:143], v[108:111], v[92:95]
  s_waitcnt vmcnt(35)
  v_rcp_f32 v28, v28
  v_mfma_f32_16x16x32_bf16 v[64:67], a[144:147], v[112:115], v[64:67]
  s_add_u32 s47, s25, 8192
  v_rcp_f32 v29, v29
  v_mfma_f32_16x16x32_bf16 v[68:71], a[144:147], v[116:119], v[68:71]
  buffer_load_dwordx4 a[128:131], v4, s[8:11], s47 offen offset:0 sc1
  v_mfma_f32_16x16x32_bf16 v[72:75], a[144:147], v[120:123], v[72:75]
  v_rcp_f32 v30, v30
  v_mfma_f32_16x16x32_bf16 v[76:79], a[144:147], v[124:127], v[76:79]
  s_waitcnt vmcnt(35)
  v_rcp_f32 v31, v31
  v_mfma_f32_16x16x32_bf16 v[80:83], a[148:151], v[112:115], v[80:83]
  v_mul_f32 v28, v28, v36
  v_mul_f32 v29, v29, v37
  v_mfma_f32_16x16x32_bf16 v[84:87], a[148:151], v[116:119], v[84:87]
  buffer_load_dwordx4 a[132:135], v4, s[8:11], s47 offen offset:1024 sc1
  v_mfma_f32_16x16x32_bf16 v[88:91], a[148:151], v[120:123], v[88:91]
  v_mul_f32 v30, v30, v38
  v_mul_f32 v31, v31, v39
  v_mfma_f32_16x16x32_bf16 v[92:95], a[148:151], v[124:127], v[92:95]
  s_waitcnt vmcnt(35) lgkmcnt(7)
  v_cvt_pk_bf16_f32 v34, v28, v29
  v_cvt_pk_bf16_f32 v35, v30, v31
  v_mfma_f32_16x16x32_bf16 v[64:67], a[152:155], v[176:179], v[64:67]
  s_waitcnt lgkmcnt(4)
  v_permlane32_swap_b32 v32, v34
  v_permlane32_swap_b32 v33, v35
  v_mfma_f32_16x16x32_bf16 v[68:71], a[152:155], v[180:183], v[68:71]
  s_add_u32 s48, s25, 16384
  v_or_b32 v32, 1, v32
  v_mfma_f32_16x16x32_bf16 v[72:75], a[152:155], v[184:187], v[72:75]
  buffer_load_dwordx4 a[136:139], v4, s[8:11], s48 offen offset:2048 sc1
  v_mfma_f32_16x16x32_bf16 v[76:79], a[152:155], v[188:191], v[76:79]
  buffer_store_dwordx4 v[32:35], v10, s[8:11], s42 offen sc1
  s_waitcnt vmcnt(36)
  v_mfma_f32_16x16x32_bf16 v[80:83], a[156:159], v[176:179], v[80:83]
  v_exp_f32 v24, v40
  v_mfma_f32_16x16x32_bf16 v[84:87], a[156:159], v[180:183], v[84:87]
  v_exp_f32 v25, v41
  v_mfma_f32_16x16x32_bf16 v[88:91], a[156:159], v[184:187], v[88:91]
  buffer_load_dwordx4 a[140:143], v4, s[8:11], s48 offen offset:3072 sc1
  v_mfma_f32_16x16x32_bf16 v[92:95], a[156:159], v[188:191], v[92:95]
  s_waitcnt vmcnt(36)
  v_exp_f32 v26, v42
  v_mfma_f32_16x16x32_bf16 v[64:67], a[0:3], v[128:131], v[64:67]
  ds_read_b128 v[176:179], v8 offset:4096
  ds_read_b128 v[180:183], v8 offset:18432
  v_mfma_f32_16x16x32_bf16 v[68:71], a[0:3], v[132:135], v[68:71]
  v_exp_f32 v27, v43
  v_mfma_f32_16x16x32_bf16 v[72:75], a[0:3], v[136:139], v[72:75]
  s_waitcnt vmcnt(35)
  ds_read_b128 v[184:187], v9 offset:4096
  ds_read_b128 v[188:191], v9 offset:18432
  v_mfma_f32_16x16x32_bf16 v[76:79], a[0:3], v[140:143], v[76:79]
  buffer_load_dwordx4 a[144:147], v4, s[8:11], s47 offen offset:2048 sc1
  v_mfma_f32_16x16x32_bf16 v[80:83], a[4:7], v[128:131], v[80:83]
  v_mul_f32 v40, v40, v56
  v_mul_f32 v41, v41, v57
  v_mfma_f32_16x16x32_bf16 v[84:87], a[4:7], v[132:135], v[84:87]
  v_mul_f32 v42, v42, v58
  v_mul_f32 v43, v43, v59
  v_mfma_f32_16x16x32_bf16 v[88:91], a[4:7], v[136:139], v[88:91]
  s_waitcnt vmcnt(35) lgkmcnt(7)
  v_fma_f32 v24, v24, s54, s54
  v_fma_f32 v25, v25, s54, s54
  v_mfma_f32_16x16x32_bf16 v[92:95], a[4:7], v[140:143], v[92:95]
  buffer_load_dwordx4 a[148:151], v4, s[8:11], s47 offen offset:3072 sc1
  v_mfma_f32_16x16x32_bf16 v[64:67], a[8:11], v[192:195], v[64:67]
  s_waitcnt lgkmcnt(6)
  v_fma_f32 v26, v26, s54, s54
  v_fma_f32 v27, v27, s54, s54
  v_mfma_f32_16x16x32_bf16 v[68:71], a[8:11], v[196:199], v[68:71]
  s_waitcnt lgkmcnt(5)
  v_rcp_f32 v24, v24
  v_mfma_f32_16x16x32_bf16 v[72:75], a[8:11], v[200:203], v[72:75]
  s_waitcnt lgkmcnt(4)
  v_rcp_f32 v25, v25
  v_mfma_f32_16x16x32_bf16 v[76:79], a[8:11], v[204:207], v[76:79]
  s_waitcnt vmcnt(35)
  v_rcp_f32 v26, v26
  v_mfma_f32_16x16x32_bf16 v[80:83], a[12:15], v[192:195], v[80:83]
  buffer_load_dwordx4 a[152:155], v4, s[8:11], s48 offen offset:0 sc1
  v_mfma_f32_16x16x32_bf16 v[84:87], a[12:15], v[196:199], v[84:87]
  v_rcp_f32 v27, v27
  v_mfma_f32_16x16x32_bf16 v[88:91], a[12:15], v[200:203], v[88:91]
  v_mul_f32 v24, v24, v40
  v_mul_f32 v25, v25, v41
  v_mfma_f32_16x16x32_bf16 v[92:95], a[12:15], v[204:207], v[92:95]
  s_waitcnt vmcnt(35) lgkmcnt(3)
  v_mul_f32 v26, v26, v42
  v_mul_f32 v27, v27, v43
  v_mfma_f32_16x16x32_bf16 v[64:67], a[16:19], v[176:179], v[64:67]
  s_waitcnt lgkmcnt(1)
  ds_read_b128 v[192:195], v8 offset:9216
  ds_read_b128 v[196:199], v8 offset:23552
  v_mfma_f32_16x16x32_bf16 v[68:71], a[16:19], v[180:183], v[68:71]
  buffer_load_dwordx4 a[156:159], v4, s[8:11], s48 offen offset:1024 sc1
  v_mfma_f32_16x16x32_bf16 v[72:75], a[16:19], v[184:187], v[72:75]
  s_waitcnt lgkmcnt(2)
  ds_read_b128 v[200:203], v9 offset:9216
  ds_read_b128 v[204:207], v9 offset:23552
  v_mfma_f32_16x16x32_bf16 v[76:79], a[16:19], v[188:191], v[76:79]
  s_waitcnt vmcnt(35)
  v_cvt_pk_bf16_f32 v40, v24, v25
  v_cvt_pk_bf16_f32 v41, v26, v27
  v_mfma_f32_16x16x32_bf16 v[80:83], a[20:23], v[176:179], v[80:83]
  s_add_u32 s49, s25, 12288
  v_exp_f32 v28, v44
  v_mfma_f32_16x16x32_bf16 v[84:87], a[20:23], v[180:183], v[84:87]
  buffer_load_dwordx4 a[0:3], v4, s[8:11], s49 offen offset:0 sc1
  v_mfma_f32_16x16x32_bf16 v[88:91], a[20:23], v[184:187], v[88:91]
  v_exp_f32 v29, v45
  v_mfma_f32_16x16x32_bf16 v[92:95], a[20:23], v[188:191], v[92:95]
  s_waitcnt vmcnt(35) lgkmcnt(3)
  v_exp_f32 v30, v46
  v_mfma_f32_16x16x32_bf16 v[64:67], a[24:27], v[192:195], v[64:67]
  s_waitcnt lgkmcnt(1)
  ds_read_b128 v[176:179], v8 offset:5120
  ds_read_b128 v[180:183], v8 offset:19456
  v_mfma_f32_16x16x32_bf16 v[68:71], a[24:27], v[196:199], v[68:71]
  buffer_load_dwordx4 a[4:7], v4, s[8:11], s49 offen offset:1024 sc1
  v_mfma_f32_16x16x32_bf16 v[72:75], a[24:27], v[200:203], v[72:75]
  s_waitcnt lgkmcnt(2)
  ds_read_b128 v[184:187], v9 offset:5120
  ds_read_b128 v[188:191], v9 offset:19456
  v_mfma_f32_16x16x32_bf16 v[76:79], a[24:27], v[204:207], v[76:79]
  s_waitcnt vmcnt(35)
  v_exp_f32 v31, v47
  v_mfma_f32_16x16x32_bf16 v[80:83], a[28:31], v[192:195], v[80:83]
  v_mul_f32 v44, v44, v60
  v_mul_f32 v45, v45, v61
  v_mfma_f32_16x16x32_bf16 v[84:87], a[28:31], v[196:199], v[84:87]
  v_mul_f32 v46, v46, v62
  v_mul_f32 v47, v47, v63
  v_mfma_f32_16x16x32_bf16 v[88:91], a[28:31], v[200:203], v[88:91]
  buffer_load_dwordx4 a[8:11], v4, s[8:11], s49 offen offset:2048 sc1
  v_mfma_f32_16x16x32_bf16 v[92:95], a[28:31], v[204:207], v[92:95]
  s_waitcnt vmcnt(35) lgkmcnt(3)
  v_fma_f32 v28, v28, s54, s54
  v_fma_f32 v29, v29, s54, s54
  v_mfma_f32_16x16x32_bf16 v[64:67], a[32:35], v[176:179], v[64:67]
  s_waitcnt lgkmcnt(2)
  ds_read_b128 v[192:195], v8 offset:8192
  ds_read_b128 v[196:199], v8 offset:22528
  v_mfma_f32_16x16x32_bf16 v[68:71], a[32:35], v[180:183], v[68:71]
  s_waitcnt lgkmcnt(3)
  v_fma_f32 v30, v30, s54, s54
  v_fma_f32 v31, v31, s54, s54
  v_mfma_f32_16x16x32_bf16 v[72:75], a[32:35], v[184:187], v[72:75]
  s_waitcnt vmcnt(34) lgkmcnt(2)
  ds_read_b128 v[200:203], v9 offset:8192
  ds_read_b128 v[204:207], v9 offset:22528
  v_mfma_f32_16x16x32_bf16 v[76:79], a[32:35], v[188:191], v[76:79]
  buffer_load_dwordx4 a[12:15], v4, s[8:11], s49 offen offset:3072 sc1
  v_mfma_f32_16x16x32_bf16 v[80:83], a[36:39], v[176:179], v[80:83]
  v_rcp_f32 v28, v28
  v_mfma_f32_16x16x32_bf16 v[84:87], a[36:39], v[180:183], v[84:87]
  s_waitcnt vmcnt(34) lgkmcnt(3)
  v_rcp_f32 v29, v29
  v_mfma_f32_16x16x32_bf16 v[88:91], a[36:39], v[184:187], v[88:91]
  s_add_u32 s46, s38, 24576
  v_rcp_f32 v30, v30
  v_mfma_f32_16x16x32_bf16 v[92:95], a[36:39], v[188:191], v[92:95]
  buffer_load_dwordx4 a[16:19], v4, s[8:11], s46 offen offset:0 sc1
  v_mfma_f32_16x16x32_bf16 v[64:67], a[40:43], v[192:195], v[64:67]
  s_waitcnt lgkmcnt(2)
  ds_read_b128 v[176:179], v8 offset:11264
  ds_read_b128 v[180:183], v8 offset:25600
  v_mfma_f32_16x16x32_bf16 v[68:71], a[40:43], v[196:199], v[68:71]
  s_waitcnt lgkmcnt(3)
  v_rcp_f32 v31, v31
  v_mfma_f32_16x16x32_bf16 v[72:75], a[40:43], v[200:203], v[72:75]
  s_waitcnt vmcnt(34) lgkmcnt(2)
  ds_read_b128 v[184:187], v9 offset:11264
  ds_read_b128 v[188:191], v9 offset:25600
  v_mfma_f32_16x16x32_bf16 v[76:79], a[40:43], v[204:207], v[76:79]
  s_add_u32 s47, s38, 4096
  v_mul_f32 v28, v28, v44
  v_mul_f32 v29, v29, v45
  v_mfma_f32_16x16x32_bf16 v[80:83], a[44:47], v[192:195], v[80:83]
  buffer_load_dwordx4 a[20:23], v4, s[8:11], s47 offen offset:0 sc1
  v_mfma_f32_16x16x32_bf16 v[84:87], a[44:47], v[196:199], v[84:87]
  v_mul_f32 v30, v30, v46
  v_mul_f32 v31, v31, v47
  v_mfma_f32_16x16x32_bf16 v[88:91], a[44:47], v[200:203], v[88:91]
  v_cvt_pk_bf16_f32 v42, v28, v29
  v_cvt_pk_bf16_f32 v43, v30, v31
  v_mfma_f32_16x16x32_bf16 v[92:95], a[44:47], v[204:207], v[92:95]
  s_waitcnt vmcnt(34)
  v_permlane32_swap_b32 v40, v42
  v_permlane32_swap_b32 v41, v43
  v_mfma_f32_16x16x32_bf16 v[64:67], a[48:51], v[144:147], v[64:67]
  ds_read_b128 v[192:195], v8 offset:10240
  ds_read_b128 v[196:199], v8 offset:24576
  v_mfma_f32_16x16x32_bf16 v[68:71], a[48:51], v[148:151], v[68:71]
  buffer_load_dwordx4 a[24:27], v4, s[8:11], s47 offen offset:2048 sc1
  v_mfma_f32_16x16x32_bf16 v[72:75], a[48:51], v[152:155], v[72:75]
  s_waitcnt vmcnt(34)
  ds_read_b128 v[200:203], v9 offset:10240
  ds_read_b128 v[204:207], v9 offset:24576
  v_mfma_f32_16x16x32_bf16 v[76:79], a[48:51], v[156:159], v[76:79]
  s_add_u32 s48, s38, 8192
  v_or_b32 v40, 1, v40
  v_mfma_f32_16x16x32_bf16 v[80:83], a[52:55], v[144:147], v[80:83]
  buffer_load_dwordx4 a[28:31], v4, s[8:11], s48 offen offset:2048 sc1
  v_mfma_f32_16x16x32_bf16 v[84:87], a[52:55], v[148:151], v[84:87]
  buffer_store_dwordx4 v[40:43], v11, s[8:11], s42 offen sc1
  v_mfma_f32_16x16x32_bf16 v[88:91], a[52:55], v[152:155], v[88:91]
  v_mfma_f32_16x16x32_bf16 v[92:95], a[52:55], v[156:159], v[92:95]
  s_waitcnt vmcnt(35)
  v_mfma_f32_16x16x32_bf16 v[64:67], a[56:59], v[160:163], v[64:67]
  s_add_u32 s49, s38, 16384
  v_mfma_f32_16x16x32_bf16 v[68:71], a[56:59], v[164:167], v[68:71]
  buffer_load_dwordx4 a[32:35], v4, s[8:11], s49 offen offset:0 sc1
  v_mfma_f32_16x16x32_bf16 v[72:75], a[56:59], v[168:171], v[72:75]
  v_mfma_f32_16x16x32_bf16 v[76:79], a[56:59], v[172:175], v[76:79]
  s_waitcnt vmcnt(35)
  v_mfma_f32_16x16x32_bf16 v[80:83], a[60:63], v[160:163], v[80:83]
  s_add_u32 s46, s38, 0
  v_mfma_f32_16x16x32_bf16 v[84:87], a[60:63], v[164:167], v[84:87]
  buffer_load_dwordx4 a[36:39], v4, s[8:11], s46 offen offset:0 sc1
  v_mfma_f32_16x16x32_bf16 v[88:91], a[60:63], v[168:171], v[88:91]
  v_mfma_f32_16x16x32_bf16 v[92:95], a[60:63], v[172:175], v[92:95]
  s_waitcnt vmcnt(35)
  v_mfma_f32_16x16x32_bf16 v[32:35], a[64:67], v[208:211], 0
  v_mfma_f32_16x16x32_bf16 v[36:39], a[64:67], v[212:215], 0
  s_add_u32 s47, s38, 24576
  v_mfma_f32_16x16x32_bf16 v[40:43], a[64:67], v[216:219], 0
  buffer_load_dwordx4 a[40:43], v4, s[8:11], s47 offen offset:2048 sc1
  v_mfma_f32_16x16x32_bf16 v[44:47], a[64:67], v[220:223], 0
  s_waitcnt vmcnt(35)
  v_exp_f32 v24, v64
  v_mfma_f32_16x16x32_bf16 v[48:51], a[68:71], v[208:211], 0
  v_exp_f32 v25, v65
  v_mfma_f32_16x16x32_bf16 v[52:55], a[68:71], v[212:215], 0
  v_exp_f32 v26, v66
  v_mfma_f32_16x16x32_bf16 v[56:59], a[68:71], v[216:219], 0
  buffer_load_dwordx4 a[44:47], v4, s[8:11], s46 offen offset:2048 sc1
  v_mfma_f32_16x16x32_bf16 v[60:63], a[68:71], v[220:223], 0
  s_waitcnt vmcnt(35)
  v_exp_f32 v27, v67
  v_mfma_f32_16x16x32_bf16 v[32:35], a[72:75], v[224:227], v[32:35]
  v_mul_f32 v64, v64, v80
  v_mul_f32 v65, v65, v81
  v_mfma_f32_16x16x32_bf16 v[36:39], a[72:75], v[228:231], v[36:39]
  s_waitcnt vmcnt(34)
  v_mul_f32 v66, v66, v82
  v_mul_f32 v67, v67, v83
  v_mfma_f32_16x16x32_bf16 v[40:43], a[72:75], v[232:235], v[40:43]
  s_add_u32 s48, s38, 20480
  v_fma_f32 v24, v24, s54, s54
  v_fma_f32 v25, v25, s54, s54
  v_mfma_f32_16x16x32_bf16 v[44:47], a[72:75], v[236:239], v[44:47]
  buffer_load_dwordx4 a[48:51], v4, s[8:11], s48 offen offset:2048 sc1
  v_mfma_f32_16x16x32_bf16 v[48:51], a[76:79], v[224:227], v[48:51]
  v_fma_f32 v26, v26, s54, s54
  v_fma_f32 v27, v27, s54, s54
  v_mfma_f32_16x16x32_bf16 v[52:55], a[76:79], v[228:231], v[52:55]
  v_rcp_f32 v24, v24
  v_mfma_f32_16x16x32_bf16 v[56:59], a[76:79], v[232:235], v[56:59]
  s_waitcnt vmcnt(34)
  v_rcp_f32 v25, v25
  v_mfma_f32_16x16x32_bf16 v[60:63], a[76:79], v[236:239], v[60:63]
  buffer_load_dwordx4 a[52:55], v4, s[8:11], s48 offen offset:0 sc1
  v_mfma_f32_16x16x32_bf16 v[32:35], a[80:83], v[240:243], v[32:35]
  v_rcp_f32 v26, v26
  v_mfma_f32_16x16x32_bf16 v[36:39], a[80:83], v[244:247], v[36:39]
  v_rcp_f32 v27, v27
  v_mfma_f32_16x16x32_bf16 v[40:43], a[80:83], v[248:251], v[40:43]
  s_waitcnt vmcnt(34)
  v_mul_f32 v24, v24, v64
  v_mul_f32 v25, v25, v65
  v_mfma_f32_16x16x32_bf16 v[44:47], a[80:83], v[252:255], v[44:47]
  s_add_u32 s49, s38, 12288
  v_mul_f32 v26, v26, v66
  v_mul_f32 v27, v27, v67
  v_mfma_f32_16x16x32_bf16 v[48:51], a[84:87], v[240:243], v[48:51]
  buffer_load_dwordx4 a[56:59], v4, s[8:11], s49 offen offset:0 sc1
  v_mfma_f32_16x16x32_bf16 v[52:55], a[84:87], v[244:247], v[52:55]
  v_cvt_pk_bf16_f32 v64, v24, v25
  v_cvt_pk_bf16_f32 v65, v26, v27
  v_mfma_f32_16x16x32_bf16 v[56:59], a[84:87], v[248:251], v[56:59]
  v_exp_f32 v28, v68
  v_mfma_f32_16x16x32_bf16 v[60:63], a[84:87], v[252:255], v[60:63]
  s_waitcnt vmcnt(34)
  v_exp_f32 v29, v69
  v_mfma_f32_16x16x32_bf16 v[32:35], a[88:91], v[96:99], v[32:35]
  buffer_load_dwordx4 a[60:63], v4, s[8:11], s49 offen offset:2048 sc1
  v_mfma_f32_16x16x32_bf16 v[36:39], a[88:91], v[100:103], v[36:39]
  v_exp_f32 v30, v70
  v_mfma_f32_16x16x32_bf16 v[40:43], a[88:91], v[104:107], v[40:43]
  v_exp_f32 v31, v71
  v_mfma_f32_16x16x32_bf16 v[44:47], a[88:91], v[108:111], v[44:47]
  s_waitcnt vmcnt(34)
  v_mul_f32 v68, v68, v84
  v_mul_f32 v69, v69, v85
  v_mfma_f32_16x16x32_bf16 v[48:51], a[92:95], v[96:99], v[48:51]
  s_add_u32 s46, s38, 8192
  v_mul_f32 v70, v70, v86
  v_mul_f32 v71, v71, v87
  v_mfma_f32_16x16x32_bf16 v[52:55], a[92:95], v[100:103], v[52:55]
  buffer_load_dwordx4 a[64:67], v4, s[8:11], s46 offen offset:0 sc1
  v_mfma_f32_16x16x32_bf16 v[56:59], a[92:95], v[104:107], v[56:59]
  v_fma_f32 v28, v28, s54, s54
  v_fma_f32 v29, v29, s54, s54
  v_mfma_f32_16x16x32_bf16 v[60:63], a[92:95], v[108:111], v[60:63]
  s_waitcnt vmcnt(34)
  v_fma_f32 v30, v30, s54, s54
  v_fma_f32 v31, v31, s54, s54
  v_mfma_f32_16x16x32_bf16 v[32:35], a[96:99], v[112:115], v[32:35]
  s_add_u32 s47, s38, 16384
  v_rcp_f32 v28, v28
  v_mfma_f32_16x16x32_bf16 v[36:39], a[96:99], v[116:119], v[36:39]
  buffer_load_dwordx4 a[68:71], v4, s[8:11], s47 offen offset:2048 sc1
  v_mfma_f32_16x16x32_bf16 v[40:43], a[96:99], v[120:123], v[40:43]
  v_rcp_f32 v29, v29
  v_mfma_f32_16x16x32_bf16 v[44:47], a[96:99], v[124:127], v[44:47]
  s_waitcnt vmcnt(34)
  v_rcp_f32 v30, v30
  v_mfma_f32_16x16x32_bf16 v[48:51], a[100:103], v[112:115], v[48:51]
  v_rcp_f32 v31, v31
  v_mfma_f32_16x16x32_bf16 v[52:55], a[100:103], v[116:119], v[52:55]
  s_add_u32 s48, s26, 12288
  v_mul_f32 v28, v28, v68
  v_mul_f32 v29, v29, v69
  v_mfma_f32_16x16x32_bf16 v[56:59], a[100:103], v[120:123], v[56:59]
  buffer_load_dwordx4 a[72:75], v4, s[8:11], s48 offen offset:2048 sc1
  v_mfma_f32_16x16x32_bf16 v[60:63], a[100:103], v[124:127], v[60:63]
  s_waitcnt vmcnt(34) lgkmcnt(7)
  v_mul_f32 v30, v30, v70
  v_mul_f32 v31, v31, v71
  v_mfma_f32_16x16x32_bf16 v[32:35], a[104:107], v[176:179], v[32:35]
  s_waitcnt lgkmcnt(4)
  v_cvt_pk_bf16_f32 v66, v28, v29
  v_cvt_pk_bf16_f32 v67, v30, v31
  v_mfma_f32_16x16x32_bf16 v[36:39], a[104:107], v[180:183], v[36:39]
  s_add_u32 s44, s42, 8192
  v_permlane32_swap_b32 v64, v66
  v_permlane32_swap_b32 v65, v67
  v_mfma_f32_16x16x32_bf16 v[40:43], a[104:107], v[184:187], v[40:43]
  buffer_load_dwordx4 a[76:79], v4, s[8:11], s48 offen offset:3072 sc1
  v_mfma_f32_16x16x32_bf16 v[44:47], a[104:107], v[188:191], v[44:47]
  s_waitcnt vmcnt(34)
  v_or_b32 v64, 1, v64
  v_mfma_f32_16x16x32_bf16 v[48:51], a[108:111], v[176:179], v[48:51]
  buffer_store_dwordx4 v[64:67], v10, s[8:11], s44 offen sc1
  v_mfma_f32_16x16x32_bf16 v[52:55], a[108:111], v[180:183], v[52:55]
  s_waitcnt vmcnt(34)
  v_exp_f32 v24, v72
  v_mfma_f32_16x16x32_bf16 v[56:59], a[108:111], v[184:187], v[56:59]
  s_add_u32 s49, s31, 8192
  v_exp_f32 v25, v73
  v_mfma_f32_16x16x32_bf16 v[60:63], a[108:111], v[188:191], v[60:63]
  buffer_load_dwordx4 a[80:83], v4, s[8:11], s49 offen offset:1024 sc1
  v_mfma_f32_16x16x32_bf16 v[32:35], a[112:115], v[128:131], v[32:35]
  ds_read_b128 v[176:179], v8 offset:4096
  ds_read_b128 v[180:183], v8 offset:18432
  v_mfma_f32_16x16x32_bf16 v[36:39], a[112:115], v[132:135], v[36:39]
  v_exp_f32 v26, v74
  v_mfma_f32_16x16x32_bf16 v[40:43], a[112:115], v[136:139], v[40:43]
  s_waitcnt vmcnt(34)
  ds_read_b128 v[184:187], v9 offset:4096
  ds_read_b128 v[188:191], v9 offset:18432
  v_mfma_f32_16x16x32_bf16 v[44:47], a[112:115], v[140:143], v[44:47]
  buffer_load_dwordx4 a[84:87], v4, s[8:11], s49 offen offset:2048 sc1
  v_mfma_f32_16x16x32_bf16 v[48:51], a[116:119], v[128:131], v[48:51]
  v_exp_f32 v27, v75
  v_mfma_f32_16x16x32_bf16 v[52:55], a[116:119], v[132:135], v[52:55]
  v_mul_f32 v72, v72, v88
  v_mul_f32 v73, v73, v89
  v_mfma_f32_16x16x32_bf16 v[56:59], a[116:119], v[136:139], v[56:59]
  v_mul_f32 v74, v74, v90
  v_mul_f32 v75, v75, v91
  v_mfma_f32_16x16x32_bf16 v[60:63], a[116:119], v[140:143], v[60:63]
  s_waitcnt vmcnt(34) lgkmcnt(6)
  v_fma_f32 v24, v24, s54, s54
  v_fma_f32 v25, v25, s54, s54
  v_mfma_f32_16x16x32_bf16 v[32:35], a[120:123], v[192:195], v[32:35]
  buffer_load_dwordx4 a[88:91], v4, s[8:11], s49 offen offset:3072 sc1
  v_mfma_f32_16x16x32_bf16 v[36:39], a[120:123], v[196:199], v[36:39]
  s_waitcnt lgkmcnt(5)
  v_fma_f32 v26, v26, s54, s54
  v_fma_f32 v27, v27, s54, s54
  v_mfma_f32_16x16x32_bf16 v[40:43], a[120:123], v[200:203], v[40:43]
  s_waitcnt vmcnt(34) lgkmcnt(4)
  v_rcp_f32 v24, v24
  v_mfma_f32_16x16x32_bf16 v[44:47], a[120:123], v[204:207], v[44:47]
  s_add_u32 s46, s31, 12288
  v_rcp_f32 v25, v25
  v_mfma_f32_16x16x32_bf16 v[48:51], a[124:127], v[192:195], v[48:51]
  buffer_load_dwordx4 a[92:95], v4, s[8:11], s46 offen offset:0 sc1
  v_mfma_f32_16x16x32_bf16 v[52:55], a[124:127], v[196:199], v[52:55]
  v_rcp_f32 v26, v26
  v_mfma_f32_16x16x32_bf16 v[56:59], a[124:127], v[200:203], v[56:59]
  v_rcp_f32 v27, v27
  v_mfma_f32_16x16x32_bf16 v[60:63], a[124:127], v[204:207], v[60:63]
  s_waitcnt vmcnt(34) lgkmcnt(3)
  v_mul_f32 v24, v24, v72
  v_mul_f32 v25, v25, v73
  v_mfma_f32_16x16x32_bf16 v[32:35], a[128:131], v[176:179], v[32:35]
  s_waitcnt lgkmcnt(1)
  ds_read_b128 v[192:195], v8 offset:9216
  ds_read_b128 v[196:199], v8 offset:23552
  v_mfma_f32_16x16x32_bf16 v[36:39], a[128:131], v[180:183], v[36:39]
  buffer_load_dwordx4 a[96:99], v4, s[8:11], s46 offen offset:1024 sc1
  v_mfma_f32_16x16x32_bf16 v[40:43], a[128:131], v[184:187], v[40:43]
  s_waitcnt lgkmcnt(2)
  ds_read_b128 v[200:203], v9 offset:9216
  ds_read_b128 v[204:207], v9 offset:23552
  v_mfma_f32_16x16x32_bf16 v[44:47], a[128:131], v[188:191], v[44:47]
  s_waitcnt vmcnt(34)
  v_mul_f32 v26, v26, v74
  v_mul_f32 v27, v27, v75
  v_mfma_f32_16x16x32_bf16 v[48:51], a[132:135], v[176:179], v[48:51]
  v_cvt_pk_bf16_f32 v72, v24, v25
  v_cvt_pk_bf16_f32 v73, v26, v27
  v_mfma_f32_16x16x32_bf16 v[52:55], a[132:135], v[180:183], v[52:55]
  buffer_load_dwordx4 a[100:103], v4, s[8:11], s46 offen offset:2048 sc1
  v_mfma_f32_16x16x32_bf16 v[56:59], a[132:135], v[184:187], v[56:59]
  v_exp_f32 v28, v76
  v_mfma_f32_16x16x32_bf16 v[60:63], a[132:135], v[188:191], v[60:63]
  s_waitcnt vmcnt(34) lgkmcnt(3)
  v_exp_f32 v29, v77
  v_mfma_f32_16x16x32_bf16 v[32:35], a[136:139], v[192:195], v[32:35]
  s_waitcnt lgkmcnt(2)
  ds_read_b128 v[176:179], v8 offset:5120
  ds_read_b128 v[180:183], v8 offset:19456
  v_mfma_f32_16x16x32_bf16 v[36:39], a[136:139], v[196:199], v[36:39]
  s_waitcnt lgkmcnt(3)
  v_exp_f32 v30, v78
  v_mfma_f32_16x16x32_bf16 v[40:43], a[136:139], v[200:203], v[40:43]
  s_waitcnt vmcnt(32) lgkmcnt(2)
  ds_read_b128 v[184:187], v9 offset:5120
  ds_read_b128 v[188:191], v9 offset:19456
  v_mfma_f32_16x16x32_bf16 v[44:47], a[136:139], v[204:207], v[44:47]
  buffer_load_dwordx4 a[104:107], v4, s[8:11], s46 offen offset:3072 sc1
  v_mfma_f32_16x16x32_bf16 v[48:51], a[140:143], v[192:195], v[48:51]
  v_exp_f32 v31, v79
  v_mfma_f32_16x16x32_bf16 v[52:55], a[140:143], v[196:199], v[52:55]
  s_add_u32 s35, s16, 0
  v_mul_f32 v76, v76, v92
  v_mul_f32 v77, v77, v93
  v_mfma_f32_16x16x32_bf16 v[56:59], a[140:143], v[200:203], v[56:59]
  buffer_load_dwordx4 a[108:111], v4, s[8:11], s35 offen sc1
  v_mfma_f32_16x16x32_bf16 v[60:63], a[140:143], v[204:207], v[60:63]
  s_waitcnt vmcnt(33) lgkmcnt(3)
  v_mul_f32 v78, v78, v94
  v_mul_f32 v79, v79, v95
  v_mfma_f32_16x16x32_bf16 v[32:35], a[144:147], v[176:179], v[32:35]
  s_waitcnt lgkmcnt(2)
  ds_read_b128 v[192:195], v8 offset:8192
  ds_read_b128 v[196:199], v8 offset:22528
  v_mfma_f32_16x16x32_bf16 v[36:39], a[144:147], v[180:183], v[36:39]
  s_waitcnt lgkmcnt(3)
  v_fma_f32 v28, v28, s54, s54
  v_fma_f32 v29, v29, s54, s54
  v_mfma_f32_16x16x32_bf16 v[40:43], a[144:147], v[184:187], v[40:43]
  s_waitcnt vmcnt(32) lgkmcnt(2)
  ds_read_b128 v[200:203], v9 offset:8192
  ds_read_b128 v[204:207], v9 offset:22528
  v_mfma_f32_16x16x32_bf16 v[44:47], a[144:147], v[188:191], v[44:47]
  s_add_u32 s35, s17, 0
  v_fma_f32 v30, v30, s54, s54
  v_fma_f32 v31, v31, s54, s54
  v_mfma_f32_16x16x32_bf16 v[48:51], a[148:151], v[176:179], v[48:51]
  buffer_load_dwordx4 a[112:115], v4, s[8:11], s35 offen sc1
  v_mfma_f32_16x16x32_bf16 v[52:55], a[148:151], v[180:183], v[52:55]
  v_rcp_f32 v28, v28
  v_mfma_f32_16x16x32_bf16 v[56:59], a[148:151], v[184:187], v[56:59]
  s_waitcnt vmcnt(32) lgkmcnt(2)
  v_rcp_f32 v29, v29
  v_mfma_f32_16x16x32_bf16 v[60:63], a[148:151], v[188:191], v[60:63]
  s_add_u32 s35, s18, 0
  v_rcp_f32 v30, v30
  v_mfma_f32_16x16x32_bf16 v[32:35], a[152:155], v[192:195], v[32:35]
  buffer_load_dwordx4 a[116:119], v4, s[8:11], s35 offen sc1
  v_mfma_f32_16x16x32_bf16 v[36:39], a[152:155], v[196:199], v[36:39]
  s_waitcnt lgkmcnt(1)
  v_rcp_f32 v31, v31
  v_mfma_f32_16x16x32_bf16 v[40:43], a[152:155], v[200:203], v[40:43]
  s_waitcnt lgkmcnt(0)
  v_mul_f32 v28, v28, v76
  v_mul_f32 v29, v29, v77
  v_mfma_f32_16x16x32_bf16 v[44:47], a[152:155], v[204:207], v[44:47]
  s_waitcnt vmcnt(32)
  v_mul_f32 v30, v30, v78
  v_mul_f32 v31, v31, v79
  v_mfma_f32_16x16x32_bf16 v[48:51], a[156:159], v[192:195], v[48:51]
  v_cvt_pk_bf16_f32 v74, v28, v29
  v_cvt_pk_bf16_f32 v75, v30, v31
  v_mfma_f32_16x16x32_bf16 v[52:55], a[156:159], v[196:199], v[52:55]
  s_add_u32 s35, s19, 0
  v_permlane32_swap_b32 v72, v74
  v_permlane32_swap_b32 v73, v75
  v_mfma_f32_16x16x32_bf16 v[56:59], a[156:159], v[200:203], v[56:59]
  buffer_load_dwordx4 a[120:123], v4, s[8:11], s35 offen sc1
  v_mfma_f32_16x16x32_bf16 v[60:63], a[156:159], v[204:207], v[60:63]
  s_waitcnt vmcnt(32)
  v_or_b32 v72, 1, v72
  v_mfma_f32_16x16x32_bf16 v[32:35], a[0:3], v[144:147], v[32:35]
  buffer_store_dwordx4 v[72:75], v11, s[8:11], s44 offen sc1
  v_mfma_f32_16x16x32_bf16 v[36:39], a[0:3], v[148:151], v[36:39]
  s_waitcnt vmcnt(32)
  v_lshl_add_u32 v88, s20, 10, v4
  v_xor_b32 v89, 1024, v88
  v_mfma_f32_16x16x32_bf16 v[40:43], a[0:3], v[152:155], v[40:43]
  s_add_u32 s47, s43, 1835008
  v_xor_b32 v90, 2048, v88
  v_xor_b32 v91, 3072, v88
  v_mfma_f32_16x16x32_bf16 v[44:47], a[0:3], v[156:159], v[44:47]
  buffer_load_dwordx4 a[124:127], v88, s[8:11], s47 offen sc1
  v_mfma_f32_16x16x32_bf16 v[48:51], a[4:7], v[144:147], v[48:51]
  v_mfma_f32_16x16x32_bf16 v[52:55], a[4:7], v[148:151], v[52:55]
  v_mfma_f32_16x16x32_bf16 v[56:59], a[4:7], v[152:155], v[56:59]
  v_mfma_f32_16x16x32_bf16 v[60:63], a[4:7], v[156:159], v[60:63]
  s_waitcnt vmcnt(32)
  v_mfma_f32_16x16x32_bf16 v[32:35], a[8:11], v[160:163], v[32:35]
  buffer_load_dwordx4 a[128:131], v89, s[8:11], s47 offen sc1
  v_mfma_f32_16x16x32_bf16 v[36:39], a[8:11], v[164:167], v[36:39]
  v_mfma_f32_16x16x32_bf16 v[40:43], a[8:11], v[168:171], v[40:43]
  v_mfma_f32_16x16x32_bf16 v[44:47], a[8:11], v[172:175], v[44:47]
  s_waitcnt vmcnt(32)
  v_mfma_f32_16x16x32_bf16 v[48:51], a[12:15], v[160:163], v[48:51]
  v_mfma_f32_16x16x32_bf16 v[52:55], a[12:15], v[164:167], v[52:55]
  buffer_load_dwordx4 a[132:135], v90, s[8:11], s47 offen sc1
  v_mfma_f32_16x16x32_bf16 v[56:59], a[12:15], v[168:171], v[56:59]
  v_mfma_f32_16x16x32_bf16 v[60:63], a[12:15], v[172:175], v[60:63]
  s_waitcnt vmcnt(32)
  v_mfma_f32_16x16x32_bf16 v[64:67], a[16:19], v[96:99], 0
  v_mfma_f32_16x16x32_bf16 v[68:71], a[16:19], v[100:103], 0
  v_mfma_f32_16x16x32_bf16 v[72:75], a[16:19], v[104:107], 0
  buffer_load_dwordx4 v[96:99], v91, s[8:11], s47 offen sc1
  v_exp_f32 v24, v32
  v_mfma_f32_16x16x32_bf16 v[76:79], a[16:19], v[108:111], 0
  s_waitcnt vmcnt(32)
  v_exp_f32 v25, v33
  v_exp_f32 v26, v34
  v_mfma_f32_16x16x32_bf16 v[64:67], a[20:23], v[112:115], v[64:67]
  v_exp_f32 v27, v35
  v_mul_f32 v32, v32, v48
  v_mul_f32 v33, v33, v49
  v_mfma_f32_16x16x32_bf16 v[68:71], a[20:23], v[116:119], v[68:71]
  v_mul_f32 v34, v34, v50
  v_mul_f32 v35, v35, v51
  v_fma_f32 v24, v24, s54, s54
  v_fma_f32 v25, v25, s54, s54
  v_mfma_f32_16x16x32_bf16 v[72:75], a[20:23], v[120:123], v[72:75]
  s_waitcnt vmcnt(31)
  v_fma_f32 v26, v26, s54, s54
  v_fma_f32 v27, v27, s54, s54
  v_rcp_f32 v24, v24
  v_mfma_f32_16x16x32_bf16 v[76:79], a[20:23], v[124:127], v[76:79]
  s_add_u32 s48, s43, 4096
  v_rcp_f32 v25, v25
  v_rcp_f32 v26, v26
  v_mfma_f32_16x16x32_bf16 v[64:67], a[24:27], v[128:131], v[64:67]
  buffer_load_dwordx4 v[100:103], v88, s[8:11], s48 offen sc1
  v_rcp_f32 v27, v27
  v_mfma_f32_16x16x32_bf16 v[68:71], a[24:27], v[132:135], v[68:71]
  v_mul_f32 v24, v24, v32
  v_mul_f32 v25, v25, v33
  v_mul_f32 v26, v26, v34
  v_mul_f32 v27, v27, v35
  v_mfma_f32_16x16x32_bf16 v[72:75], a[24:27], v[136:139], v[72:75]
  v_cvt_pk_bf16_f32 v32, v24, v25
  v_cvt_pk_bf16_f32 v33, v26, v27
  v_exp_f32 v28, v36
  v_mfma_f32_16x16x32_bf16 v[76:79], a[24:27], v[140:143], v[76:79]
  s_waitcnt vmcnt(31)
  v_exp_f32 v29, v37
  v_exp_f32 v30, v38
  v_mfma_f32_16x16x32_bf16 v[64:67], a[28:31], v[176:179], v[64:67]
  v_exp_f32 v31, v39
  v_mul_f32 v36, v36, v52
  v_mul_f32 v37, v37, v53
  v_mfma_f32_16x16x32_bf16 v[68:71], a[28:31], v[180:183], v[68:71]
  buffer_load_dwordx4 v[104:107], v89, s[8:11], s48 offen sc1
  v_mul_f32 v38, v38, v54
  v_mul_f32 v39, v39, v55
  v_mfma_f32_16x16x32_bf16 v[72:75], a[28:31], v[184:187], v[72:75]
  v_fma_f32 v28, v28, s54, s54
  v_fma_f32 v29, v29, s54, s54
  v_fma_f32 v30, v30, s54, s54
  v_fma_f32 v31, v31, s54, s54
  v_mfma_f32_16x16x32_bf16 v[76:79], a[28:31], v[188:191], v[76:79]
  s_waitcnt vmcnt(30)
  v_rcp_f32 v28, v28
  v_rcp_f32 v29, v29
  v_mfma_f32_16x16x32_bf16 v[64:67], a[32:35], v[192:195], v[64:67]
  ds_read_b128 v[176:179], v8 offset:11264
  ds_read_b128 v[180:183], v8 offset:25600
  v_rcp_f32 v30, v30
  v_mfma_f32_16x16x32_bf16 v[68:71], a[32:35], v[196:199], v[68:71]
  v_rcp_f32 v31, v31
  v_mul_f32 v28, v28, v36
  v_mul_f32 v29, v29, v37
  v_mfma_f32_16x16x32_bf16 v[72:75], a[32:35], v[200:203], v[72:75]
  s_waitcnt vmcnt(29)
  ds_read_b128 v[184:187], v9 offset:11264
  ds_read_b128 v[188:191], v9 offset:25600
  v_mul_f32 v30, v30, v38
  v_mul_f32 v31, v31, v39
  v_mfma_f32_16x16x32_bf16 v[76:79], a[32:35], v[204:207], v[76:79]
  buffer_load_dwordx4 v[108:111], v90, s[8:11], s48 offen sc1
  v_cvt_pk_bf16_f32 v34, v28, v29
  v_cvt_pk_bf16_f32 v35, v30, v31
  v_mfma_f32_16x16x32_bf16 v[64:67], a[36:39], v[208:211], v[64:67]
  ds_read_b128 v[192:195], v8 offset:10240
  ds_read_b128 v[196:199], v8 offset:24576
  v_mfma_f32_16x16x32_bf16 v[68:71], a[36:39], v[212:215], v[68:71]
  s_add_u32 s44, s42, 16384
  v_permlane32_swap_b32 v32, v34
  v_permlane32_swap_b32 v33, v35
  v_or_b32 v32, 1, v32
  v_mfma_f32_16x16x32_bf16 v[72:75], a[36:39], v[216:219], v[72:75]
  s_waitcnt vmcnt(29)
  ds_read_b128 v[200:203], v9 offset:10240
  ds_read_b128 v[204:207], v9 offset:24576
  v_mfma_f32_16x16x32_bf16 v[76:79], a[36:39], v[220:223], v[76:79]
  buffer_load_dwordx4 v[112:115], v91, s[8:11], s48 offen sc1
  v_mfma_f32_16x16x32_bf16 v[64:67], a[40:43], v[224:227], v[64:67]
  buffer_store_dwordx4 v[32:35], v10, s[8:11], s44 offen sc1
  v_exp_f32 v24, v40
  v_mfma_f32_16x16x32_bf16 v[68:71], a[40:43], v[228:231], v[68:71]
  v_exp_f32 v25, v41
  v_exp_f32 v26, v42
  v_mfma_f32_16x16x32_bf16 v[72:75], a[40:43], v[232:235], v[72:75]
  s_waitcnt vmcnt(30)
  v_exp_f32 v27, v43
  v_mul_f32 v40, v40, v56
  v_mul_f32 v41, v41, v57
  v_mfma_f32_16x16x32_bf16 v[76:79], a[40:43], v[236:239], v[76:79]
  s_add_u32 s49, s43, 1839104
  v_mul_f32 v42, v42, v58
  v_mul_f32 v43, v43, v59
  v_fma_f32 v24, v24, s54, s54
  v_fma_f32 v25, v25, s54, s54
  v_mfma_f32_16x16x32_bf16 v[64:67], a[44:47], v[240:243], v[64:67]
  buffer_load_dwordx4 v[116:119], v88, s[8:11], s49 offen sc1
  v_fma_f32 v26, v26, s54, s54
  v_fma_f32 v27, v27, s54, s54
  v_mfma_f32_16x16x32_bf16 v[68:71], a[44:47], v[244:247], v[68:71]
  v_rcp_f32 v24, v24
  v_rcp_f32 v25, v25
  v_mfma_f32_16x16x32_bf16 v[72:75], a[44:47], v[248:251], v[72:75]
  v_rcp_f32 v26, v26
  v_rcp_f32 v27, v27
  v_mfma_f32_16x16x32_bf16 v[76:79], a[44:47], v[252:255], v[76:79]
  s_waitcnt vmcnt(30) lgkmcnt(7)
  v_mul_f32 v24, v24, v40
  v_mul_f32 v25, v25, v41
  v_mul_f32 v26, v26, v42
  v_mul_f32 v27, v27, v43
  v_mfma_f32_16x16x32_bf16 v[64:67], a[48:51], v[176:179], v[64:67]
  s_waitcnt lgkmcnt(6)
  v_cvt_pk_bf16_f32 v40, v24, v25
  v_cvt_pk_bf16_f32 v41, v26, v27
  v_exp_f32 v28, v44
  v_mfma_f32_16x16x32_bf16 v[68:71], a[48:51], v[180:183], v[68:71]
  s_waitcnt lgkmcnt(4)
  v_exp_f32 v29, v45
  v_exp_f32 v30, v46
  v_mfma_f32_16x16x32_bf16 v[72:75], a[48:51], v[184:187], v[72:75]
  buffer_load_dwordx4 v[120:123], v89, s[8:11], s49 offen sc1
  v_exp_f32 v31, v47
  v_mfma_f32_16x16x32_bf16 v[76:79], a[48:51], v[188:191], v[76:79]
  s_waitcnt vmcnt(30) lgkmcnt(3)
  v_mul_f32 v44, v44, v60
  v_mul_f32 v45, v45, v61
  v_mul_f32 v46, v46, v62
  v_mul_f32 v47, v47, v63
  v_mfma_f32_16x16x32_bf16 v[64:67], a[52:55], v[192:195], v[64:67]
  s_waitcnt lgkmcnt(2)
  ds_read_b128 v[176:179], v8 offset:4096
  ds_read_b128 v[180:183], v8 offset:18432
  v_fma_f32 v28, v28, s54, s54
  v_fma_f32 v29, v29, s54, s54
  v_mfma_f32_16x16x32_bf16 v[68:71], a[52:55], v[196:199], v[68:71]
  s_waitcnt lgkmcnt(3)
  v_fma_f32 v30, v30, s54, s54
  v_fma_f32 v31, v31, s54, s54
  v_rcp_f32 v28, v28
  v_mfma_f32_16x16x32_bf16 v[72:75], a[52:55], v[200:203], v[72:75]
  s_waitcnt vmcnt(29) lgkmcnt(2)
  ds_read_b128 v[184:187], v9 offset:4096
  ds_read_b128 v[188:191], v9 offset:18432
  v_rcp_f32 v29, v29
  v_mfma_f32_16x16x32_bf16 v[76:79], a[52:55], v[204:207], v[76:79]
  buffer_load_dwordx4 v[124:127], v90, s[8:11], s49 offen sc1
  v_rcp_f32 v30, v30
  v_mfma_f32_16x16x32_bf16 v[64:67], a[56:59], v[144:147], v[64:67]
  ds_read_b128 v[192:195], v8 offset:9216
  ds_read_b128 v[196:199], v8 offset:23552
  v_rcp_f32 v31, v31
  v_mfma_f32_16x16x32_bf16 v[68:71], a[56:59], v[148:151], v[68:71]
  v_mul_f32 v28, v28, v44
  v_mul_f32 v29, v29, v45
  v_mul_f32 v30, v30, v46
  v_mul_f32 v31, v31, v47
  v_mfma_f32_16x16x32_bf16 v[72:75], a[56:59], v[152:155], v[72:75]
  ds_read_b128 v[200:203], v9 offset:9216
  ds_read_b128 v[204:207], v9 offset:23552
  ds_read_b128 a[136:139], v20 offset:0
  v_cvt_pk_bf16_f32 v42, v28, v29
  v_mfma_f32_16x16x32_bf16 v[76:79], a[56:59], v[156:159], v[76:79]
  ds_read_b128 a[140:143], v20 offset:4096
  v_cvt_pk_bf16_f32 v43, v30, v31
  v_permlane32_swap_b32 v40, v42
  s_nop 0
  v_permlane32_swap_b32 v41, v43
  s_waitcnt vmcnt(29)
  v_mfma_f32_16x16x32_bf16 v[64:67], a[60:63], v[160:163], v[64:67]
  ds_read_b128 a[144:147], v20 offset:8192
  v_or_b32 v40, 1, v40
  v_mfma_f32_16x16x32_bf16 v[68:71], a[60:63], v[164:167], v[68:71]
  s_waitcnt vmcnt(28) lgkmcnt(10)
  ds_read_b128 a[148:151], v20 offset:12288
  v_mfma_f32_16x16x32_bf16 v[72:75], a[60:63], v[168:171], v[72:75]
  buffer_load_dwordx4 v[128:131], v91, s[8:11], s49 offen sc1
  v_mfma_f32_16x16x32_bf16 v[76:79], a[60:63], v[172:175], v[76:79]
  buffer_store_dwordx4 v[40:43], v11, s[8:11], s44 offen sc1
  v_mfma_f32_16x16x32_bf16 v[64:67], a[64:67], v[176:179], v[64:67]
  s_add_u32 s46, s43, 8192
  v_add_u32 v244, s56, v4
  v_min_u32 v252, 1, v3
  v_add_u32 v253, s58, v244
  v_mad_i32_i24 v252, v252, s69, v253
  s_waitcnt lgkmcnt(10)
  v_mfma_f32_16x16x32_bf16 v[68:71], a[64:67], v[180:183], v[68:71]
  s_waitcnt vmcnt(18) lgkmcnt(9)
  v_accvgpr_read_b32 v21, a108
  s_waitcnt vmcnt(17)
  v_accvgpr_read_b32 v22, a112
  s_waitcnt vmcnt(16)
  v_accvgpr_read_b32 v19, a116
  v_bitop3_b32 v21, v21, v22, v19 bitop3:0x80
  v_mfma_f32_16x16x32_bf16 v[72:75], a[64:67], v[184:187], v[72:75]
  s_waitcnt vmcnt(15) lgkmcnt(8)
  v_accvgpr_read_b32 v22, a120
  v_bitop3_b32 v21, v21, v22, 1 bitop3:0x80
  v_cmp_ne_u32 vcc, 1, v21
  v_add_u32 v253, s57, v244
  v_mfma_f32_16x16x32_bf16 v[76:79], a[64:67], v[188:191], v[76:79]
  s_cbranch_vccnz k_hs1_0
k_hb1_0:
  buffer_load_dwordx4 v[132:135], v88, s[8:11], s46 offen sc1
  v_lshl_add_u32 v254, s20, 4, v2
  v_lshlrev_b32 v254, 3, v254
  s_waitcnt lgkmcnt(7)
  v_mfma_f32_16x16x32_bf16 v[64:67], a[68:71], v[192:195], v[64:67]
  s_waitcnt lgkmcnt(6)
  v_add_u32 v254, 153600, v254
  ds_read_u16 v252, v252
  ds_read_u16 v253, v253
  ds_read_b64 v[254:255], v254
  v_mfma_f32_16x16x32_bf16 v[68:71], a[68:71], v[196:199], v[68:71]
  s_waitcnt lgkmcnt(7)
  ds_read_b128 v[248:251], v244 offset:1024
  ds_read_b128 v[244:247], v244
  v_mfma_f32_16x16x32_bf16 v[72:75], a[68:71], v[200:203], v[72:75]
  buffer_load_dwordx4 v[136:139], v89, s[8:11], s46 offen sc1
  v_mfma_f32_16x16x32_bf16 v[76:79], a[68:71], v[204:207], v[76:79]
  s_waitcnt lgkmcnt(8)
  v_mfma_f32_16x16x32_bf16 v[144:147], a[136:139], a[108:111], 0
  s_waitcnt lgkmcnt(7)
  v_mfma_f32_16x16x32_bf16 v[148:151], a[140:143], a[108:111], 0
  s_waitcnt lgkmcnt(5)
  v_mfma_f32_16x16x32_bf16 v[152:155], a[144:147], a[108:111], 0
  ds_write_b128 v17, v[72:75] offset:0
  ds_read_b128 a[152:155], v20 offset:16384
  v_mfma_f32_16x16x32_bf16 v[156:159], a[148:151], a[108:111], 0
  ds_write_b128 v17, v[76:79] offset:1024
  ds_read_b128 a[156:159], v20 offset:20480
  v_mfma_f32_16x16x32_bf16 v[160:163], a[136:139], a[112:115], 0
  ds_read_b128 a[0:3], v20 offset:24576
  v_mfma_f32_16x16x32_bf16 v[164:167], a[140:143], a[112:115], 0
  s_waitcnt lgkmcnt(2)
  ds_read_b128 a[4:7], v20 offset:28672
  v_mfma_f32_16x16x32_bf16 v[168:171], a[144:147], a[112:115], 0
  s_barrier
  ds_read_b128 v[80:83], v18 offset:0
  ds_read_b128 v[84:87], v18 offset:1024
  v_mfma_f32_16x16x32_bf16 v[172:175], a[148:151], a[112:115], 0
  buffer_load_dwordx4 v[140:143], v90, s[8:11], s46 offen sc1
  v_mfma_f32_16x16x32_bf16 v[176:179], a[136:139], a[116:119], 0
  buffer_load_dwordx4 v[208:211], v91, s[8:11], s46 offen sc1
  v_mfma_f32_16x16x32_bf16 v[180:183], a[140:143], a[116:119], 0
  v_mfma_f32_16x16x32_bf16 v[184:187], a[144:147], a[116:119], 0
  s_waitcnt vmcnt(17)
  v_accvgpr_read_b32 v21, a124
  s_waitcnt vmcnt(16)
  v_accvgpr_read_b32 v22, a128
  s_waitcnt vmcnt(15)
  v_accvgpr_read_b32 v19, a132
  v_bitop3_b32 v21, v21, v22, v19 bitop3:0x80
  v_mfma_f32_16x16x32_bf16 v[188:191], a[148:151], a[116:119], 0
  s_waitcnt vmcnt(14)
  v_bitop3_b32 v21, v21, v96, 1 bitop3:0x80
  v_cmp_ne_u32 vcc, 1, v21
  s_waitcnt lgkmcnt(1)
  v_cndmask_b32 v24, v64, v80, s[52:53]
  v_cndmask_b32 v25, v65, v81, s[52:53]
  v_mfma_f32_16x16x32_bf16 v[192:195], a[136:139], a[120:123], 0
  s_cbranch_vccnz k_hs1_1
k_hb1_1:
  v_cndmask_b32 v26, v66, v82, s[52:53]
  v_cndmask_b32 v27, v67, v83, s[52:53]
  v_exp_f32 v24, v24
  v_mfma_f32_16x16x32_bf16 v[196:199], a[140:143], a[120:123], 0
  s_add_u32 s47, s43, 1843200
  buffer_load_dwordx4 v[212:215], v88, s[8:11], s47 offen sc1
  v_exp_f32 v25, v25
  v_mfma_f32_16x16x32_bf16 v[200:203], a[144:147], a[120:123], 0
  v_exp_f32 v26, v26
  v_exp_f32 v27, v27
  v_mfma_f32_16x16x32_bf16 v[204:207], a[148:151], a[120:123], 0
  buffer_load_dwordx4 v[216:219], v89, s[8:11], s47 offen sc1
  v_mul_f32 v64, v64, v80
  v_mul_f32 v65, v65, v81
  v_mfma_f32_16x16x32_bf16 v[144:147], a[152:155], a[124:127], v[144:147]
  v_mul_f32 v66, v66, v82
  v_mul_f32 v67, v67, v83
  v_fma_f32 v24, v24, s54, s54
  v_fma_f32 v25, v25, s54, s54
  v_mfma_f32_16x16x32_bf16 v[148:151], a[156:159], a[124:127], v[148:151]
  v_fma_f32 v26, v26, s54, s54
  v_fma_f32 v27, v27, s54, s54
  v_rcp_f32 v24, v24
  v_mfma_f32_16x16x32_bf16 v[152:155], a[0:3], a[124:127], v[152:155]
  ds_read_b128 a[8:11], v20 offset:32768
  v_rcp_f32 v25, v25
  v_mfma_f32_16x16x32_bf16 v[156:159], a[4:7], a[124:127], v[156:159]
  ds_read_b128 a[12:15], v20 offset:36864
  v_rcp_f32 v26, v26
  v_mfma_f32_16x16x32_bf16 v[160:163], a[152:155], a[128:131], v[160:163]
  ds_read_b128 a[16:19], v20 offset:40960
  v_rcp_f32 v27, v27
  v_mul_f32 v24, v24, v64
  v_mfma_f32_16x16x32_bf16 v[164:167], a[156:159], a[128:131], v[164:167]
  ds_read_b128 a[20:23], v20 offset:45056
  v_mul_f32 v25, v25, v65
  v_mul_f32 v26, v26, v66
  v_mul_f32 v27, v27, v67
  v_mfma_f32_16x16x32_bf16 v[168:171], a[0:3], a[128:131], v[168:171]
  buffer_load_dwordx4 v[220:223], v90, s[8:11], s47 offen sc1
  v_cvt_pk_bf16_f32 v64, v24, v25
  v_cvt_pk_bf16_f32 v65, v26, v27
  v_mfma_f32_16x16x32_bf16 v[172:175], a[4:7], a[128:131], v[172:175]
  s_waitcnt lgkmcnt(4)
  v_cndmask_b32 v28, v68, v84, s[52:53]
  v_cndmask_b32 v29, v69, v85, s[52:53]
  v_cndmask_b32 v30, v70, v86, s[52:53]
  v_cndmask_b32 v31, v71, v87, s[52:53]
  v_mfma_f32_16x16x32_bf16 v[176:179], a[152:155], a[132:135], v[176:179]
  buffer_load_dwordx4 v[224:227], v91, s[8:11], s47 offen sc1
  v_exp_f32 v28, v28
  v_mfma_f32_16x16x32_bf16 v[180:183], a[156:159], a[132:135], v[180:183]
  v_exp_f32 v29, v29
  v_exp_f32 v30, v30
  v_mfma_f32_16x16x32_bf16 v[184:187], a[0:3], a[132:135], v[184:187]
  v_exp_f32 v31, v31
  v_mul_f32 v68, v68, v84
  v_mul_f32 v69, v69, v85
  v_mfma_f32_16x16x32_bf16 v[188:191], a[4:7], a[132:135], v[188:191]
  s_waitcnt vmcnt(15)
  v_bitop3_b32 v21, v100, v104, v108 bitop3:0x80
  s_waitcnt vmcnt(14)
  v_bitop3_b32 v21, v21, v112, 1 bitop3:0x80
  v_cmp_ne_u32 vcc, 1, v21
  v_mul_f32 v70, v70, v86
  v_mfma_f32_16x16x32_bf16 v[192:195], a[152:155], v[96:99], v[192:195]
  s_cbranch_vccnz k_hs1_2
k_hb1_2:
  v_mul_f32 v71, v71, v87
  v_fma_f32 v28, v28, s54, s54
  v_fma_f32 v29, v29, s54, s54
  v_fma_f32 v30, v30, s54, s54
  v_mfma_f32_16x16x32_bf16 v[196:199], a[156:159], v[96:99], v[196:199]
  s_add_u32 s48, s43, 12288
  buffer_load_dwordx4 v[228:231], v88, s[8:11], s48 offen sc1
  v_fma_f32 v31, v31, s54, s54
  v_mfma_f32_16x16x32_bf16 v[200:203], a[0:3], v[96:99], v[200:203]
  v_rcp_f32 v28, v28
  v_rcp_f32 v29, v29
  v_mfma_f32_16x16x32_bf16 v[204:207], a[4:7], v[96:99], v[204:207]
  s_waitcnt lgkmcnt(3)
  v_rcp_f32 v30, v30
  v_rcp_f32 v31, v31
  v_mfma_f32_16x16x32_bf16 v[144:147], a[8:11], v[100:103], v[144:147]
  s_waitcnt lgkmcnt(1)
  v_mul_f32 v28, v28, v68
  v_mul_f32 v29, v29, v69
  v_mul_f32 v30, v30, v70
  v_mul_f32 v31, v31, v71
  v_mfma_f32_16x16x32_bf16 v[148:151], a[12:15], v[100:103], v[148:151]
  buffer_load_dwordx4 v[232:235], v89, s[8:11], s48 offen sc1
  v_cvt_pk_bf16_f32 v66, v28, v29
  v_cvt_pk_bf16_f32 v67, v30, v31
  v_mfma_f32_16x16x32_bf16 v[152:155], a[16:19], v[100:103], v[152:155]
  s_waitcnt lgkmcnt(0)
  ds_read_b128 a[24:27], v20 offset:49152
  v_permlane32_swap_b32 v64, v66
  v_permlane32_swap_b32 v65, v67
  v_or_b32 v64, 1, v64
  v_mfma_f32_16x16x32_bf16 v[156:159], a[20:23], v[100:103], v[156:159]
  ds_read_b128 a[28:31], v20 offset:53248
  v_mfma_f32_16x16x32_bf16 v[160:163], a[8:11], v[104:107], v[160:163]
  buffer_store_dwordx4 v[64:67], v12, s[8:11], s42 offen sc1
  v_lshlrev_b32 v48, 16, v252
  v_perm_b32 v49, v244, v243, s59
  v_mfma_f32_16x16x32_bf16 v[164:167], a[12:15], v[104:107], v[164:167]
  buffer_load_dwordx4 v[236:239], v90, s[8:11], s48 offen sc1
  v_perm_b32 v50, v245, v244, s60
  v_perm_b32 v51, v245, v244, s59
  v_mfma_f32_16x16x32_bf16 v[168:171], a[16:19], v[104:107], v[168:171]
  v_perm_b32 v52, v246, v245, s60
  v_perm_b32 v53, v246, v245, s59
  v_perm_b32 v54, v247, v246, s60
  v_perm_b32 v55, v247, v246, s59
  v_mfma_f32_16x16x32_bf16 v[172:175], a[20:23], v[104:107], v[172:175]
  v_lshlrev_b32 v56, 16, v253
  v_perm_b32 v57, v248, v247, s59
  v_perm_b32 v58, v249, v248, s60
  v_perm_b32 v59, v249, v248, s59
  v_mfma_f32_16x16x32_bf16 v[176:179], a[8:11], v[108:111], v[176:179]
  v_perm_b32 v60, v250, v249, s60
  v_perm_b32 v61, v250, v249, s59
  v_perm_b32 v62, v251, v250, s60
  v_perm_b32 v63, v251, v250, s59
  v_mfma_f32_16x16x32_bf16 v[180:183], a[12:15], v[108:111], v[180:183]
  v_fma_f32 v48, v48, v255, v254
  v_fma_f32 v49, v49, v255, v254
  v_fma_f32 v50, v50, v255, v254
  v_fma_f32 v51, v51, v255, v254
  v_mfma_f32_16x16x32_bf16 v[184:187], a[16:19], v[108:111], v[184:187]
  buffer_load_dwordx4 v[240:243], v91, s[8:11], s48 offen sc1
  v_fma_f32 v52, v52, v255, v254
  v_fma_f32 v53, v53, v255, v254
  v_mfma_f32_16x16x32_bf16 v[188:191], a[20:23], v[108:111], v[188:191]
  s_waitcnt vmcnt(15)
  v_bitop3_b32 v21, v116, v120, v124 bitop3:0x80
  s_waitcnt vmcnt(14)
  v_bitop3_b32 v21, v21, v128, 1 bitop3:0x80
  v_cmp_ne_u32 vcc, 1, v21
  v_fma_f32 v54, v54, v255, v254
  v_mfma_f32_16x16x32_bf16 v[192:195], a[8:11], v[112:115], v[192:195]
  s_cbranch_vccnz k_hs1_3
k_hb1_3:
  v_fma_f32 v55, v55, v255, v254
  v_fma_f32 v56, v56, v255, v254
  v_fma_f32 v57, v57, v255, v254
  v_fma_f32 v58, v58, v255, v254
  v_mfma_f32_16x16x32_bf16 v[196:199], a[12:15], v[112:115], v[196:199]
  s_add_u32 s49, s43, 1847296
  v_fma_f32 v59, v59, v255, v254
  v_fma_f32 v60, v60, v255, v254
  v_fma_f32 v61, v61, v255, v254
  v_fma_f32 v62, v62, v255, v254
  v_mfma_f32_16x16x32_bf16 v[200:203], a[16:19], v[112:115], v[200:203]
  buffer_load_dwordx4 v[32:35], v88, s[8:11], s49 offen sc1
  v_fma_f32 v63, v63, v255, v254
  v_mul_u32_u24 v94, s61, v2
  v_mfma_f32_16x16x32_bf16 v[204:207], a[20:23], v[112:115], v[204:207]
  s_waitcnt lgkmcnt(1)
  v_mad_u32_u24 v94, v3, s63, v94
  v_add_u32 v94, s55, v94
  v_add_u32 v95, 1, v3
  v_lshrrev_b32 v95, 2, v95
  v_mfma_f32_16x16x32_bf16 v[144:147], a[24:27], v[116:119], v[144:147]
  s_waitcnt lgkmcnt(0)
  v_lshl_add_u32 v95, v95, 31, v94
  v_lshl_add_u32 v95, s63, 2, v95
  v_add_u32 v47, s39, v4
  v_mfma_f32_16x16x32_bf16 v[148:151], a[28:31], v[116:119], v[148:151]
  s_xor_b32 s34, s20, 1
  v_mfma_f32_16x16x32_bf16 v[152:155], a[72:75], v[116:119], v[152:155]
  ds_read_b128 a[32:35], v13 offset:0
  v_mfma_f32_16x16x32_bf16 v[156:159], a[76:79], v[116:119], v[156:159]
  ds_read_b128 a[36:39], v13 offset:4096
  v_mfma_f32_16x16x32_bf16 v[160:163], a[24:27], v[120:123], v[160:163]
  ds_read_b128 a[40:43], v13 offset:8192
  v_mfma_f32_16x16x32_bf16 v[164:167], a[28:31], v[120:123], v[164:167]
  ds_read_b128 a[44:47], v13 offset:12288
  v_mfma_f32_16x16x32_bf16 v[168:171], a[72:75], v[120:123], v[168:171]
  buffer_load_dwordx4 v[36:39], v89, s[8:11], s49 offen sc1
  v_mfma_f32_16x16x32_bf16 v[172:175], a[76:79], v[120:123], v[172:175]
  buffer_load_dwordx4 v[40:43], v90, s[8:11], s49 offen sc1
  v_mfma_f32_16x16x32_bf16 v[176:179], a[24:27], v[124:127], v[176:179]
  s_mul_i32 s34, s34, 14336
  v_add_u32 v44, s34, v4
  v_mfma_f32_16x16x32_bf16 v[180:183], a[28:31], v[124:127], v[180:183]
  s_xor_b32 s34, s20, 2
  v_mfma_f32_16x16x32_bf16 v[184:187], a[72:75], v[124:127], v[184:187]
  s_mul_i32 s34, s34, 14336
  v_add_u32 v45, s34, v4
  v_mfma_f32_16x16x32_bf16 v[188:191], a[76:79], v[124:127], v[188:191]
  s_waitcnt vmcnt(13)
  v_bitop3_b32 v21, v132, v136, v140 bitop3:0x80
  s_waitcnt vmcnt(12)
  v_bitop3_b32 v21, v21, v208, 1 bitop3:0x80
  v_mfma_f32_16x16x32_bf16 v[192:195], a[24:27], v[128:131], v[192:195]
  v_cmp_ne_u32 vcc, 1, v21
  v_mfma_f32_16x16x32_bf16 v[196:199], a[28:31], v[128:131], v[196:199]
  s_cbranch_vccnz k_hs1_4
k_hb1_4:
  v_mfma_f32_16x16x32_bf16 v[200:203], a[72:75], v[128:131], v[200:203]
  buffer_load_dwordx4 v[72:75], v91, s[8:11], s49 offen sc1
  v_mfma_f32_16x16x32_bf16 v[204:207], a[76:79], v[128:131], v[204:207]
  s_add_u32 s46, s43, 16384
  s_waitcnt lgkmcnt(3)
  v_mfma_f32_16x16x32_bf16 v[144:147], a[32:35], v[132:135], v[144:147]
  buffer_load_dwordx4 v[76:79], v88, s[8:11], s46 offen sc1
  s_waitcnt lgkmcnt(2)
  v_mfma_f32_16x16x32_bf16 v[148:151], a[36:39], v[132:135], v[148:151]
  s_xor_b32 s34, s20, 3
  s_waitcnt lgkmcnt(1)
  v_mfma_f32_16x16x32_bf16 v[152:155], a[40:43], v[132:135], v[152:155]
  s_waitcnt lgkmcnt(0)
  ds_read_b128 a[48:51], v13 offset:16384
  v_mfma_f32_16x16x32_bf16 v[156:159], a[44:47], v[132:135], v[156:159]
  ds_read_b128 a[52:55], v13 offset:20480
  v_mfma_f32_16x16x32_bf16 v[160:163], a[32:35], v[136:139], v[160:163]
  ds_read_b128 a[56:59], v13 offset:24576
  v_mfma_f32_16x16x32_bf16 v[164:167], a[36:39], v[136:139], v[164:167]
  ds_read_b128 a[60:63], v13 offset:28672
  v_mfma_f32_16x16x32_bf16 v[168:171], a[40:43], v[136:139], v[168:171]
  buffer_load_dwordx4 v[96:99], v89, s[8:11], s46 offen sc1
  v_mfma_f32_16x16x32_bf16 v[172:175], a[44:47], v[136:139], v[172:175]
  s_mul_i32 s34, s34, 14336
  v_add_u32 v46, s34, v4
  v_mfma_f32_16x16x32_bf16 v[176:179], a[32:35], v[140:143], v[176:179]
  buffer_load_dwordx4 v[100:103], v90, s[8:11], s46 offen sc1
  v_mfma_f32_16x16x32_bf16 v[180:183], a[36:39], v[140:143], v[180:183]
  v_mfma_f32_16x16x32_bf16 v[184:187], a[40:43], v[140:143], v[184:187]
  v_mfma_f32_16x16x32_bf16 v[188:191], a[44:47], v[140:143], v[188:191]
  s_waitcnt vmcnt(13)
  v_bitop3_b32 v21, v212, v216, v220 bitop3:0x80
  s_waitcnt vmcnt(12)
  v_bitop3_b32 v21, v21, v224, 1 bitop3:0x80
  v_mfma_f32_16x16x32_bf16 v[192:195], a[32:35], v[208:211], v[192:195]
  v_cmp_ne_u32 vcc, 1, v21
  v_mfma_f32_16x16x32_bf16 v[196:199], a[36:39], v[208:211], v[196:199]
  s_cbranch_vccnz k_hs1_5
k_hb1_5:
  v_mfma_f32_16x16x32_bf16 v[200:203], a[40:43], v[208:211], v[200:203]
  buffer_load_dwordx4 v[104:107], v91, s[8:11], s46 offen sc1
  v_mfma_f32_16x16x32_bf16 v[204:207], a[44:47], v[208:211], v[204:207]
  s_add_u32 s47, s43, 1851392
  s_waitcnt lgkmcnt(3)
  v_mfma_f32_16x16x32_bf16 v[144:147], a[48:51], v[212:215], v[144:147]
  buffer_load_dwordx4 v[108:111], v88, s[8:11], s47 offen sc1
  s_waitcnt lgkmcnt(2)
  v_mfma_f32_16x16x32_bf16 v[148:151], a[52:55], v[212:215], v[148:151]
  s_waitcnt lgkmcnt(1)
  v_mfma_f32_16x16x32_bf16 v[152:155], a[56:59], v[212:215], v[152:155]
  s_waitcnt lgkmcnt(0)
  ds_read_b128 a[64:67], v13 offset:32768
  v_mfma_f32_16x16x32_bf16 v[156:159], a[60:63], v[212:215], v[156:159]
  v_mfma_f32_16x16x32_bf16 v[160:163], a[48:51], v[216:219], v[160:163]
  buffer_load_dwordx4 v[112:115], v89, s[8:11], s47 offen sc1
  v_mfma_f32_16x16x32_bf16 v[164:167], a[52:55], v[216:219], v[164:167]
  v_mfma_f32_16x16x32_bf16 v[168:171], a[56:59], v[216:219], v[168:171]
  v_mfma_f32_16x16x32_bf16 v[172:175], a[60:63], v[216:219], v[172:175]
  v_mfma_f32_16x16x32_bf16 v[176:179], a[48:51], v[220:223], v[176:179]
  buffer_load_dwordx4 v[64:67], v90, s[8:11], s47 offen sc1
  v_mfma_f32_16x16x32_bf16 v[180:183], a[52:55], v[220:223], v[180:183]
  v_mfma_f32_16x16x32_bf16 v[184:187], a[56:59], v[220:223], v[184:187]
  v_mfma_f32_16x16x32_bf16 v[188:191], a[60:63], v[220:223], v[188:191]
  s_waitcnt vmcnt(12)
  v_bitop3_b32 v21, v228, v232, v236 bitop3:0x80
  s_waitcnt vmcnt(11)
  v_bitop3_b32 v21, v21, v240, 1 bitop3:0x80
  v_mfma_f32_16x16x32_bf16 v[192:195], a[48:51], v[224:227], v[192:195]
  v_cmp_ne_u32 vcc, 1, v21
  v_mfma_f32_16x16x32_bf16 v[196:199], a[52:55], v[224:227], v[196:199]
  s_cbranch_vccnz k_hs1_6
k_hb1_6:
  v_mfma_f32_16x16x32_bf16 v[200:203], a[56:59], v[224:227], v[200:203]
  buffer_load_dwordx4 v[68:71], v91, s[8:11], s47 offen sc1
  v_mfma_f32_16x16x32_bf16 v[204:207], a[60:63], v[224:227], v[204:207]
  s_add_u32 s48, s43, 20480
  s_waitcnt lgkmcnt(0)
  v_mfma_f32_16x16x32_bf16 v[144:147], a[64:67], v[228:231], v[144:147]
  buffer_load_dwordx4 v[80:83], v88, s[8:11], s48 offen sc1
  v_mfma_f32_16x16x32_bf16 v[148:151], a[80:83], v[228:231], v[148:151]
  v_mfma_f32_16x16x32_bf16 v[152:155], a[84:87], v[228:231], v[152:155]
  v_mfma_f32_16x16x32_bf16 v[156:159], a[88:91], v[228:231], v[156:159]
  v_mfma_f32_16x16x32_bf16 v[160:163], a[64:67], v[232:235], v[160:163]
  buffer_load_dwordx4 v[84:87], v89, s[8:11], s48 offen sc1
  v_mfma_f32_16x16x32_bf16 v[164:167], a[80:83], v[232:235], v[164:167]
  v_mfma_f32_16x16x32_bf16 v[168:171], a[84:87], v[232:235], v[168:171]
  v_mfma_f32_16x16x32_bf16 v[172:175], a[88:91], v[232:235], v[172:175]
  v_mfma_f32_16x16x32_bf16 v[176:179], a[64:67], v[236:239], v[176:179]
  buffer_load_dwordx4 v[116:119], v90, s[8:11], s48 offen sc1
  v_mfma_f32_16x16x32_bf16 v[180:183], a[80:83], v[236:239], v[180:183]
  v_mfma_f32_16x16x32_bf16 v[184:187], a[84:87], v[236:239], v[184:187]
  v_mfma_f32_16x16x32_bf16 v[188:191], a[88:91], v[236:239], v[188:191]
  s_waitcnt vmcnt(12)
  v_bitop3_b32 v21, v32, v36, v40 bitop3:0x80
  s_waitcnt vmcnt(11)
  v_bitop3_b32 v21, v21, v72, 1 bitop3:0x80
  v_mfma_f32_16x16x32_bf16 v[192:195], a[64:67], v[240:243], v[192:195]
  v_cmp_ne_u32 vcc, 1, v21
  v_mfma_f32_16x16x32_bf16 v[196:199], a[80:83], v[240:243], v[196:199]
  s_cbranch_vccnz k_hs1_7
k_hb1_7:
  v_mfma_f32_16x16x32_bf16 v[200:203], a[84:87], v[240:243], v[200:203]
  buffer_load_dwordx4 v[120:123], v91, s[8:11], s48 offen sc1
  v_mfma_f32_16x16x32_bf16 v[204:207], a[88:91], v[240:243], v[204:207]
  s_add_u32 s49, s43, 1855488
  v_mfma_f32_16x16x32_bf16 v[144:147], a[92:95], v[32:35], v[144:147]
  buffer_load_dwordx4 v[124:127], v89, s[8:11], s49 offen sc1
  v_mfma_f32_16x16x32_bf16 v[148:151], a[96:99], v[32:35], v[148:151]
  v_mfma_f32_16x16x32_bf16 v[152:155], a[100:103], v[32:35], v[152:155]
  v_mfma_f32_16x16x32_bf16 v[156:159], a[104:107], v[32:35], v[156:159]
  v_mfma_f32_16x16x32_bf16 v[160:163], a[92:95], v[36:39], v[160:163]
  v_mfma_f32_16x16x32_bf16 v[164:167], a[96:99], v[36:39], v[164:167]
  s_add_u32 s46, s43, 24576
  v_mfma_f32_16x16x32_bf16 v[168:171], a[100:103], v[36:39], v[168:171]
  buffer_load_dwordx4 v[128:131], v89, s[8:11], s46 offen sc1
  v_mfma_f32_16x16x32_bf16 v[172:175], a[104:107], v[36:39], v[172:175]
  v_mfma_f32_16x16x32_bf16 v[176:179], a[92:95], v[40:43], v[176:179]
  v_mfma_f32_16x16x32_bf16 v[180:183], a[96:99], v[40:43], v[180:183]
  s_add_u32 s47, s43, 1859584
  v_mfma_f32_16x16x32_bf16 v[184:187], a[100:103], v[40:43], v[184:187]
  buffer_load_dwordx4 v[132:135], v89, s[8:11], s47 offen sc1
  v_mfma_f32_16x16x32_bf16 v[188:191], a[104:107], v[40:43], v[188:191]
  s_waitcnt vmcnt(12)
  v_bitop3_b32 v21, v76, v96, v100 bitop3:0x80
  s_waitcnt vmcnt(11)
  v_bitop3_b32 v21, v21, v104, 1 bitop3:0x80
  v_mfma_f32_16x16x32_bf16 v[192:195], a[92:95], v[72:75], v[192:195]
  v_cmp_ne_u32 vcc, 1, v21
  v_mfma_f32_16x16x32_bf16 v[196:199], a[96:99], v[72:75], v[196:199]
  s_cbranch_vccnz k_hs1_8
k_hb1_8:
  v_mfma_f32_16x16x32_bf16 v[200:203], a[100:103], v[72:75], v[200:203]
  buffer_load_dwordx4 v[136:139], v90, s[8:11], s49 offen sc1
  v_mfma_f32_16x16x32_bf16 v[204:207], a[104:107], v[72:75], v[204:207]
  v_mfma_f32_16x16x32_bf16 v[144:147], a[160:163], v[76:79], v[144:147]
  v_mfma_f32_16x16x32_bf16 v[148:151], a[164:167], v[76:79], v[148:151]
  v_mfma_f32_16x16x32_bf16 v[152:155], a[168:171], v[76:79], v[152:155]
  buffer_load_dwordx4 v[140:143], v90, s[8:11], s46 offen sc1
  v_mfma_f32_16x16x32_bf16 v[156:159], a[172:175], v[76:79], v[156:159]
  v_mfma_f32_16x16x32_bf16 v[160:163], a[160:163], v[96:99], v[160:163]
  v_mfma_f32_16x16x32_bf16 v[164:167], a[164:167], v[96:99], v[164:167]
  v_mfma_f32_16x16x32_bf16 v[168:171], a[168:171], v[96:99], v[168:171]
  buffer_load_dwordx4 v[208:211], v90, s[8:11], s47 offen sc1
  v_mfma_f32_16x16x32_bf16 v[172:175], a[172:175], v[96:99], v[172:175]
  v_mfma_f32_16x16x32_bf16 v[176:179], a[160:163], v[100:103], v[176:179]
  v_mfma_f32_16x16x32_bf16 v[180:183], a[164:167], v[100:103], v[180:183]
  v_mfma_f32_16x16x32_bf16 v[184:187], a[168:171], v[100:103], v[184:187]
  buffer_load_dwordx4 v[212:215], v91, s[8:11], s49 offen sc1
  v_mfma_f32_16x16x32_bf16 v[188:191], a[172:175], v[100:103], v[188:191]
  s_waitcnt vmcnt(12)
  v_bitop3_b32 v21, v108, v112, v64 bitop3:0x80
  s_waitcnt vmcnt(11)
  v_bitop3_b32 v21, v21, v68, 1 bitop3:0x80
  v_mfma_f32_16x16x32_bf16 v[192:195], a[160:163], v[104:107], v[192:195]
  v_cmp_ne_u32 vcc, 1, v21
  v_mfma_f32_16x16x32_bf16 v[196:199], a[164:167], v[104:107], v[196:199]
  s_cbranch_vccnz k_hs1_9
k_hb1_9:
  v_mfma_f32_16x16x32_bf16 v[200:203], a[168:171], v[104:107], v[200:203]
  buffer_load_dwordx4 v[216:219], v91, s[8:11], s46 offen sc1
  v_mfma_f32_16x16x32_bf16 v[204:207], a[172:175], v[104:107], v[204:207]
  v_mfma_f32_16x16x32_bf16 v[144:147], a[176:179], v[108:111], v[144:147]
  v_mfma_f32_16x16x32_bf16 v[148:151], a[180:183], v[108:111], v[148:151]
  v_mfma_f32_16x16x32_bf16 v[152:155], a[184:187], v[108:111], v[152:155]
  buffer_load_dwordx4 v[220:223], v91, s[8:11], s47 offen sc1
  v_mfma_f32_16x16x32_bf16 v[156:159], a[188:191], v[108:111], v[156:159]
  v_mfma_f32_16x16x32_bf16 v[160:163], a[176:179], v[112:115], v[160:163]
  v_mfma_f32_16x16x32_bf16 v[164:167], a[180:183], v[112:115], v[164:167]
  v_mfma_f32_16x16x32_bf16 v[168:171], a[184:187], v[112:115], v[168:171]
  buffer_load_dwordx4 v[224:227], v88, s[8:11], s49 offen sc1
  v_mfma_f32_16x16x32_bf16 v[172:175], a[188:191], v[112:115], v[172:175]
  v_mfma_f32_16x16x32_bf16 v[176:179], a[176:179], v[64:67], v[176:179]
  v_mfma_f32_16x16x32_bf16 v[180:183], a[180:183], v[64:67], v[180:183]
  v_mfma_f32_16x16x32_bf16 v[184:187], a[184:187], v[64:67], v[184:187]
  buffer_load_dwordx4 v[228:231], v88, s[8:11], s46 offen sc1
  v_mfma_f32_16x16x32_bf16 v[188:191], a[188:191], v[64:67], v[188:191]
  s_waitcnt vmcnt(12)
  v_bitop3_b32 v21, v80, v84, v116 bitop3:0x80
  s_waitcnt vmcnt(11)
  v_bitop3_b32 v21, v21, v120, 1 bitop3:0x80
  v_mfma_f32_16x16x32_bf16 v[192:195], a[176:179], v[68:71], v[192:195]
  v_cmp_ne_u32 vcc, 1, v21
  v_mfma_f32_16x16x32_bf16 v[196:199], a[180:183], v[68:71], v[196:199]
  s_cbranch_vccnz k_hs1_10
k_hb1_10:
  v_mfma_f32_16x16x32_bf16 v[200:203], a[184:187], v[68:71], v[200:203]
  buffer_load_dwordx4 v[232:235], v88, s[8:11], s47 offen sc1
  v_mfma_f32_16x16x32_bf16 v[204:207], a[188:191], v[68:71], v[204:207]
  v_mfma_f32_16x16x32_bf16 v[144:147], a[192:195], v[80:83], v[144:147]
  v_mfma_f32_16x16x32_bf16 v[148:151], a[196:199], v[80:83], v[148:151]
  v_mfma_f32_16x16x32_bf16 v[152:155], a[200:203], v[80:83], v[152:155]
  v_mfma_f32_16x16x32_bf16 v[156:159], a[204:207], v[80:83], v[156:159]
  v_mfma_f32_16x16x32_bf16 v[160:163], a[192:195], v[84:87], v[160:163]
  v_mfma_f32_16x16x32_bf16 v[164:167], a[196:199], v[84:87], v[164:167]
  v_mfma_f32_16x16x32_bf16 v[168:171], a[200:203], v[84:87], v[168:171]
  v_mfma_f32_16x16x32_bf16 v[172:175], a[204:207], v[84:87], v[172:175]
  v_mfma_f32_16x16x32_bf16 v[176:179], a[192:195], v[116:119], v[176:179]
  v_mfma_f32_16x16x32_bf16 v[180:183], a[196:199], v[116:119], v[180:183]
  v_mfma_f32_16x16x32_bf16 v[184:187], a[200:203], v[116:119], v[184:187]
  v_mfma_f32_16x16x32_bf16 v[188:191], a[204:207], v[116:119], v[188:191]
  s_waitcnt vmcnt(9)
  v_bitop3_b32 v21, v124, v128, v132 bitop3:0x80
  s_waitcnt vmcnt(8)
  v_bitop3_b32 v21, v21, v136, 1 bitop3:0x80
  v_mfma_f32_16x16x32_bf16 v[192:195], a[192:195], v[120:123], v[192:195]
  v_cmp_ne_u32 vcc, 1, v21
  v_mfma_f32_16x16x32_bf16 v[196:199], a[196:199], v[120:123], v[196:199]
  s_cbranch_vccnz k_hs1_11
k_hb1_11:
  v_mfma_f32_16x16x32_bf16 v[200:203], a[200:203], v[120:123], v[200:203]
  v_mfma_f32_16x16x32_bf16 v[204:207], a[204:207], v[120:123], v[204:207]
  v_mfma_f32_16x16x32_bf16 v[160:163], a[208:211], v[124:127], v[160:163]
  v_mfma_f32_16x16x32_bf16 v[164:167], a[212:215], v[124:127], v[164:167]
  v_mfma_f32_16x16x32_bf16 v[168:171], a[216:219], v[124:127], v[168:171]
  v_mfma_f32_16x16x32_bf16 v[172:175], a[220:223], v[124:127], v[172:175]
  v_mfma_f32_16x16x32_bf16 v[160:163], a[224:227], v[128:131], v[160:163]
  v_mfma_f32_16x16x32_bf16 v[164:167], a[228:231], v[128:131], v[164:167]
  v_mfma_f32_16x16x32_bf16 v[168:171], a[232:235], v[128:131], v[168:171]
  v_mfma_f32_16x16x32_bf16 v[172:175], a[236:239], v[128:131], v[172:175]
  v_mfma_f32_16x16x32_bf16 v[160:163], a[240:243], v[132:135], v[160:163]
  v_mfma_f32_16x16x32_bf16 v[164:167], a[244:247], v[132:135], v[164:167]
  v_mfma_f32_16x16x32_bf16 v[168:171], a[248:251], v[132:135], v[168:171]
  v_mfma_f32_16x16x32_bf16 v[172:175], a[252:255], v[132:135], v[172:175]
  s_waitcnt vmcnt(5)
  v_bitop3_b32 v21, v140, v208, v212 bitop3:0x80
  s_waitcnt vmcnt(4)
  v_bitop3_b32 v21, v21, v216, 1 bitop3:0x80
  v_mfma_f32_16x16x32_bf16 v[176:179], a[208:211], v[136:139], v[176:179]
  v_cmp_ne_u32 vcc, 1, v21
  v_mfma_f32_16x16x32_bf16 v[180:183], a[212:215], v[136:139], v[180:183]
  s_cbranch_vccnz k_hs1_12
k_hb1_12:
  v_mfma_f32_16x16x32_bf16 v[184:187], a[216:219], v[136:139], v[184:187]
  ds_write_b128 v44, v[160:163] offset:0
  v_mfma_f32_16x16x32_bf16 v[188:191], a[220:223], v[136:139], v[188:191]
  ds_write_b128 v44, v[164:167] offset:1024
  v_mfma_f32_16x16x32_bf16 v[176:179], a[224:227], v[140:143], v[176:179]
  ds_write_b128 v44, v[168:171] offset:2048
  v_mfma_f32_16x16x32_bf16 v[180:183], a[228:231], v[140:143], v[180:183]
  ds_write_b128 v44, v[172:175] offset:3072
  v_mfma_f32_16x16x32_bf16 v[184:187], a[232:235], v[140:143], v[184:187]
  v_mfma_f32_16x16x32_bf16 v[188:191], a[236:239], v[140:143], v[188:191]
  v_mfma_f32_16x16x32_bf16 v[176:179], a[240:243], v[208:211], v[176:179]
  v_mfma_f32_16x16x32_bf16 v[180:183], a[244:247], v[208:211], v[180:183]
  v_mfma_f32_16x16x32_bf16 v[184:187], a[248:251], v[208:211], v[184:187]
  v_mfma_f32_16x16x32_bf16 v[188:191], a[252:255], v[208:211], v[188:191]
  s_nop 4
  ds_write_b128 v45, v[176:179] offset:4096
  v_mfma_f32_16x16x32_bf16 v[192:195], a[208:211], v[212:215], v[192:195]
  v_mfma_f32_16x16x32_bf16 v[196:199], a[212:215], v[212:215], v[196:199]
  ds_write_b128 v45, v[180:183] offset:5120
  v_mfma_f32_16x16x32_bf16 v[200:203], a[216:219], v[212:215], v[200:203]
  v_mfma_f32_16x16x32_bf16 v[204:207], a[220:223], v[212:215], v[204:207]
  s_waitcnt vmcnt(1)
  v_bitop3_b32 v21, v220, v224, v228 bitop3:0x80
  s_waitcnt vmcnt(0)
  v_bitop3_b32 v21, v21, v232, 1 bitop3:0x80
  v_mfma_f32_16x16x32_bf16 v[192:195], a[224:227], v[216:219], v[192:195]
  v_cmp_ne_u32 vcc, 1, v21
  v_mfma_f32_16x16x32_bf16 v[196:199], a[228:231], v[216:219], v[196:199]
  s_cbranch_vccnz k_hs1_13
k_hb1_13:
  v_mfma_f32_16x16x32_bf16 v[200:203], a[232:235], v[216:219], v[200:203]
  ds_write_b128 v45, v[184:187] offset:6144
  v_mfma_f32_16x16x32_bf16 v[204:207], a[236:239], v[216:219], v[204:207]
  ds_write_b128 v45, v[188:191] offset:7168
  v_mfma_f32_16x16x32_bf16 v[192:195], a[240:243], v[220:223], v[192:195]
  v_mfma_f32_16x16x32_bf16 v[196:199], a[244:247], v[220:223], v[196:199]
  v_mfma_f32_16x16x32_bf16 v[200:203], a[248:251], v[220:223], v[200:203]
  v_mfma_f32_16x16x32_bf16 v[204:207], a[252:255], v[220:223], v[204:207]
  s_nop 4
  ds_write_b128 v46, v[192:195] offset:8192
  v_mfma_f32_16x16x32_bf16 v[144:147], a[208:211], v[224:227], v[144:147]
  ds_write_b128 v46, v[196:199] offset:9216
  v_mfma_f32_16x16x32_bf16 v[148:151], a[212:215], v[224:227], v[148:151]
  ds_write_b128 v46, v[200:203] offset:10240
  v_mfma_f32_16x16x32_bf16 v[152:155], a[216:219], v[224:227], v[152:155]
  ds_write_b128 v46, v[204:207] offset:11264
  v_mfma_f32_16x16x32_bf16 v[156:159], a[220:223], v[224:227], v[156:159]
  s_waitcnt lgkmcnt(0)
  v_mfma_f32_16x16x32_bf16 v[144:147], a[224:227], v[228:231], v[144:147]
  s_barrier
  ds_read_b128 v[160:163], v47 offset:0
  ds_read_b128 v[164:167], v47 offset:1024
  v_mfma_f32_16x16x32_bf16 v[148:151], a[228:231], v[228:231], v[148:151]
  ds_read_b128 v[176:179], v47 offset:4096
  ds_read_b128 v[180:183], v47 offset:5120
  v_mfma_f32_16x16x32_bf16 v[152:155], a[232:235], v[228:231], v[152:155]
  ds_read_b128 v[192:195], v47 offset:8192
  ds_read_b128 v[196:199], v47 offset:9216
  v_mfma_f32_16x16x32_bf16 v[156:159], a[236:239], v[228:231], v[156:159]
  ds_read_b128 v[168:171], v47 offset:2048
  ds_read_b128 v[172:175], v47 offset:3072
  v_mfma_f32_16x16x32_bf16 v[144:147], a[240:243], v[232:235], v[144:147]
  ds_read_b128 v[184:187], v47 offset:6144
  ds_read_b128 v[188:191], v47 offset:7168
  v_mfma_f32_16x16x32_bf16 v[148:151], a[244:247], v[232:235], v[148:151]
  ds_read_b128 v[200:203], v47 offset:10240
  ds_read_b128 v[204:207], v47 offset:11264
  v_mfma_f32_16x16x32_bf16 v[152:155], a[248:251], v[232:235], v[152:155]
  v_mfma_f32_16x16x32_bf16 v[156:159], a[252:255], v[232:235], v[156:159]
  s_nop 0
  v_pk_add_f32 v[144:145], v[144:145], v[48:49]
  v_pk_add_f32 v[146:147], v[146:147], v[50:51]
  s_nop 0
  v_pk_add_f32 v[148:149], v[148:149], v[52:53]
  v_pk_add_f32 v[150:151], v[150:151], v[54:55]
  s_nop 0
  v_pk_add_f32 v[152:153], v[152:153], v[56:57]
  v_pk_add_f32 v[154:155], v[154:155], v[58:59]
  v_pk_add_f32 v[156:157], v[156:157], v[60:61]
  v_pk_add_f32 v[158:159], v[158:159], v[62:63]
  s_waitcnt lgkmcnt(11)
  v_pk_add_f32 v[144:145], v[144:145], v[160:161]
  v_pk_add_f32 v[146:147], v[146:147], v[162:163]
  s_waitcnt lgkmcnt(10)
  v_pk_add_f32 v[148:149], v[148:149], v[164:165]
  v_pk_add_f32 v[150:151], v[150:151], v[166:167]
  s_waitcnt lgkmcnt(9)
  v_pk_add_f32 v[144:145], v[144:145], v[176:177]
  v_pk_add_f32 v[146:147], v[146:147], v[178:179]
  s_waitcnt lgkmcnt(8)
  v_pk_add_f32 v[148:149], v[148:149], v[180:181]
  v_pk_add_f32 v[150:151], v[150:151], v[182:183]
  s_waitcnt lgkmcnt(7)
  v_pk_add_f32 v[144:145], v[144:145], v[192:193]
  v_pk_add_f32 v[146:147], v[146:147], v[194:195]
  s_waitcnt lgkmcnt(6)
  v_pk_add_f32 v[148:149], v[148:149], v[196:197]
  v_pk_add_f32 v[150:151], v[150:151], v[198:199]
  v_cvt_pk_bf16_f32 v144, v144, v145
  v_cvt_pk_bf16_f32 v145, v146, v147
  v_cvt_pk_bf16_f32 v146, v148, v149
  v_cvt_pk_bf16_f32 v147, v150, v151
  buffer_store_dwordx4 v[144:147], v94, s[12:15], 0 offen
  s_waitcnt lgkmcnt(5)
  v_pk_add_f32 v[152:153], v[152:153], v[168:169]
  v_pk_add_f32 v[154:155], v[154:155], v[170:171]
  s_waitcnt lgkmcnt(4)
  v_pk_add_f32 v[156:157], v[156:157], v[172:173]
  v_pk_add_f32 v[158:159], v[158:159], v[174:175]
  s_waitcnt lgkmcnt(3)
  v_pk_add_f32 v[152:153], v[152:153], v[184:185]
  v_pk_add_f32 v[154:155], v[154:155], v[186:187]
  s_waitcnt lgkmcnt(2)
  v_pk_add_f32 v[156:157], v[156:157], v[188:189]
  v_pk_add_f32 v[158:159], v[158:159], v[190:191]
  s_waitcnt lgkmcnt(1)
  v_pk_add_f32 v[152:153], v[152:153], v[200:201]
  v_pk_add_f32 v[154:155], v[154:155], v[202:203]
  s_waitcnt lgkmcnt(0)
  v_pk_add_f32 v[156:157], v[156:157], v[204:205]
  v_pk_add_f32 v[158:159], v[158:159], v[206:207]
  v_cvt_pk_bf16_f32 v152, v152, v153
  v_cvt_pk_bf16_f32 v153, v154, v155
  v_cvt_pk_bf16_f32 v154, v156, v157
  v_cvt_pk_bf16_f32 v155, v158, v159
  buffer_store_dwordx4 v[152:155], v95, s[12:15], 0 offen
k_end:
  s_endpgm
k_hs0_0:
  s_mov_b32 s68, 0
k_hp0_0:
  s_add_u32 s35, s43, 0
  buffer_load_dwordx4 v[96:99], v88, s[8:11], s35 offen sc1
  buffer_load_dwordx4 v[100:103], v89, s[8:11], s35 offen sc1
  buffer_load_dwordx4 v[104:107], v90, s[8:11], s35 offen sc1
  buffer_load_dwordx4 v[108:111], v91, s[8:11], s35 offen sc1
  s_add_u32 s35, s43, 4096
  buffer_load_dwordx4 v[128:131], v88, s[8:11], s35 offen sc1
  buffer_load_dwordx4 v[132:135], v89, s[8:11], s35 offen sc1
  buffer_load_dwordx4 v[136:139], v90, s[8:11], s35 offen sc1
  buffer_load_dwordx4 v[140:143], v91, s[8:11], s35 offen sc1
  s_add_u32 s68, s68, 1
  s_waitcnt vmcnt(0)
  v_bitop3_b32 v21, v96, v100, v104 bitop3:0xfe
  v_bitop3_b32 v21, v21, v108, 1 bitop3:0xa8
  v_cmp_ne_u32 vcc, 0, v21
  s_cmp_ge_u32 s68, 0x20000
  s_cbranch_scc1 k_hp0_0_go
  s_nop 2
  s_cbranch_vccnz k_hp0_0
k_hp0_0_go:
  s_branch k_hb0_0
k_hs0_1:
  s_mov_b32 s68, 0
k_hp0_1:
  s_add_u32 s35, s43, 1835008
  buffer_load_dwordx4 v[112:115], v88, s[8:11], s35 offen sc1
  buffer_load_dwordx4 v[116:119], v89, s[8:11], s35 offen sc1
  buffer_load_dwordx4 v[120:123], v90, s[8:11], s35 offen sc1
  buffer_load_dwordx4 v[124:127], v91, s[8:11], s35 offen sc1
  s_add_u32 s35, s43, 1839104
  buffer_load_dwordx4 v[208:211], v88, s[8:11], s35 offen sc1
  buffer_load_dwordx4 v[212:215], v89, s[8:11], s35 offen sc1
  buffer_load_dwordx4 v[216:219], v90, s[8:11], s35 offen sc1
  buffer_load_dwordx4 v[220:223], v91, s[8:11], s35 offen sc1
  s_add_u32 s68, s68, 1
  s_waitcnt vmcnt(0)
  v_bitop3_b32 v21, v112, v116, v120 bitop3:0xfe
  v_bitop3_b32 v21, v21, v124, 1 bitop3:0xa8
  v_cmp_ne_u32 vcc, 0, v21
  s_cmp_ge_u32 s68, 0x20000
  s_cbranch_scc1 k_hp0_1_go
  s_nop 2
  s_cbranch_vccnz k_hp0_1
k_hp0_1_go:
  s_branch k_hb0_1
k_hs0_2:
  s_mov_b32 s68, 0
k_hp0_2:
  s_add_u32 s35, s43, 4096
  buffer_load_dwordx4 v[128:131], v88, s[8:11], s35 offen sc1
  buffer_load_dwordx4 v[132:135], v89, s[8:11], s35 offen sc1
  buffer_load_dwordx4 v[136:139], v90, s[8:11], s35 offen sc1
  buffer_load_dwordx4 v[140:143], v91, s[8:11], s35 offen sc1
  s_add_u32 s68, s68, 1
  s_waitcnt vmcnt(0)
  v_bitop3_b32 v21, v128, v132, v136 bitop3:0xfe
  v_bitop3_b32 v21, v21, v140, 1 bitop3:0xa8
  v_cmp_ne_u32 vcc, 0, v21
  s_cmp_ge_u32 s68, 0x20000
  s_cbranch_scc1 k_hp0_2_go
  s_nop 2
  s_cbranch_vccnz k_hp0_2
k_hp0_2_go:
  s_branch k_hb0_2
k_hs0_3:
  s_mov_b32 s68, 0
k_hp0_3:
  s_add_u32 s35, s43, 1839104
  buffer_load_dwordx4 v[208:211], v88, s[8:11], s35 offen sc1
  buffer_load_dwordx4 v[212:215], v89, s[8:11], s35 offen sc1
  buffer_load_dwordx4 v[216:219], v90, s[8:11], s35 offen sc1
  buffer_load_dwordx4 v[220:223], v91, s[8:11], s35 offen sc1
  s_add_u32 s68, s68, 1
  s_waitcnt vmcnt(0)
  v_bitop3_b32 v21, v208, v212, v216 bitop3:0xfe
  v_bitop3_b32 v21, v21, v220, 1 bitop3:0xa8
  v_cmp_ne_u32 vcc, 0, v21
  s_cmp_ge_u32 s68, 0x20000
  s_cbranch_scc1 k_hp0_3_go
  s_nop 2
  s_cbranch_vccnz k_hp0_3
k_hp0_3_go:
  s_branch k_hb0_3
k_hs0_4:
  s_mov_b32 s68, 0
k_hp0_4:
  s_add_u32 s35, s43, 8192
  buffer_load_dwordx4 v[224:227], v88, s[8:11], s35 offen sc1
  buffer_load_dwordx4 v[228:231], v89, s[8:11], s35 offen sc1
  buffer_load_dwordx4 v[232:235], v90, s[8:11], s35 offen sc1
  buffer_load_dwordx4 v[236:239], v91, s[8:11], s35 offen sc1
  s_add_u32 s35, s43, 12288
  buffer_load_dwordx4 v[96:99], v88, s[8:11], s35 offen sc1
  buffer_load_dwordx4 v[72:75], v89, s[8:11], s35 offen sc1
  buffer_load_dwordx4 v[76:79], v90, s[8:11], s35 offen sc1
  buffer_load_dwordx4 v[100:103], v91, s[8:11], s35 offen sc1
  s_add_u32 s68, s68, 1
  s_waitcnt vmcnt(0)
  v_bitop3_b32 v21, v224, v228, v232 bitop3:0xfe
  v_bitop3_b32 v21, v21, v236, 1 bitop3:0xa8
  v_cmp_ne_u32 vcc, 0, v21
  s_cmp_ge_u32 s68, 0x20000
  s_cbranch_scc1 k_hp0_4_go
  s_nop 2
  s_cbranch_vccnz k_hp0_4
k_hp0_4_go:
  s_branch k_hb0_4
k_hs0_5:
  s_mov_b32 s68, 0
k_hp0_5:
  s_add_u32 s35, s43, 1843200
  buffer_load_dwordx4 v[240:243], v88, s[8:11], s35 offen sc1
  buffer_load_dwordx4 v[32:35], v89, s[8:11], s35 offen sc1
  buffer_load_dwordx4 v[36:39], v90, s[8:11], s35 offen sc1
  buffer_load_dwordx4 v[40:43], v91, s[8:11], s35 offen sc1
  s_add_u32 s35, s43, 1847296
  buffer_load_dwordx4 v[104:107], v88, s[8:11], s35 offen sc1
  buffer_load_dwordx4 v[108:111], v89, s[8:11], s35 offen sc1
  buffer_load_dwordx4 v[112:115], v90, s[8:11], s35 offen sc1
  buffer_load_dwordx4 v[116:119], v91, s[8:11], s35 offen sc1
  s_add_u32 s68, s68, 1
  s_waitcnt vmcnt(0)
  v_bitop3_b32 v21, v240, v32, v36 bitop3:0xfe
  v_bitop3_b32 v21, v21, v40, 1 bitop3:0xa8
  v_cmp_ne_u32 vcc, 0, v21
  s_cmp_ge_u32 s68, 0x20000
  s_cbranch_scc1 k_hp0_5_go
  s_nop 2
  s_cbranch_vccnz k_hp0_5
k_hp0_5_go:
  s_branch k_hb0_5
k_hs0_6:
  s_mov_b32 s68, 0
k_hp0_6:
  s_add_u32 s35, s43, 12288
  buffer_load_dwordx4 v[96:99], v88, s[8:11], s35 offen sc1
  buffer_load_dwordx4 v[72:75], v89, s[8:11], s35 offen sc1
  buffer_load_dwordx4 v[76:79], v90, s[8:11], s35 offen sc1
  buffer_load_dwordx4 v[100:103], v91, s[8:11], s35 offen sc1
  s_add_u32 s68, s68, 1
  s_waitcnt vmcnt(0)
  v_bitop3_b32 v21, v96, v72, v76 bitop3:0xfe
  v_bitop3_b32 v21, v21, v100, 1 bitop3:0xa8
  v_cmp_ne_u32 vcc, 0, v21
  s_cmp_ge_u32 s68, 0x20000
  s_cbranch_scc1 k_hp0_6_go
  s_nop 2
  s_cbranch_vccnz k_hp0_6
k_hp0_6_go:
  s_branch k_hb0_6
k_hs0_7:
  s_mov_b32 s68, 0
k_hp0_7:
  s_add_u32 s35, s43, 1847296
  buffer_load_dwordx4 v[104:107], v88, s[8:11], s35 offen sc1
  buffer_load_dwordx4 v[108:111], v89, s[8:11], s35 offen sc1
  buffer_load_dwordx4 v[112:115], v90, s[8:11], s35 offen sc1
  buffer_load_dwordx4 v[116:119], v91, s[8:11], s35 offen sc1
  s_add_u32 s68, s68, 1
  s_waitcnt vmcnt(0)
  v_bitop3_b32 v21, v104, v108, v112 bitop3:0xfe
  v_bitop3_b32 v21, v21, v116, 1 bitop3:0xa8
  v_cmp_ne_u32 vcc, 0, v21
  s_cmp_ge_u32 s68, 0x20000
  s_cbranch_scc1 k_hp0_7_go
  s_nop 2
  s_cbranch_vccnz k_hp0_7
k_hp0_7_go:
  s_branch k_hb0_7
k_hs0_8:
  s_mov_b32 s68, 0
k_hp0_8:
  s_add_u32 s35, s43, 16384
  buffer_load_dwordx4 v[120:123], v88, s[8:11], s35 offen sc1
  buffer_load_dwordx4 v[124:127], v89, s[8:11], s35 offen sc1
  buffer_load_dwordx4 v[128:131], v90, s[8:11], s35 offen sc1
  buffer_load_dwordx4 v[132:135], v91, s[8:11], s35 offen sc1
  s_add_u32 s35, s43, 20480
  buffer_load_dwordx4 v[216:219], v88, s[8:11], s35 offen sc1
  buffer_load_dwordx4 v[220:223], v89, s[8:11], s35 offen sc1
  buffer_load_dwordx4 v[224:227], v90, s[8:11], s35 offen sc1
  buffer_load_dwordx4 v[228:231], v91, s[8:11], s35 offen sc1
  s_add_u32 s68, s68, 1
  s_waitcnt vmcnt(0)
  v_bitop3_b32 v21, v120, v124, v128 bitop3:0xfe
  v_bitop3_b32 v21, v21, v132, 1 bitop3:0xa8
  v_cmp_ne_u32 vcc, 0, v21
  s_cmp_ge_u32 s68, 0x20000
  s_cbranch_scc1 k_hp0_8_go
  s_nop 2
  s_cbranch_vccnz k_hp0_8
k_hp0_8_go:
  s_branch k_hb0_8
k_hs0_9:
  s_mov_b32 s68, 0
k_hp0_9:
  s_add_u32 s35, s43, 1851392
  buffer_load_dwordx4 v[136:139], v88, s[8:11], s35 offen sc1
  buffer_load_dwordx4 v[140:143], v89, s[8:11], s35 offen sc1
  buffer_load_dwordx4 v[208:211], v90, s[8:11], s35 offen sc1
  buffer_load_dwordx4 v[212:215], v91, s[8:11], s35 offen sc1
  s_add_u32 s35, s43, 1855488
  buffer_load_dwordx4 v[64:67], v89, s[8:11], s35 offen sc1
  buffer_load_dwordx4 v[84:87], v90, s[8:11], s35 offen sc1
  s_add_u32 s68, s68, 1
  s_waitcnt vmcnt(0)
  v_bitop3_b32 v21, v136, v140, v208 bitop3:0xfe
  v_bitop3_b32 v21, v21, v212, 1 bitop3:0xa8
  v_cmp_ne_u32 vcc, 0, v21
  s_cmp_ge_u32 s68, 0x20000
  s_cbranch_scc1 k_hp0_9_go
  s_nop 2
  s_cbranch_vccnz k_hp0_9
k_hp0_9_go:
  s_branch k_hb0_9
k_hs0_10:
  s_mov_b32 s68, 0
k_hp0_10:
  s_add_u32 s35, s43, 20480
  buffer_load_dwordx4 v[216:219], v88, s[8:11], s35 offen sc1
  buffer_load_dwordx4 v[220:223], v89, s[8:11], s35 offen sc1
  buffer_load_dwordx4 v[224:227], v90, s[8:11], s35 offen sc1
  buffer_load_dwordx4 v[228:231], v91, s[8:11], s35 offen sc1
  s_add_u32 s68, s68, 1
  s_waitcnt vmcnt(0)
  v_bitop3_b32 v21, v216, v220, v224 bitop3:0xfe
  v_bitop3_b32 v21, v21, v228, 1 bitop3:0xa8
  v_cmp_ne_u32 vcc, 0, v21
  s_cmp_ge_u32 s68, 0x20000
  s_cbranch_scc1 k_hp0_10_go
  s_nop 2
  s_cbranch_vccnz k_hp0_10
k_hp0_10_go:
  s_branch k_hb0_10
k_hs0_11:
  s_mov_b32 s68, 0
k_hp0_11:
  s_add_u32 s35, s43, 1855488
  buffer_load_dwordx4 v[64:67], v89, s[8:11], s35 offen sc1
  s_add_u32 s35, s43, 24576
  buffer_load_dwordx4 v[68:71], v89, s[8:11], s35 offen sc1
  s_add_u32 s35, s43, 1859584
  buffer_load_dwordx4 v[80:83], v89, s[8:11], s35 offen sc1
  s_add_u32 s35, s43, 1855488
  buffer_load_dwordx4 v[84:87], v90, s[8:11], s35 offen sc1
  s_add_u32 s35, s43, 24576
  buffer_load_dwordx4 v[232:235], v90, s[8:11], s35 offen sc1
  s_add_u32 s35, s43, 1859584
  buffer_load_dwordx4 v[236:239], v90, s[8:11], s35 offen sc1
  s_add_u32 s35, s43, 1855488
  buffer_load_dwordx4 v[240:243], v91, s[8:11], s35 offen sc1
  s_add_u32 s35, s43, 24576
  buffer_load_dwordx4 v[32:35], v91, s[8:11], s35 offen sc1
  s_add_u32 s35, s43, 1859584
  buffer_load_dwordx4 v[36:39], v91, s[8:11], s35 offen sc1
  s_add_u32 s35, s43, 1855488
  buffer_load_dwordx4 v[40:43], v88, s[8:11], s35 offen sc1
  s_add_u32 s35, s43, 24576
  buffer_load_dwordx4 v[96:99], v88, s[8:11], s35 offen sc1
  s_add_u32 s35, s43, 1859584
  buffer_load_dwordx4 v[72:75], v88, s[8:11], s35 offen sc1
  s_add_u32 s68, s68, 1
  s_waitcnt vmcnt(0)
  v_bitop3_b32 v21, v64, v68, v80 bitop3:0xfe
  v_bitop3_b32 v21, v21, v84, 1 bitop3:0xa8
  v_cmp_ne_u32 vcc, 0, v21
  s_cmp_ge_u32 s68, 0x20000
  s_cbranch_scc1 k_hp0_11_go
  s_nop 2
  s_cbranch_vccnz k_hp0_11
k_hp0_11_go:
  s_branch k_hb0_11
k_hs0_12:
  s_mov_b32 s68, 0
k_hp0_12:
  s_add_u32 s35, s43, 24576
  buffer_load_dwordx4 v[232:235], v90, s[8:11], s35 offen sc1
  s_add_u32 s35, s43, 1859584
  buffer_load_dwordx4 v[236:239], v90, s[8:11], s35 offen sc1
  s_add_u32 s35, s43, 1855488
  buffer_load_dwordx4 v[240:243], v91, s[8:11], s35 offen sc1
  s_add_u32 s35, s43, 24576
  buffer_load_dwordx4 v[32:35], v91, s[8:11], s35 offen sc1
  s_add_u32 s35, s43, 1859584
  buffer_load_dwordx4 v[36:39], v91, s[8:11], s35 offen sc1
  s_add_u32 s35, s43, 1855488
  buffer_load_dwordx4 v[40:43], v88, s[8:11], s35 offen sc1
  s_add_u32 s35, s43, 24576
  buffer_load_dwordx4 v[96:99], v88, s[8:11], s35 offen sc1
  s_add_u32 s35, s43, 1859584
  buffer_load_dwordx4 v[72:75], v88, s[8:11], s35 offen sc1
  s_add_u32 s68, s68, 1
  s_waitcnt vmcnt(0)
  v_bitop3_b32 v21, v232, v236, v240 bitop3:0xfe
  v_bitop3_b32 v21, v21, v32, 1 bitop3:0xa8
  v_cmp_ne_u32 vcc, 0, v21
  s_cmp_ge_u32 s68, 0x20000
  s_cbranch_scc1 k_hp0_12_go
  s_nop 2
  s_cbranch_vccnz k_hp0_12
k_hp0_12_go:
  s_branch k_hb0_12
k_hs0_13:
  s_mov_b32 s68, 0
k_hp0_13:
  s_add_u32 s35, s43, 1859584
  buffer_load_dwordx4 v[36:39], v91, s[8:11], s35 offen sc1
  s_add_u32 s35, s43, 1855488
  buffer_load_dwordx4 v[40:43], v88, s[8:11], s35 offen sc1
  s_add_u32 s35, s43, 24576
  buffer_load_dwordx4 v[96:99], v88, s[8:11], s35 offen sc1
  s_add_u32 s35, s43, 1859584
  buffer_load_dwordx4 v[72:75], v88, s[8:11], s35 offen sc1
  s_add_u32 s68, s68, 1
  s_waitcnt vmcnt(0)
  v_bitop3_b32 v21, v36, v40, v96 bitop3:0xfe
  v_bitop3_b32 v21, v21, v72, 1 bitop3:0xa8
  v_cmp_ne_u32 vcc, 0, v21
  s_cmp_ge_u32 s68, 0x20000
  s_cbranch_scc1 k_hp0_13_go
  s_nop 2
  s_cbranch_vccnz k_hp0_13
k_hp0_13_go:
  s_branch k_hb0_13
k_p2:
  s_mov_b32 s68, 0
k_p2s:
  buffer_load_dword v19, v20, s[8:11], s34 offen sc1
  s_add_u32 s68, s68, 1
  s_waitcnt vmcnt(0)
  v_cmp_ne_u32 vcc, 0, v19
  s_cmp_ge_u32 s68, 0x20000
  s_cbranch_scc1 k_p2s_go
  s_nop 2
  s_cbranch_vccnz k_p2s
k_p2s_go:
  s_branch k_p2b
k_zs0:
  s_mov_b32 s68, 0
k_zp0:
  s_add_u32 m0, s39, 0
  s_add_u32 s35, s36, 0
  buffer_load_dwordx4 v4, s[8:11], s35 offen offset:0 sc1 lds
  buffer_load_dwordx4 v4, s[8:11], s35 offen offset:1024 sc1 lds
  s_add_u32 s35, s36, 2048
  buffer_load_dwordx4 v4, s[8:11], s35 offen offset:2048 sc1 lds
  buffer_load_dwordx4 v4, s[8:11], s35 offen offset:3072 sc1 lds
  s_add_u32 m0, s39, 4096
  s_add_u32 s35, s36, 8192
  buffer_load_dwordx4 v4, s[8:11], s35 offen offset:0 sc1 lds
  buffer_load_dwordx4 v4, s[8:11], s35 offen offset:1024 sc1 lds
  s_add_u32 s35, s36, 10240
  buffer_load_dwordx4 v4, s[8:11], s35 offen offset:2048 sc1 lds
  buffer_load_dwordx4 v4, s[8:11], s35 offen offset:3072 sc1 lds
  s_add_u32 m0, s39, 8192
  s_add_u32 s35, s36, 16384
  buffer_load_dwordx4 v4, s[8:11], s35 offen offset:0 sc1 lds
  buffer_load_dwordx4 v4, s[8:11], s35 offen offset:1024 sc1 lds
  s_add_u32 s35, s36, 18432
  buffer_load_dwordx4 v4, s[8:11], s35 offen offset:2048 sc1 lds
  buffer_load_dwordx4 v4, s[8:11], s35 offen offset:3072 sc1 lds
  s_add_u32 m0, s39, 12288
  s_add_u32 s35, s36, 24576
  buffer_load_dwordx4 v4, s[8:11], s35 offen offset:0 sc1 lds
  buffer_load_dwordx4 v4, s[8:11], s35 offen offset:1024 sc1 lds
  s_add_u32 s68, s68, 1
  s_waitcnt vmcnt(0)
  ds_read2st64_b32 v[208:209], v5 offset0:0 offset1:1
  ds_read2st64_b32 v[210:211], v5 offset0:2 offset1:3
  ds_read2st64_b32 v[212:213], v5 offset0:4 offset1:5
  ds_read2st64_b32 v[214:215], v5 offset0:6 offset1:7
  s_waitcnt lgkmcnt(0)
  v_max3_u32 v44, v208, v209, v210
  v_max3_u32 v45, v211, v212, v213
  v_max3_u32 v44, v44, v214, v215
  v_max_u32 v44, v44, v45
  v_cmp_eq_u32 vcc, -1, v44
  s_cmp_ge_u32 s68, 0x20000
  s_cbranch_scc1 k_zp0_go
  s_nop 2
  s_cbranch_vccnz k_zp0
k_zp0_go:
  s_branch k_zb0
k_zs1:
  s_mov_b32 s68, 0
k_zp1:
  s_add_u32 m0, s39, 2048
  s_add_u32 s35, s36, 4096
  buffer_load_dwordx4 v4, s[8:11], s35 offen offset:0 sc1 lds
  buffer_load_dwordx4 v4, s[8:11], s35 offen offset:1024 sc1 lds
  s_add_u32 s35, s36, 6144
  buffer_load_dwordx4 v4, s[8:11], s35 offen offset:2048 sc1 lds
  buffer_load_dwordx4 v4, s[8:11], s35 offen offset:3072 sc1 lds
  s_add_u32 m0, s39, 6144
  s_add_u32 s35, s36, 12288
  buffer_load_dwordx4 v4, s[8:11], s35 offen offset:0 sc1 lds
  buffer_load_dwordx4 v4, s[8:11], s35 offen offset:1024 sc1 lds
  s_add_u32 s35, s36, 14336
  buffer_load_dwordx4 v4, s[8:11], s35 offen offset:2048 sc1 lds
  buffer_load_dwordx4 v4, s[8:11], s35 offen offset:3072 sc1 lds
  s_add_u32 m0, s39, 10240
  s_add_u32 s35, s36, 20480
  buffer_load_dwordx4 v4, s[8:11], s35 offen offset:0 sc1 lds
  buffer_load_dwordx4 v4, s[8:11], s35 offen offset:1024 sc1 lds
  s_add_u32 s35, s36, 22528
  buffer_load_dwordx4 v4, s[8:11], s35 offen offset:2048 sc1 lds
  buffer_load_dwordx4 v4, s[8:11], s35 offen offset:3072 sc1 lds
  s_add_u32 s68, s68, 1
  s_waitcnt vmcnt(0)
  ds_read2st64_b32 v[216:217], v5 offset0:8 offset1:9
  ds_read2st64_b32 v[218:219], v5 offset0:10 offset1:11
  ds_read2st64_b32 v[220:221], v5 offset0:12 offset1:13
  ds_read2st64_b32 v[222:223], v5 offset0:14 offset1:15
  s_waitcnt lgkmcnt(0)
  v_max3_u32 v44, v216, v217, v218
  v_max3_u32 v45, v219, v220, v221
  v_max3_u32 v44, v44, v222, v223
  v_max_u32 v44, v44, v45
  v_cmp_eq_u32 vcc, -1, v44
  s_cmp_ge_u32 s68, 0x20000
  s_cbranch_scc1 k_zp1_go
  s_nop 2
  s_cbranch_vccnz k_zp1
k_zp1_go:
  s_branch k_zb1
k_zs2:
  s_mov_b32 s68, 0
k_zp2:
  s_add_u32 m0, s39, 4096
  s_add_u32 s35, s36, 8192
  buffer_load_dwordx4 v4, s[8:11], s35 offen offset:0 sc1 lds
  buffer_load_dwordx4 v4, s[8:11], s35 offen offset:1024 sc1 lds
  s_add_u32 s35, s36, 10240
  buffer_load_dwordx4 v4, s[8:11], s35 offen offset:2048 sc1 lds
  buffer_load_dwordx4 v4, s[8:11], s35 offen offset:3072 sc1 lds
  s_add_u32 m0, s39, 8192
  s_add_u32 s35, s36, 16384
  buffer_load_dwordx4 v4, s[8:11], s35 offen offset:0 sc1 lds
  buffer_load_dwordx4 v4, s[8:11], s35 offen offset:1024 sc1 lds
  s_add_u32 s35, s36, 18432
  buffer_load_dwordx4 v4, s[8:11], s35 offen offset:2048 sc1 lds
  buffer_load_dwordx4 v4, s[8:11], s35 offen offset:3072 sc1 lds
  s_add_u32 m0, s39, 12288
  s_add_u32 s35, s36, 24576
  buffer_load_dwordx4 v4, s[8:11], s35 offen offset:0 sc1 lds
  buffer_load_dwordx4 v4, s[8:11], s35 offen offset:1024 sc1 lds
  s_add_u32 s68, s68, 1
  s_waitcnt vmcnt(0)
  ds_read2st64_b32 v[224:225], v5 offset0:16 offset1:17
  ds_read2st64_b32 v[226:227], v5 offset0:18 offset1:19
  ds_read2st64_b32 v[228:229], v5 offset0:20 offset1:21
  ds_read2st64_b32 v[230:231], v5 offset0:22 offset1:23
  s_waitcnt lgkmcnt(0)
  v_max3_u32 v44, v224, v225, v226
  v_max3_u32 v45, v227, v228, v229
  v_max3_u32 v44, v44, v230, v231
  v_max_u32 v44, v44, v45
  v_cmp_eq_u32 vcc, -1, v44
  s_cmp_ge_u32 s68, 0x20000
  s_cbranch_scc1 k_zp2_go
  s_nop 2
  s_cbranch_vccnz k_zp2
k_zp2_go:
  s_branch k_zb2
k_zs3:
  s_mov_b32 s68, 0
k_zp3:
  s_add_u32 m0, s39, 6144
  s_add_u32 s35, s36, 12288
  buffer_load_dwordx4 v4, s[8:11], s35 offen offset:0 sc1 lds
  buffer_load_dwordx4 v4, s[8:11], s35 offen offset:1024 sc1 lds
  s_add_u32 s35, s36, 14336
  buffer_load_dwordx4 v4, s[8:11], s35 offen offset:2048 sc1 lds
  buffer_load_dwordx4 v4, s[8:11], s35 offen offset:3072 sc1 lds
  s_add_u32 m0, s39, 10240
  s_add_u32 s35, s36, 20480
  buffer_load_dwordx4 v4, s[8:11], s35 offen offset:0 sc1 lds
  buffer_load_dwordx4 v4, s[8:11], s35 offen offset:1024 sc1 lds
  s_add_u32 s35, s36, 22528
  buffer_load_dwordx4 v4, s[8:11], s35 offen offset:2048 sc1 lds
  buffer_load_dwordx4 v4, s[8:11], s35 offen offset:3072 sc1 lds
  s_add_u32 s68, s68, 1
  s_waitcnt vmcnt(0)
  ds_read2st64_b32 v[208:209], v5 offset0:24 offset1:25
  ds_read2st64_b32 v[210:211], v5 offset0:26 offset1:27
  ds_read2st64_b32 v[212:213], v5 offset0:28 offset1:29
  ds_read2st64_b32 v[214:215], v5 offset0:30 offset1:31
  s_waitcnt lgkmcnt(0)
  v_max3_u32 v44, v208, v209, v210
  v_max3_u32 v45, v211, v212, v213
  v_max3_u32 v44, v44, v214, v215
  v_max_u32 v44, v44, v45
  v_cmp_eq_u32 vcc, -1, v44
  s_cmp_ge_u32 s68, 0x20000
  s_cbranch_scc1 k_zp3_go
  s_nop 2
  s_cbranch_vccnz k_zp3
k_zp3_go:
  s_branch k_zb3
k_zs4:
  s_mov_b32 s68, 0
k_zp4:
  s_add_u32 m0, s39, 8192
  s_add_u32 s35, s36, 16384
  buffer_load_dwordx4 v4, s[8:11], s35 offen offset:0 sc1 lds
  buffer_load_dwordx4 v4, s[8:11], s35 offen offset:1024 sc1 lds
  s_add_u32 s35, s36, 18432
  buffer_load_dwordx4 v4, s[8:11], s35 offen offset:2048 sc1 lds
  buffer_load_dwordx4 v4, s[8:11], s35 offen offset:3072 sc1 lds
  s_add_u32 m0, s39, 12288
  s_add_u32 s35, s36, 24576
  buffer_load_dwordx4 v4, s[8:11], s35 offen offset:0 sc1 lds
  buffer_load_dwordx4 v4, s[8:11], s35 offen offset:1024 sc1 lds
  s_add_u32 s68, s68, 1
  s_waitcnt vmcnt(0)
  ds_read2st64_b32 v[216:217], v5 offset0:32 offset1:33
  ds_read2st64_b32 v[218:219], v5 offset0:34 offset1:35
  ds_read2st64_b32 v[220:221], v5 offset0:36 offset1:37
  ds_read2st64_b32 v[222:223], v5 offset0:38 offset1:39
  s_waitcnt lgkmcnt(0)
  v_max3_u32 v44, v216, v217, v218
  v_max3_u32 v45, v219, v220, v221
  v_max3_u32 v44, v44, v222, v223
  v_max_u32 v44, v44, v45
  v_cmp_eq_u32 vcc, -1, v44
  s_cmp_ge_u32 s68, 0x20000
  s_cbranch_scc1 k_zp4_go
  s_nop 2
  s_cbranch_vccnz k_zp4
k_zp4_go:
  s_branch k_zb4
k_zs5:
  s_mov_b32 s68, 0
k_zp5:
  s_add_u32 m0, s39, 10240
  s_add_u32 s35, s36, 20480
  buffer_load_dwordx4 v4, s[8:11], s35 offen offset:0 sc1 lds
  buffer_load_dwordx4 v4, s[8:11], s35 offen offset:1024 sc1 lds
  s_add_u32 s35, s36, 22528
  buffer_load_dwordx4 v4, s[8:11], s35 offen offset:2048 sc1 lds
  buffer_load_dwordx4 v4, s[8:11], s35 offen offset:3072 sc1 lds
  s_add_u32 s68, s68, 1
  s_waitcnt vmcnt(0)
  ds_read2st64_b32 v[224:225], v5 offset0:40 offset1:41
  ds_read2st64_b32 v[226:227], v5 offset0:42 offset1:43
  ds_read2st64_b32 v[228:229], v5 offset0:44 offset1:45
  ds_read2st64_b32 v[230:231], v5 offset0:46 offset1:47
  s_waitcnt lgkmcnt(0)
  v_max3_u32 v44, v224, v225, v226
  v_max3_u32 v45, v227, v228, v229
  v_max3_u32 v44, v44, v230, v231
  v_max_u32 v44, v44, v45
  v_cmp_eq_u32 vcc, -1, v44
  s_cmp_ge_u32 s68, 0x20000
  s_cbranch_scc1 k_zp5_go
  s_nop 2
  s_cbranch_vccnz k_zp5
k_zp5_go:
  s_branch k_zb5
k_zs6:
  s_mov_b32 s68, 0
k_zp6:
  s_add_u32 m0, s39, 12288
  s_add_u32 s35, s36, 24576
  buffer_load_dwordx4 v4, s[8:11], s35 offen offset:0 sc1 lds
  buffer_load_dwordx4 v4, s[8:11], s35 offen offset:1024 sc1 lds
  s_add_u32 s68, s68, 1
  s_waitcnt vmcnt(0)
  ds_read2st64_b32 v[208:209], v5 offset0:48 offset1:49
  ds_read2st64_b32 v[210:211], v5 offset0:50 offset1:51
  ds_read2st64_b32 v[212:213], v5 offset0:52 offset1:53
  ds_read2st64_b32 v[214:215], v5 offset0:54 offset1:55
  s_waitcnt lgkmcnt(0)
  v_max3_u32 v44, v208, v209, v210
  v_max3_u32 v45, v211, v212, v213
  v_max3_u32 v44, v44, v214, v215
  v_max_u32 v44, v44, v45
  v_cmp_eq_u32 vcc, -1, v44
  s_cmp_ge_u32 s68, 0x20000
  s_cbranch_scc1 k_zp6_go
  s_nop 2
  s_cbranch_vccnz k_zp6
k_zp6_go:
  s_branch k_zb6
k_hs1_0:
  s_mov_b32 s68, 0
k_hp1_0:
  s_add_u32 s35, s43, 0
  buffer_load_dwordx4 a[108:111], v88, s[8:11], s35 offen sc1
  buffer_load_dwordx4 a[112:115], v89, s[8:11], s35 offen sc1
  buffer_load_dwordx4 a[116:119], v90, s[8:11], s35 offen sc1
  buffer_load_dwordx4 a[120:123], v91, s[8:11], s35 offen sc1
  s_add_u32 s35, s43, 4096
  buffer_load_dwordx4 v[100:103], v88, s[8:11], s35 offen sc1
  buffer_load_dwordx4 v[104:107], v89, s[8:11], s35 offen sc1
  buffer_load_dwordx4 v[108:111], v90, s[8:11], s35 offen sc1
  buffer_load_dwordx4 v[112:115], v91, s[8:11], s35 offen sc1
  s_add_u32 s68, s68, 1
  s_waitcnt vmcnt(0)
  v_accvgpr_read_b32 v21, a108
  v_accvgpr_read_b32 v22, a112
  v_accvgpr_read_b32 v19, a116
  v_bitop3_b32 v21, v21, v22, v19 bitop3:0x80
  v_accvgpr_read_b32 v22, a120
  v_bitop3_b32 v21, v21, v22, 1 bitop3:0x80
  v_cmp_ne_u32 vcc, 1, v21
  s_cmp_ge_u32 s68, 0x20000
  s_cbranch_scc1 k_hp1_0_go
  s_nop 2
  s_cbranch_vccnz k_hp1_0
k_hp1_0_go:
  s_branch k_hb1_0
k_hs1_1:
  s_mov_b32 s68, 0
k_hp1_1:
  s_add_u32 s35, s43, 1835008
  buffer_load_dwordx4 a[124:127], v88, s[8:11], s35 offen sc1
  buffer_load_dwordx4 a[128:131], v89, s[8:11], s35 offen sc1
  buffer_load_dwordx4 a[132:135], v90, s[8:11], s35 offen sc1
  buffer_load_dwordx4 v[96:99], v91, s[8:11], s35 offen sc1
  s_add_u32 s35, s43, 1839104
  buffer_load_dwordx4 v[116:119], v88, s[8:11], s35 offen sc1
  buffer_load_dwordx4 v[120:123], v89, s[8:11], s35 offen sc1
  buffer_load_dwordx4 v[124:127], v90, s[8:11], s35 offen sc1
  buffer_load_dwordx4 v[128:131], v91, s[8:11], s35 offen sc1
  s_add_u32 s68, s68, 1
  s_waitcnt vmcnt(0)
  v_accvgpr_read_b32 v21, a124
  v_accvgpr_read_b32 v22, a128
  v_accvgpr_read_b32 v19, a132
  v_bitop3_b32 v21, v21, v22, v19 bitop3:0x80
  v_bitop3_b32 v21, v21, v96, 1 bitop3:0x80
  v_cmp_ne_u32 vcc, 1, v21
  s_cmp_ge_u32 s68, 0x20000
  s_cbranch_scc1 k_hp1_1_go
  s_nop 2
  s_cbranch_vccnz k_hp1_1
k_hp1_1_go:
  s_branch k_hb1_1
k_hs1_2:
  s_mov_b32 s68, 0
k_hp1_2:
  s_add_u32 s35, s43, 4096
  buffer_load_dwordx4 v[100:103], v88, s[8:11], s35 offen sc1
  buffer_load_dwordx4 v[104:107], v89, s[8:11], s35 offen sc1
  buffer_load_dwordx4 v[108:111], v90, s[8:11], s35 offen sc1
  buffer_load_dwordx4 v[112:115], v91, s[8:11], s35 offen sc1
  s_add_u32 s68, s68, 1
  s_waitcnt vmcnt(0)
  v_bitop3_b32 v21, v100, v104, v108 bitop3:0x80
  v_bitop3_b32 v21, v21, v112, 1 bitop3:0x80
  v_cmp_ne_u32 vcc, 1, v21
  s_cmp_ge_u32 s68, 0x20000
  s_cbranch_scc1 k_hp1_2_go
  s_nop 2
  s_cbranch_vccnz k_hp1_2
k_hp1_2_go:
  s_branch k_hb1_2
k_hs1_3:
  s_mov_b32 s68, 0
k_hp1_3:
  s_add_u32 s35, s43, 1839104
  buffer_load_dwordx4 v[116:119], v88, s[8:11], s35 offen sc1
  buffer_load_dwordx4 v[120:123], v89, s[8:11], s35 offen sc1
  buffer_load_dwordx4 v[124:127], v90, s[8:11], s35 offen sc1
  buffer_load_dwordx4 v[128:131], v91, s[8:11], s35 offen sc1
  s_add_u32 s68, s68, 1
  s_waitcnt vmcnt(0)
  v_bitop3_b32 v21, v116, v120, v124 bitop3:0x80
  v_bitop3_b32 v21, v21, v128, 1 bitop3:0x80
  v_cmp_ne_u32 vcc, 1, v21
  s_cmp_ge_u32 s68, 0x20000
  s_cbranch_scc1 k_hp1_3_go
  s_nop 2
  s_cbranch_vccnz k_hp1_3
k_hp1_3_go:
  s_branch k_hb1_3
k_hs1_4:
  s_mov_b32 s68, 0
k_hp1_4:
  s_add_u32 s35, s43, 8192
  buffer_load_dwordx4 v[132:135], v88, s[8:11], s35 offen sc1
  buffer_load_dwordx4 v[136:139], v89, s[8:11], s35 offen sc1
  buffer_load_dwordx4 v[140:143], v90, s[8:11], s35 offen sc1
  buffer_load_dwordx4 v[208:211], v91, s[8:11], s35 offen sc1
  s_add_u32 s35, s43, 12288
  buffer_load_dwordx4 v[228:231], v88, s[8:11], s35 offen sc1
  buffer_load_dwordx4 v[232:235], v89, s[8:11], s35 offen sc1
  buffer_load_dwordx4 v[236:239], v90, s[8:11], s35 offen sc1
  buffer_load_dwordx4 v[240:243], v91, s[8:11], s35 offen sc1
  s_add_u32 s68, s68, 1
  s_waitcnt vmcnt(0)
  v_bitop3_b32 v21, v132, v136, v140 bitop3:0x80
  v_bitop3_b32 v21, v21, v208, 1 bitop3:0x80
  v_cmp_ne_u32 vcc, 1, v21
  s_cmp_ge_u32 s68, 0x20000
  s_cbranch_scc1 k_hp1_4_go
  s_nop 2
  s_cbranch_vccnz k_hp1_4
k_hp1_4_go:
  s_branch k_hb1_4
k_hs1_5:
  s_mov_b32 s68, 0
k_hp1_5:
  s_add_u32 s35, s43, 1843200
  buffer_load_dwordx4 v[212:215], v88, s[8:11], s35 offen sc1
  buffer_load_dwordx4 v[216:219], v89, s[8:11], s35 offen sc1
  buffer_load_dwordx4 v[220:223], v90, s[8:11], s35 offen sc1
  buffer_load_dwordx4 v[224:227], v91, s[8:11], s35 offen sc1
  s_add_u32 s35, s43, 1847296
  buffer_load_dwordx4 v[32:35], v88, s[8:11], s35 offen sc1
  buffer_load_dwordx4 v[36:39], v89, s[8:11], s35 offen sc1
  buffer_load_dwordx4 v[40:43], v90, s[8:11], s35 offen sc1
  buffer_load_dwordx4 v[72:75], v91, s[8:11], s35 offen sc1
  s_add_u32 s68, s68, 1
  s_waitcnt vmcnt(0)
  v_bitop3_b32 v21, v212, v216, v220 bitop3:0x80
  v_bitop3_b32 v21, v21, v224, 1 bitop3:0x80
  v_cmp_ne_u32 vcc, 1, v21
  s_cmp_ge_u32 s68, 0x20000
  s_cbranch_scc1 k_hp1_5_go
  s_nop 2
  s_cbranch_vccnz k_hp1_5
k_hp1_5_go:
  s_branch k_hb1_5
k_hs1_6:
  s_mov_b32 s68, 0
k_hp1_6:
  s_add_u32 s35, s43, 12288
  buffer_load_dwordx4 v[228:231], v88, s[8:11], s35 offen sc1
  buffer_load_dwordx4 v[232:235], v89, s[8:11], s35 offen sc1
  buffer_load_dwordx4 v[236:239], v90, s[8:11], s35 offen sc1
  buffer_load_dwordx4 v[240:243], v91, s[8:11], s35 offen sc1
  s_add_u32 s68, s68, 1
  s_waitcnt vmcnt(0)
  v_bitop3_b32 v21, v228, v232, v236 bitop3:0x80
  v_bitop3_b32 v21, v21, v240, 1 bitop3:0x80
  v_cmp_ne_u32 vcc, 1, v21
  s_cmp_ge_u32 s68, 0x20000
  s_cbranch_scc1 k_hp1_6_go
  s_nop 2
  s_cbranch_vccnz k_hp1_6
k_hp1_6_go:
  s_branch k_hb1_6
k_hs1_7:
  s_mov_b32 s68, 0
k_hp1_7:
  s_add_u32 s35, s43, 1847296
  buffer_load_dwordx4 v[32:35], v88, s[8:11], s35 offen sc1
  buffer_load_dwordx4 v[36:39], v89, s[8:11], s35 offen sc1
  buffer_load_dwordx4 v[40:43], v90, s[8:11], s35 offen sc1
  buffer_load_dwordx4 v[72:75], v91, s[8:11], s35 offen sc1
  s_add_u32 s68, s68, 1
  s_waitcnt vmcnt(0)
  v_bitop3_b32 v21, v32, v36, v40 bitop3:0x80
  v_bitop3_b32 v21, v21, v72, 1 bitop3:0x80
  v_cmp_ne_u32 vcc, 1, v21
  s_cmp_ge_u32 s68, 0x20000
  s_cbranch_scc1 k_hp1_7_go
  s_nop 2
  s_cbranch_vccnz k_hp1_7
k_hp1_7_go:
  s_branch k_hb1_7
k_hs1_8:
  s_mov_b32 s68, 0
k_hp1_8:
  s_add_u32 s35, s43, 16384
  buffer_load_dwordx4 v[76:79], v88, s[8:11], s35 offen sc1
  buffer_load_dwordx4 v[96:99], v89, s[8:11], s35 offen sc1
  buffer_load_dwordx4 v[100:103], v90, s[8:11], s35 offen sc1
  buffer_load_dwordx4 v[104:107], v91, s[8:11], s35 offen sc1
  s_add_u32 s35, s43, 20480
  buffer_load_dwordx4 v[80:83], v88, s[8:11], s35 offen sc1
  buffer_load_dwordx4 v[84:87], v89, s[8:11], s35 offen sc1
  buffer_load_dwordx4 v[116:119], v90, s[8:11], s35 offen sc1
  buffer_load_dwordx4 v[120:123], v91, s[8:11], s35 offen sc1
  s_add_u32 s68, s68, 1
  s_waitcnt vmcnt(0)
  v_bitop3_b32 v21, v76, v96, v100 bitop3:0x80
  v_bitop3_b32 v21, v21, v104, 1 bitop3:0x80
  v_cmp_ne_u32 vcc, 1, v21
  s_cmp_ge_u32 s68, 0x20000
  s_cbranch_scc1 k_hp1_8_go
  s_nop 2
  s_cbranch_vccnz k_hp1_8
k_hp1_8_go:
  s_branch k_hb1_8
k_hs1_9:
  s_mov_b32 s68, 0
k_hp1_9:
  s_add_u32 s35, s43, 1851392
  buffer_load_dwordx4 v[108:111], v88, s[8:11], s35 offen sc1
  buffer_load_dwordx4 v[112:115], v89, s[8:11], s35 offen sc1
  buffer_load_dwordx4 v[64:67], v90, s[8:11], s35 offen sc1
  buffer_load_dwordx4 v[68:71], v91, s[8:11], s35 offen sc1
  s_add_u32 s35, s43, 1855488
  buffer_load_dwordx4 v[124:127], v89, s[8:11], s35 offen sc1
  buffer_load_dwordx4 v[136:139], v90, s[8:11], s35 offen sc1
  buffer_load_dwordx4 v[212:215], v91, s[8:11], s35 offen sc1
  s_add_u32 s68, s68, 1
  s_waitcnt vmcnt(0)
  v_bitop3_b32 v21, v108, v112, v64 bitop3:0x80
  v_bitop3_b32 v21, v21, v68, 1 bitop3:0x80
  v_cmp_ne_u32 vcc, 1, v21
  s_cmp_ge_u32 s68, 0x20000
  s_cbranch_scc1 k_hp1_9_go
  s_nop 2
  s_cbranch_vccnz k_hp1_9
k_hp1_9_go:
  s_branch k_hb1_9
k_hs1_10:
  s_mov_b32 s68, 0
k_hp1_10:
  s_add_u32 s35, s43, 20480
  buffer_load_dwordx4 v[80:83], v88, s[8:11], s35 offen sc1
  buffer_load_dwordx4 v[84:87], v89, s[8:11], s35 offen sc1
  buffer_load_dwordx4 v[116:119], v90, s[8:11], s35 offen sc1
  buffer_load_dwordx4 v[120:123], v91, s[8:11], s35 offen sc1
  s_add_u32 s68, s68, 1
  s_waitcnt vmcnt(0)
  v_bitop3_b32 v21, v80, v84, v116 bitop3:0x80
  v_bitop3_b32 v21, v21, v120, 1 bitop3:0x80
  v_cmp_ne_u32 vcc, 1, v21
  s_cmp_ge_u32 s68, 0x20000
  s_cbranch_scc1 k_hp1_10_go
  s_nop 2
  s_cbranch_vccnz k_hp1_10
k_hp1_10_go:
  s_branch k_hb1_10
k_hs1_11:
  s_mov_b32 s68, 0
k_hp1_11:
  s_add_u32 s35, s43, 1855488
  buffer_load_dwordx4 v[124:127], v89, s[8:11], s35 offen sc1
  s_add_u32 s35, s43, 24576
  buffer_load_dwordx4 v[128:131], v89, s[8:11], s35 offen sc1
  s_add_u32 s35, s43, 1859584
  buffer_load_dwordx4 v[132:135], v89, s[8:11], s35 offen sc1
  s_add_u32 s35, s43, 1855488
  buffer_load_dwordx4 v[136:139], v90, s[8:11], s35 offen sc1
  s_add_u32 s35, s43, 24576
  buffer_load_dwordx4 v[140:143], v90, s[8:11], s35 offen sc1
  s_add_u32 s35, s43, 1859584
  buffer_load_dwordx4 v[208:211], v90, s[8:11], s35 offen sc1
  s_add_u32 s35, s43, 1855488
  buffer_load_dwordx4 v[212:215], v91, s[8:11], s35 offen sc1
  s_add_u32 s35, s43, 24576
  buffer_load_dwordx4 v[216:219], v91, s[8:11], s35 offen sc1
  s_add_u32 s35, s43, 1859584
  buffer_load_dwordx4 v[220:223], v91, s[8:11], s35 offen sc1
  s_add_u32 s35, s43, 1855488
  buffer_load_dwordx4 v[224:227], v88, s[8:11], s35 offen sc1
  s_add_u32 s35, s43, 24576
  buffer_load_dwordx4 v[228:231], v88, s[8:11], s35 offen sc1
  s_add_u32 s35, s43, 1859584
  buffer_load_dwordx4 v[232:235], v88, s[8:11], s35 offen sc1
  s_add_u32 s68, s68, 1
  s_waitcnt vmcnt(0)
  v_bitop3_b32 v21, v124, v128, v132 bitop3:0x80
  v_bitop3_b32 v21, v21, v136, 1 bitop3:0x80
  v_cmp_ne_u32 vcc, 1, v21
  s_cmp_ge_u32 s68, 0x20000
  s_cbranch_scc1 k_hp1_11_go
  s_nop 2
  s_cbranch_vccnz k_hp1_11
k_hp1_11_go:
  s_branch k_hb1_11
k_hs1_12:
  s_mov_b32 s68, 0
k_hp1_12:
  s_add_u32 s35, s43, 24576
  buffer_load_dwordx4 v[140:143], v90, s[8:11], s35 offen sc1
  s_add_u32 s35, s43, 1859584
  buffer_load_dwordx4 v[208:211], v90, s[8:11], s35 offen sc1
  s_add_u32 s35, s43, 1855488
  buffer_load_dwordx4 v[212:215], v91, s[8:11], s35 offen sc1
  s_add_u32 s35, s43, 24576
  buffer_load_dwordx4 v[216:219], v91, s[8:11], s35 offen sc1
  s_add_u32 s35, s43, 1859584
  buffer_load_dwordx4 v[220:223], v91, s[8:11], s35 offen sc1
  s_add_u32 s35, s43, 1855488
  buffer_load_dwordx4 v[224:227], v88, s[8:11], s35 offen sc1
  s_add_u32 s35, s43, 24576
  buffer_load_dwordx4 v[228:231], v88, s[8:11], s35 offen sc1
  s_add_u32 s35, s43, 1859584
  buffer_load_dwordx4 v[232:235], v88, s[8:11], s35 offen sc1
  s_add_u32 s68, s68, 1
  s_waitcnt vmcnt(0)
  v_bitop3_b32 v21, v140, v208, v212 bitop3:0x80
  v_bitop3_b32 v21, v21, v216, 1 bitop3:0x80
  v_cmp_ne_u32 vcc, 1, v21
  s_cmp_ge_u32 s68, 0x20000
  s_cbranch_scc1 k_hp1_12_go
  s_nop 2
  s_cbranch_vccnz k_hp1_12
k_hp1_12_go:
  s_branch k_hb1_12
k_hs1_13:
  s_mov_b32 s68, 0
k_hp1_13:
  s_add_u32 s35, s43, 1859584
  buffer_load_dwordx4 v[220:223], v91, s[8:11], s35 offen sc1
  s_add_u32 s35, s43, 1855488
  buffer_load_dwordx4 v[224:227], v88, s[8:11], s35 offen sc1
  s_add_u32 s35, s43, 24576
  buffer_load_dwordx4 v[228:231], v88, s[8:11], s35 offen sc1
  s_add_u32 s35, s43, 1859584
  buffer_load_dwordx4 v[232:235], v88, s[8:11], s35 offen sc1
  s_add_u32 s68, s68, 1
  s_waitcnt vmcnt(0)
  v_bitop3_b32 v21, v220, v224, v228 bitop3:0x80
  v_bitop3_b32 v21, v21, v232, 1 bitop3:0x80
  v_cmp_ne_u32 vcc, 1, v21
  s_cmp_ge_u32 s68, 0x20000
  s_cbranch_scc1 k_hp1_13_go
  s_nop 2
  s_cbranch_vccnz k_hp1_13
k_hp1_13_go:
  s_branch k_hb1_13
k_xre:
  s_cmp_eq_u32 s101, 0
  s_cbranch_scc1 k_xok
  s_sub_u32 s101, s101, 1
  s_waitcnt vmcnt(0) lgkmcnt(0)
  s_nop 7
  s_nop 7
  s_branch k_l2
k_rre:
  s_cmp_eq_u32 s101, 0
  s_cbranch_scc1 k_join
  s_sub_u32 s101, s101, 1
  s_mov_b32 s1, s29
k_res:
  s_add_u32 m0, s39, 0
  s_nop 0
  buffer_load_dwordx4 v60, s[4:7], s1 offen sc1 lds
  s_add_u32 m0, s39, 1024
  s_nop 0
  buffer_load_dwordx4 v61, s[4:7], s1 offen sc1 lds
  s_add_u32 m0, s39, 2048
  s_add_u32 s1, s1, s100
  buffer_load_dwordx4 v60, s[4:7], s1 offen sc1 lds
  s_add_u32 m0, s39, 3072
  s_nop 0
  buffer_load_dwordx4 v61, s[4:7], s1 offen sc1 lds
  s_add_u32 m0, s39, 4096
  s_add_u32 s1, s1, s100
  buffer_load_dwordx4 v60, s[4:7], s1 offen sc1 lds
  s_add_u32 m0, s39, 5120
  s_nop 0
  buffer_load_dwordx4 v61, s[4:7], s1 offen sc1 lds
  s_add_u32 m0, s39, 6144
  s_add_u32 s1, s1, s100
  buffer_load_dwordx4 v60, s[4:7], s1 offen sc1 lds
  s_add_u32 m0, s39, 7168
  s_nop 0
  buffer_load_dwordx4 v61, s[4:7], s1 offen sc1 lds
  s_add_u32 m0, s39, 8192
  s_add_u32 s1, s1, s100
  buffer_load_dwordx4 v60, s[4:7], s1 offen sc1 lds
  s_add_u32 m0, s39, 9216
  s_nop 0
  buffer_load_dwordx4 v61, s[4:7], s1 offen sc1 lds
  s_add_u32 m0, s39, 10240
  s_add_u32 s1, s1, s100
  buffer_load_dwordx4 v60, s[4:7], s1 offen sc1 lds
  s_add_u32 m0, s39, 11264
  s_nop 0
  buffer_load_dwordx4 v61, s[4:7], s1 offen sc1 lds
  s_add_u32 m0, s39, 12288
  s_add_u32 s1, s1, s100
  buffer_load_dwordx4 v60, s[4:7], s1 offen sc1 lds
  s_add_u32 m0, s39, 13312
  s_nop 0
  buffer_load_dwordx4 v61, s[4:7], s1 offen sc1 lds
  s_waitcnt vmcnt(0)
  s_branch k_a2t
k_idle1:
  v_lshlrev_b32 v63, 4, v63
  v_and_b32 v2, 15, v1
  v_lshlrev_b32 v4, 4, v1
  s_mov_b32 s19, 0x00020000
  s_sub_u32 s21, s2, 224
  s_lshl_b32 s21, s21, 2
  s_add_u32 s21, s21, s20
  s_cmp_eq_u32 s21, 127
  s_cselect_b32 s22, 0, 0x80000000
  v_mov_b32 v28, s22
  v_mov_b32 v36, 1
  v_mov_b32 v80, -1
  v_lshlrev_b32 v37, 6, v1
  v_add_u32 v37, s22, v37
  s_mov_b32 s49, 896
  v_mad_u32_u24 v63, v62, s49, v63
  s_add_u32 s55, s39, 57344
  s_mov_b32 s18, 1605632
  s_add_u32 s22, s21, 112
  s_lshr_b32 s25, s22, 3
  s_and_b32 s22, s22, 7
  s_mul_i32 s26, s25, 28672
  s_mul_i32 s35, s22, 112
  s_add_u32 s26, s26, s35
  s_mul_i32 s35, s25, 9363
  s_lshr_b32 s35, s35, 16
  s_mul_i32 s34, s35, 7
  s_sub_u32 s34, s25, s34
  s_cmp_eq_u32 s34, 0
  s_cselect_b32 s34, 7, s34
  s_sub_u32 s34, s34, 1
  s_lshl_b32 s34, s34, 1
  s_and_b32 s25, s35, 1
  s_add_u32 s34, s34, s25
  s_lshr_b32 s35, s35, 1
  s_lshl_b32 s22, s22, 2
  s_add_u32 s35, s35, s22
  s_mul_i32 s35, s35, 14
  s_add_u32 s35, s35, s34
  s_lshl_b32 s35, s35, 12
  s_add_u32 s46, s35, 0x310000
  s_add_u32 s22, s21, 240
  s_lshr_b32 s25, s22, 3
  s_and_b32 s22, s22, 7
  s_mul_i32 s27, s25, 28672
  s_mul_i32 s35, s22, 112
  s_add_u32 s27, s27, s35
  s_mul_i32 s35, s25, 9363
  s_lshr_b32 s35, s35, 16
  s_mul_i32 s34, s35, 7
  s_sub_u32 s34, s25, s34
  s_cmp_eq_u32 s34, 0
  s_cselect_b32 s34, 7, s34
  s_sub_u32 s34, s34, 1
  s_lshl_b32 s34, s34, 1
  s_and_b32 s25, s35, 1
  s_add_u32 s34, s34, s25
  s_lshr_b32 s35, s35, 1
  s_lshl_b32 s22, s22, 2
  s_add_u32 s35, s35, s22
  s_mul_i32 s35, s35, 14
  s_add_u32 s35, s35, s34
  s_lshl_b32 s35, s35, 12
  s_add_u32 s47, s35, 0x310000
  s_add_u32 s22, s21, 368
  s_lshr_b32 s25, s22, 3
  s_and_b32 s22, s22, 7
  s_mul_i32 s28, s25, 28672
  s_mul_i32 s35, s22, 112
  s_add_u32 s28, s28, s35
  s_mul_i32 s35, s25, 9363
  s_lshr_b32 s35, s35, 16
  s_mul_i32 s34, s35, 7
  s_sub_u32 s34, s25, s34
  s_cmp_eq_u32 s34, 0
  s_cselect_b32 s34, 7, s34
  s_sub_u32 s34, s34, 1
  s_lshl_b32 s34, s34, 1
  s_and_b32 s25, s35, 1
  s_add_u32 s34, s34, s25
  s_lshr_b32 s35, s35, 1
  s_lshl_b32 s22, s22, 2
  s_add_u32 s35, s35, s22
  s_mul_i32 s35, s35, 14
  s_add_u32 s35, s35, s34
  s_lshl_b32 s35, s35, 12
  s_add_u32 s48, s35, 0x310000
  s_cmp_ge_u32 s21, 80
  s_cselect_b32 s28, 0x80000000, s28
  s_cselect_b32 s48, 0x80000000, s48
  s_waitcnt lgkmcnt(0)
  s_mov_b32 s16, s60
  s_mov_b32 s17, s61
  s_mov_b32 s8, s66
  s_mov_b32 s9, s67
  s_mov_b32 s10, 0x1a00000
  s_mov_b32 s11, 0x00020000
  s_mov_b32 s12, s62
  s_mov_b32 s13, s63
  s_mov_b32 s14, 0x1c0000
  s_mov_b32 s15, 0x00020000
  s_mov_b32 s66, 0x100
  s_mov_b32 s67, 0x00020000
  s_mov_b32 s35, 0xb00000
  buffer_store_dword v80, v37, s[8:11], s35 offen sc1
  s_mov_b32 s35, 0xb01000
  buffer_store_dword v80, v37, s[8:11], s35 offen sc1
  s_mov_b32 s35, 0xb02000
  buffer_store_dword v80, v37, s[8:11], s35 offen sc1
  s_mov_b32 s35, 0xb03000
  buffer_store_dword v80, v37, s[8:11], s35 offen sc1
  v_add_u32 v40, s26, v63
  s_add_u32 m0, s55, 0
  s_mov_b32 s35, 0
  buffer_load_dwordx4 v40, s[16:19], s35 offen lds
  s_add_u32 m0, s55, 1024
  s_mov_b32 s35, 7168
  buffer_load_dwordx4 v40, s[16:19], s35 offen lds
  s_add_u32 m0, s55, 2048
  s_mov_b32 s35, 14336
  buffer_load_dwordx4 v40, s[16:19], s35 offen lds
  s_add_u32 m0, s55, 3072
  s_mov_b32 s35, 21504
  buffer_load_dwordx4 v40, s[16:19], s35 offen lds
  v_add_u32 v41, s27, v63
  s_add_u32 m0, s55, 4096
  s_mov_b32 s35, 0
  buffer_load_dwordx4 v41, s[16:19], s35 offen lds
  s_add_u32 m0, s55, 5120
  s_mov_b32 s35, 7168
  buffer_load_dwordx4 v41, s[16:19], s35 offen lds
  s_add_u32 m0, s55, 6144
  s_mov_b32 s35, 14336
  buffer_load_dwordx4 v41, s[16:19], s35 offen lds
  s_add_u32 m0, s55, 7168
  s_mov_b32 s35, 21504
  buffer_load_dwordx4 v41, s[16:19], s35 offen lds
  v_add_u32 v42, s28, v63
  s_add_u32 m0, s55, 8192
  s_mov_b32 s35, 0
  buffer_load_dwordx4 v42, s[16:19], s35 offen lds
  s_add_u32 m0, s55, 9216
  s_mov_b32 s35, 7168
  buffer_load_dwordx4 v42, s[16:19], s35 offen lds
  s_add_u32 m0, s55, 10240
  s_mov_b32 s35, 14336
  buffer_load_dwordx4 v42, s[16:19], s35 offen lds
  s_add_u32 m0, s55, 11264
  s_mov_b32 s35, 21504
  buffer_load_dwordx4 v42, s[16:19], s35 offen lds
  s_waitcnt vmcnt(12)
  buffer_store_dword v36, v28, s[64:67], 0 offen sc1
  v_bfe_u32 v44, v1, 2, 2
  v_lshl_add_u32 v44, v3, 3, v44
  v_lshlrev_b32 v44, 3, v44
  v_and_b32 v45, 1, v1
  v_add_u32 v44, v44, v45
  v_lshl_add_u32 v44, v44, 4, s55
  v_bfe_u32 v45, v1, 1, 1
  v_mad_u32_u24 v44, v45, 32, v44
  v_add_u32 v45, 8, v44
  s_bfe_u32 s21, s2, 0x20001
  s_lshl_b32 s21, s21, 3
  s_bfe_u32 s35, s2, 0x30003
  s_add_u32 s21, s21, s35
  s_sub_u32 s26, 64, s21
  s_xor_b32 s28, s23, 1
  s_cmp_eq_u32 s21, 0
  s_cselect_b32 s26, 32, s26
  s_cselect_b32 s28, s23, s28
  s_cmp_eq_u32 s23, 0
  s_cselect_b32 s27, s21, s26
  s_mul_i32 s37, s20, 458752
  s_lshl_b32 s35, s33, 12
  s_add_u32 s37, s37, s35
  s_lshl_b32 s35, s32, 6
  s_add_u32 s37, s37, s35
  s_add_u32 s37, s37, 0x500000
  s_lshl_b32 s1, s24, 10
  s_add_u32 s1, s1, s27
  s_mul_i32 s1, s1, 896
  s_mov_b32 s100, 128
  s_mov_b32 s101, 0
  s_mov_b32 s3, 0
  s_lshl_b32 s35, s20, 11
  s_add_u32 s35, s35, 155648
  v_add_u32 v17, s35, v4
  v_xor_b32 v18, 2048, v17
  s_add_u32 m0, s39, 0
  s_nop 0
  buffer_load_dwordx4 v60, s[4:7], s1 offen offset:0 lds
  s_add_u32 m0, s39, 1024
  s_nop 0
  buffer_load_dwordx4 v61, s[4:7], s1 offen offset:0 lds
  s_add_u32 m0, s39, 1920
  s_nop 0
  buffer_load_dwordx4 v60, s[4:7], s1 offen offset:128 lds
  s_add_u32 m0, s39, 2944
  s_nop 0
  buffer_load_dwordx4 v61, s[4:7], s1 offen offset:128 lds
  s_add_u32 m0, s39, 3840
  s_nop 0
  buffer_load_dwordx4 v60, s[4:7], s1 offen offset:256 lds
  s_add_u32 m0, s39, 4864
  s_nop 0
  buffer_load_dwordx4 v61, s[4:7], s1 offen offset:256 lds
  s_add_u32 m0, s39, 5760
  s_nop 0
  buffer_load_dwordx4 v60, s[4:7], s1 offen offset:384 lds
  s_add_u32 m0, s39, 6784
  s_nop 0
  buffer_load_dwordx4 v61, s[4:7], s1 offen offset:384 lds
  s_add_u32 m0, s39, 7680
  s_nop 0
  buffer_load_dwordx4 v60, s[4:7], s1 offen offset:512 lds
  s_add_u32 m0, s39, 8704
  s_nop 0
  buffer_load_dwordx4 v61, s[4:7], s1 offen offset:512 lds
  s_add_u32 m0, s39, 9600
  s_nop 0
  buffer_load_dwordx4 v60, s[4:7], s1 offen offset:640 lds
  s_add_u32 m0, s39, 10624
  s_nop 0
  buffer_load_dwordx4 v61, s[4:7], s1 offen offset:640 lds
  s_add_u32 m0, s39, 11520
  s_nop 0
  buffer_load_dwordx4 v60, s[4:7], s1 offen offset:768 lds
  s_add_u32 m0, s39, 12544
  s_nop 0
  buffer_load_dwordx4 v61, s[4:7], s1 offen offset:768 lds
  v_add_u32 v40, s46, v4
  s_waitcnt vmcnt(22)
  ds_read_b64_tr_b16 v[96:97], v44 offset:0
  ds_read_b64_tr_b16 v[98:99], v44 offset:512
  ds_read_b64_tr_b16 v[100:101], v45 offset:0
  ds_read_b64_tr_b16 v[102:103], v45 offset:512
  ds_read_b64_tr_b16 v[104:105], v44 offset:64
  ds_read_b64_tr_b16 v[106:107], v44 offset:576
  ds_read_b64_tr_b16 v[108:109], v45 offset:64
  ds_read_b64_tr_b16 v[110:111], v45 offset:576
  v_add_u32 v41, s47, v4
  s_waitcnt vmcnt(18)
  ds_read_b64_tr_b16 v[112:113], v44 offset:4096
  ds_read_b64_tr_b16 v[114:115], v44 offset:4608
  ds_read_b64_tr_b16 v[116:117], v45 offset:4096
  ds_read_b64_tr_b16 v[118:119], v45 offset:4608
  ds_read_b64_tr_b16 v[120:121], v44 offset:4160
  ds_read_b64_tr_b16 v[122:123], v44 offset:4672
  ds_read_b64_tr_b16 v[124:125], v45 offset:4160
  ds_read_b64_tr_b16 v[126:127], v45 offset:4672
  v_add_u32 v42, s48, v4
  s_waitcnt vmcnt(14)
  ds_read_b64_tr_b16 v[128:129], v44 offset:8192
  ds_read_b64_tr_b16 v[130:131], v44 offset:8704
  ds_read_b64_tr_b16 v[132:133], v45 offset:8192
  ds_read_b64_tr_b16 v[134:135], v45 offset:8704
  ds_read_b64_tr_b16 v[136:137], v44 offset:8256
  ds_read_b64_tr_b16 v[138:139], v44 offset:8768
  ds_read_b64_tr_b16 v[140:141], v45 offset:8256
  ds_read_b64_tr_b16 v[142:143], v45 offset:8768
  s_waitcnt lgkmcnt(14)
  buffer_store_dwordx4 v[96:99], v40, s[8:11], 0 offen offset:0 sc1
  buffer_store_dwordx4 v[100:103], v40, s[8:11], 0 offen offset:1024 sc1
  buffer_store_dwordx4 v[104:107], v40, s[8:11], 0 offen offset:2048 sc1
  buffer_store_dwordx4 v[108:111], v40, s[8:11], 0 offen offset:3072 sc1
  buffer_store_dwordx4 v[112:115], v41, s[8:11], 0 offen offset:0 sc1
  s_waitcnt lgkmcnt(12)
  buffer_store_dwordx4 v[116:119], v41, s[8:11], 0 offen offset:1024 sc1
  s_waitcnt lgkmcnt(10)
  buffer_store_dwordx4 v[120:123], v41, s[8:11], 0 offen offset:2048 sc1
  s_waitcnt lgkmcnt(8)
  buffer_store_dwordx4 v[124:127], v41, s[8:11], 0 offen offset:3072 sc1
  s_waitcnt lgkmcnt(6)
  buffer_store_dwordx4 v[128:131], v42, s[8:11], 0 offen offset:0 sc1
  s_waitcnt lgkmcnt(4)
  buffer_store_dwordx4 v[132:135], v42, s[8:11], 0 offen offset:1024 sc1
  s_waitcnt lgkmcnt(2)
  buffer_store_dwordx4 v[136:139], v42, s[8:11], 0 offen offset:2048 sc1
  s_waitcnt lgkmcnt(0)
  buffer_store_dwordx4 v[140:143], v42, s[8:11], 0 offen offset:3072 sc1
  s_branch k_l1i
k_last:
  s_endpgm
.section .rodata,"a"
.p2align 6
.amdhsa_kernel interleave_layers__spectral_fnet__swiglu_ffn__prompt_kernel
  .amdhsa_next_free_vgpr 512
  .amdhsa_next_free_sgpr 102
  .amdhsa_accum_offset 256
  .amdhsa_group_segment_fixed_size 0
  .amdhsa_kernarg_size 96
  .amdhsa_user_sgpr_count 2
  .amdhsa_user_sgpr_kernarg_segment_ptr 1
  .amdhsa_system_sgpr_workgroup_id_x 1
.end_amdhsa_kernel
```
